```python
import torch

def _softmax(x, axis=-1):
    return torch.softmax(x, dim=axis)
def _gelu(x):
    return torch.nn.functional.gelu(x, approximate="tanh")
def _silu(x):
    return torch.nn.functional.silu(x)
def _sigmoid(x):
    return torch.sigmoid(x)
def _layernorm(x, axis=-1, eps=1e-5):
    m = x.mean(dim=axis, keepdim=True)
    v = x.var(dim=axis, keepdim=True, unbiased=False)
    return (x - m) / torch.sqrt(v + eps)
def _scatter_add(tgt, idx, src, axis=0):
    return tgt.clone().index_add_(axis, idx, src)
def _segment_sum(src, seg, n):
    out = torch.zeros((n,) + src.shape[1:], dtype=src.dtype)
    return out.index_add_(0, seg, src)
def _pad(x, pw):
    flat = tuple(v for pair in reversed(pw) for v in pair)
    return torch.nn.functional.pad(x, flat)

kernel_name = 'parallel_sum__ssm_conv_h3__glu_gated_bilinear__prompt'

def setup_inputs():

    _w = (lambda a: (lambda t: t.to(torch.bfloat16) if t.is_floating_point() else t)(torch.as_tensor(a)))
    def _A_setup():
        B, S, D = 1, 2048, 576
        ks = 4
        return {
            "q": _w((lambda *s: torch.randn(*s, dtype=torch.bfloat16) * 0.05)(B, S, D)),
            "k": _w((lambda *s: torch.randn(*s, dtype=torch.bfloat16) * 0.2)(B, S, D)),
            "v": _w((lambda *s: torch.randn(*s, dtype=torch.bfloat16) * 0.2)(B, S, D)),
            "shift_k": _w((lambda *s: torch.randn(*s, dtype=torch.bfloat16) * 0.2)(D, ks) * 0.5),
            "ssm_k": _w((lambda *s: torch.randn(*s, dtype=torch.bfloat16) * 0.4)(D, S) * (1.0 / S ** 0.5)),
            "ssm_D": _w((lambda *s: torch.randn(*s, dtype=torch.bfloat16) * 0.2)(D)),
        }
    _A_in = _A_setup()

    def _B_setup():
        B, S, D, F = 1, 2048, 576, 4608
        return {
            "x": _w((lambda *s: torch.randn(*s, dtype=torch.bfloat16) * 0.05)(B, S, D)),
            "w_gate": _w((lambda *s: torch.randn(*s, dtype=torch.bfloat16) * 0.2)(D, F) * (D ** -0.5)),
            "w_up": _w((lambda *s: torch.randn(*s, dtype=torch.bfloat16) * 0.2)(D, F) * (D ** -0.5)),
            "w_down": _w((lambda *s: torch.randn(*s, dtype=torch.bfloat16) * 0.2)(F, D) * (F ** -0.5)),
        }
    _B_in = _B_setup()

    return {
        "A_q": _A_in["q"],
        "A_k": _A_in["k"],
        "A_v": _A_in["v"],
        "A_shift_k": _A_in["shift_k"],
        "A_ssm_k": _A_in["ssm_k"],
        "A_ssm_D": _A_in["ssm_D"],
        "B_x": _B_in["x"],
        "B_w_gate": _B_in["w_gate"],
        "B_w_up": _B_in["w_up"],
        "B_w_down": _B_in["w_down"],
    }

def reference(A_q, A_k, A_v, A_shift_k, A_ssm_k, A_ssm_D, B_x, B_w_gate, B_w_up, B_w_down):
    def _A_ref(q, k, v, shift_k, ssm_k, ssm_D):
        B, S, D = q.shape
        ks = shift_k.shape[-1]
        k_pad = _pad(k, ((0, 0), (ks - 1, 0), (0, 0)))
        k_shift = torch.zeros_like(k)
        for t in range(ks):
            k_shift = k_shift + k_pad[:, t:t + S, :] * shift_k[:, ks - 1 - t][None, None, :]
        kv = k_shift * v
        L = 2 * S
        kv_pad = _pad(kv, ((0, 0), (0, S), (0, 0)))
        kf_pad = _pad(ssm_k, ((0, 0), (0, S)))
        kv_f = (lambda x, axes=(-2,-1): torch.fft.rfft2(x.float(), dim=axes))(kv_pad[:, None, :, :], axes=(1, 2))
        kf_f = (lambda x, axes=(-2,-1): torch.fft.rfft2(x.float(), dim=axes))(kf_pad[:, None, :], axes=(1, 2))
        kf_f = (lambda x, *d: x.permute(*d))(kf_f, 1, 2, 0)
        y_f = kv_f * kf_f[None, :, :, :]
        y = (lambda x, s, axes=(-2,-1): torch.fft.irfft2(x, s=s, dim=axes).to(torch.bfloat16))(y_f, (1, L), axes=(1, 2))[:, 0, :S, :]
        y = y + kv * ssm_D[None, None, :]
        return q * y

    def _B_ref(x, w_gate, w_up, w_down):
        g = torch.einsum("bsd,df->bsf", x, w_gate)
        u = torch.einsum("bsd,df->bsf", x, w_up)
        h = g * u
        return torch.einsum("bsf,fd->bsd", h, w_down)

    x = A_q
    xn = _layernorm(x, axis=-1)
    return x + _A_ref(xn, A_k, A_v, A_shift_k, A_ssm_k, A_ssm_D) + _B_ref(xn, B_w_gate, B_w_up, B_w_down)
```

```asm
; @launch kernel=prep_kernel grid=(208,1,1) block=(256,1,1) lds=0
; @launch kernel=gemm1_kernel grid=(256,1,1) block=(512,1,1) lds=139264
; @launch kernel=gemm2_kernel grid=(448,1,1) block=(512,1,1) lds=73728
; @launch kernel=final_kernel grid=(288,1,1) block=(256,1,1) lds=19456
.amdgcn_target "amdgcn-amd-amdhsa--gfx950"
.text
.globl prep_kernel
.p2align 8
.type prep_kernel,@function
prep_kernel:
    s_load_dwordx2 s[4:5], s[0:1], 0
    s_load_dwordx2 s[6:7], s[0:1], 8
    s_load_dwordx2 s[8:9], s[0:1], 16
    s_load_dwordx2 s[10:11], s[0:1], 24
    s_load_dwordx2 s[12:13], s[0:1], 96
    s_cmp_ge_u32 s2, 208
    s_cbranch_scc1 prep_done
    s_waitcnt lgkmcnt(0)
    s_cmp_ge_u32 s2, 64
    s_cbranch_scc1 prep_kv

    s_mov_b32 s16, s4
    s_mov_b32 s17, s5
    s_mov_b32 s18, 2359296
    s_mov_b32 s19, 0x00020000
    s_mov_b32 s20, s12
    s_mov_b32 s21, s13
    s_mov_b32 s22, 2359296
    s_mov_b32 s23, 0x00020000
    s_lshl_b32 s3, s2, 5
    v_lshrrev_b32 v1, 3, v0
    v_add_u32 v1, s3, v1
    v_and_b32 v2, 7, v0
    s_movk_i32 s24, 1152
    v_mul_lo_u32 v3, v1, s24
    v_lshl_add_u32 v3, v2, 4, v3

    buffer_load_dwordx4 v[8:11], v3, s[16:19], 0 offen offset:0
    buffer_load_dwordx4 v[12:15], v3, s[16:19], 0 offen offset:128
    buffer_load_dwordx4 v[16:19], v3, s[16:19], 0 offen offset:256
    buffer_load_dwordx4 v[20:23], v3, s[16:19], 0 offen offset:384
    buffer_load_dwordx4 v[24:27], v3, s[16:19], 0 offen offset:512
    buffer_load_dwordx4 v[28:31], v3, s[16:19], 0 offen offset:640
    buffer_load_dwordx4 v[32:35], v3, s[16:19], 0 offen offset:768
    buffer_load_dwordx4 v[36:39], v3, s[16:19], 0 offen offset:896
    buffer_load_dwordx4 v[40:43], v3, s[16:19], 0 offen offset:1024
    v_lshrrev_b32 v4, 4, v1
    v_mul_u32_u24 v4, 18, v4
    v_lshrrev_b32 v5, 2, v2
    v_add_u32 v4, v4, v5
    v_lshlrev_b32 v4, 10, v4
    v_and_b32 v5, 1, v2
    v_lshlrev_b32 v5, 5, v5
    v_and_b32 v6, 15, v1
    v_add_u32 v5, v5, v6
    v_lshl_add_u32 v4, v5, 4, v4
    v_bfe_u32 v5, v2, 1, 1
    v_lshl_add_u32 v4, v5, 3, v4
    s_waitcnt vmcnt(0)

    v_lshlrev_b32 v48, 16, v8
    v_and_b32 v49, 0xffff0000, v8
    v_lshlrev_b32 v50, 16, v9
    v_and_b32 v51, 0xffff0000, v9
    v_lshlrev_b32 v52, 16, v10
    v_and_b32 v53, 0xffff0000, v10
    v_lshlrev_b32 v54, 16, v11
    v_and_b32 v55, 0xffff0000, v11
    v_lshlrev_b32 v56, 16, v12
    v_and_b32 v57, 0xffff0000, v12
    v_lshlrev_b32 v58, 16, v13
    v_and_b32 v59, 0xffff0000, v13
    v_lshlrev_b32 v60, 16, v14
    v_and_b32 v61, 0xffff0000, v14
    v_lshlrev_b32 v62, 16, v15
    v_and_b32 v63, 0xffff0000, v15
    v_lshlrev_b32 v64, 16, v16
    v_and_b32 v65, 0xffff0000, v16
    v_lshlrev_b32 v66, 16, v17
    v_and_b32 v67, 0xffff0000, v17
    v_lshlrev_b32 v68, 16, v18
    v_and_b32 v69, 0xffff0000, v18
    v_lshlrev_b32 v70, 16, v19
    v_and_b32 v71, 0xffff0000, v19
    v_lshlrev_b32 v72, 16, v20
    v_and_b32 v73, 0xffff0000, v20
    v_lshlrev_b32 v74, 16, v21
    v_and_b32 v75, 0xffff0000, v21
    v_lshlrev_b32 v76, 16, v22
    v_and_b32 v77, 0xffff0000, v22
    v_lshlrev_b32 v78, 16, v23
    v_and_b32 v79, 0xffff0000, v23
    v_lshlrev_b32 v80, 16, v24
    v_and_b32 v81, 0xffff0000, v24
    v_lshlrev_b32 v82, 16, v25
    v_and_b32 v83, 0xffff0000, v25
    v_lshlrev_b32 v84, 16, v26
    v_and_b32 v85, 0xffff0000, v26
    v_lshlrev_b32 v86, 16, v27
    v_and_b32 v87, 0xffff0000, v27
    v_lshlrev_b32 v88, 16, v28
    v_and_b32 v89, 0xffff0000, v28
    v_lshlrev_b32 v90, 16, v29
    v_and_b32 v91, 0xffff0000, v29
    v_lshlrev_b32 v92, 16, v30
    v_and_b32 v93, 0xffff0000, v30
    v_lshlrev_b32 v94, 16, v31
    v_and_b32 v95, 0xffff0000, v31
    v_lshlrev_b32 v96, 16, v32
    v_and_b32 v97, 0xffff0000, v32
    v_lshlrev_b32 v98, 16, v33
    v_and_b32 v99, 0xffff0000, v33
    v_lshlrev_b32 v100, 16, v34
    v_and_b32 v101, 0xffff0000, v34
    v_lshlrev_b32 v102, 16, v35
    v_and_b32 v103, 0xffff0000, v35
    v_lshlrev_b32 v104, 16, v36
    v_and_b32 v105, 0xffff0000, v36
    v_lshlrev_b32 v106, 16, v37
    v_and_b32 v107, 0xffff0000, v37
    v_lshlrev_b32 v108, 16, v38
    v_and_b32 v109, 0xffff0000, v38
    v_lshlrev_b32 v110, 16, v39
    v_and_b32 v111, 0xffff0000, v39
    v_lshlrev_b32 v112, 16, v40
    v_and_b32 v113, 0xffff0000, v40
    v_lshlrev_b32 v114, 16, v41
    v_and_b32 v115, 0xffff0000, v41
    v_lshlrev_b32 v116, 16, v42
    v_and_b32 v117, 0xffff0000, v42
    v_lshlrev_b32 v118, 16, v43
    v_and_b32 v119, 0xffff0000, v43
    v_add_f32 v120, v48, v52
    v_add_f32 v121, v49, v53
    v_add_f32 v122, v50, v54
    v_add_f32 v123, v51, v55
    v_add_f32 v120, v120, v56
    v_add_f32 v121, v121, v57
    v_add_f32 v122, v122, v58
    v_add_f32 v123, v123, v59
    v_add_f32 v120, v120, v60
    v_add_f32 v121, v121, v61
    v_add_f32 v122, v122, v62
    v_add_f32 v123, v123, v63
    v_add_f32 v120, v120, v64
    v_add_f32 v121, v121, v65
    v_add_f32 v122, v122, v66
    v_add_f32 v123, v123, v67
    v_add_f32 v120, v120, v68
    v_add_f32 v121, v121, v69
    v_add_f32 v122, v122, v70
    v_add_f32 v123, v123, v71
    v_add_f32 v120, v120, v72
    v_add_f32 v121, v121, v73
    v_add_f32 v122, v122, v74
    v_add_f32 v123, v123, v75
    v_add_f32 v120, v120, v76
    v_add_f32 v121, v121, v77
    v_add_f32 v122, v122, v78
    v_add_f32 v123, v123, v79
    v_add_f32 v120, v120, v80
    v_add_f32 v121, v121, v81
    v_add_f32 v122, v122, v82
    v_add_f32 v123, v123, v83
    v_add_f32 v120, v120, v84
    v_add_f32 v121, v121, v85
    v_add_f32 v122, v122, v86
    v_add_f32 v123, v123, v87
    v_add_f32 v120, v120, v88
    v_add_f32 v121, v121, v89
    v_add_f32 v122, v122, v90
    v_add_f32 v123, v123, v91
    v_add_f32 v120, v120, v92
    v_add_f32 v121, v121, v93
    v_add_f32 v122, v122, v94
    v_add_f32 v123, v123, v95
    v_add_f32 v120, v120, v96
    v_add_f32 v121, v121, v97
    v_add_f32 v122, v122, v98
    v_add_f32 v123, v123, v99
    v_add_f32 v120, v120, v100
    v_add_f32 v121, v121, v101
    v_add_f32 v122, v122, v102
    v_add_f32 v123, v123, v103
    v_add_f32 v120, v120, v104
    v_add_f32 v121, v121, v105
    v_add_f32 v122, v122, v106
    v_add_f32 v123, v123, v107
    v_add_f32 v120, v120, v108
    v_add_f32 v121, v121, v109
    v_add_f32 v122, v122, v110
    v_add_f32 v123, v123, v111
    v_add_f32 v120, v120, v112
    v_add_f32 v121, v121, v113
    v_add_f32 v122, v122, v114
    v_add_f32 v123, v123, v115
    v_add_f32 v120, v120, v116
    v_add_f32 v121, v121, v117
    v_add_f32 v122, v122, v118
    v_add_f32 v123, v123, v119
    v_add_f32 v120, v120, v121
    v_add_f32 v122, v122, v123
    v_add_f32 v120, v120, v122
    s_nop 1
    v_add_f32_dpp v121, v120, v120 quad_perm:[1,0,3,2] row_mask:0xf bank_mask:0xf
    s_nop 1
    v_add_f32_dpp v120, v121, v121 quad_perm:[2,3,0,1] row_mask:0xf bank_mask:0xf
    s_nop 1
    v_add_f32_dpp v121, v120, v120 row_half_mirror row_mask:0xf bank_mask:0xf
    s_mov_b32 s25, 0x3ae38e39
    v_mul_f32 v124, s25, v121

    v_sub_f32 v125, v48, v124
    v_mul_f32 v120, v125, v125
    v_sub_f32 v125, v49, v124
    v_mul_f32 v121, v125, v125
    v_sub_f32 v125, v50, v124
    v_mul_f32 v122, v125, v125
    v_sub_f32 v125, v51, v124
    v_mul_f32 v123, v125, v125
    v_sub_f32 v125, v52, v124
    v_fmac_f32 v120, v125, v125
    v_sub_f32 v125, v53, v124
    v_fmac_f32 v121, v125, v125
    v_sub_f32 v125, v54, v124
    v_fmac_f32 v122, v125, v125
    v_sub_f32 v125, v55, v124
    v_fmac_f32 v123, v125, v125
    v_sub_f32 v125, v56, v124
    v_fmac_f32 v120, v125, v125
    v_sub_f32 v125, v57, v124
    v_fmac_f32 v121, v125, v125
    v_sub_f32 v125, v58, v124
    v_fmac_f32 v122, v125, v125
    v_sub_f32 v125, v59, v124
    v_fmac_f32 v123, v125, v125
    v_sub_f32 v125, v60, v124
    v_fmac_f32 v120, v125, v125
    v_sub_f32 v125, v61, v124
    v_fmac_f32 v121, v125, v125
    v_sub_f32 v125, v62, v124
    v_fmac_f32 v122, v125, v125
    v_sub_f32 v125, v63, v124
    v_fmac_f32 v123, v125, v125
    v_sub_f32 v125, v64, v124
    v_fmac_f32 v120, v125, v125
    v_sub_f32 v125, v65, v124
    v_fmac_f32 v121, v125, v125
    v_sub_f32 v125, v66, v124
    v_fmac_f32 v122, v125, v125
    v_sub_f32 v125, v67, v124
    v_fmac_f32 v123, v125, v125
    v_sub_f32 v125, v68, v124
    v_fmac_f32 v120, v125, v125
    v_sub_f32 v125, v69, v124
    v_fmac_f32 v121, v125, v125
    v_sub_f32 v125, v70, v124
    v_fmac_f32 v122, v125, v125
    v_sub_f32 v125, v71, v124
    v_fmac_f32 v123, v125, v125
    v_sub_f32 v125, v72, v124
    v_fmac_f32 v120, v125, v125
    v_sub_f32 v125, v73, v124
    v_fmac_f32 v121, v125, v125
    v_sub_f32 v125, v74, v124
    v_fmac_f32 v122, v125, v125
    v_sub_f32 v125, v75, v124
    v_fmac_f32 v123, v125, v125
    v_sub_f32 v125, v76, v124
    v_fmac_f32 v120, v125, v125
    v_sub_f32 v125, v77, v124
    v_fmac_f32 v121, v125, v125
    v_sub_f32 v125, v78, v124
    v_fmac_f32 v122, v125, v125
    v_sub_f32 v125, v79, v124
    v_fmac_f32 v123, v125, v125
    v_sub_f32 v125, v80, v124
    v_fmac_f32 v120, v125, v125
    v_sub_f32 v125, v81, v124
    v_fmac_f32 v121, v125, v125
    v_sub_f32 v125, v82, v124
    v_fmac_f32 v122, v125, v125
    v_sub_f32 v125, v83, v124
    v_fmac_f32 v123, v125, v125
    v_sub_f32 v125, v84, v124
    v_fmac_f32 v120, v125, v125
    v_sub_f32 v125, v85, v124
    v_fmac_f32 v121, v125, v125
    v_sub_f32 v125, v86, v124
    v_fmac_f32 v122, v125, v125
    v_sub_f32 v125, v87, v124
    v_fmac_f32 v123, v125, v125
    v_sub_f32 v125, v88, v124
    v_fmac_f32 v120, v125, v125
    v_sub_f32 v125, v89, v124
    v_fmac_f32 v121, v125, v125
    v_sub_f32 v125, v90, v124
    v_fmac_f32 v122, v125, v125
    v_sub_f32 v125, v91, v124
    v_fmac_f32 v123, v125, v125
    v_sub_f32 v125, v92, v124
    v_fmac_f32 v120, v125, v125
    v_sub_f32 v125, v93, v124
    v_fmac_f32 v121, v125, v125
    v_sub_f32 v125, v94, v124
    v_fmac_f32 v122, v125, v125
    v_sub_f32 v125, v95, v124
    v_fmac_f32 v123, v125, v125
    v_sub_f32 v125, v96, v124
    v_fmac_f32 v120, v125, v125
    v_sub_f32 v125, v97, v124
    v_fmac_f32 v121, v125, v125
    v_sub_f32 v125, v98, v124
    v_fmac_f32 v122, v125, v125
    v_sub_f32 v125, v99, v124
    v_fmac_f32 v123, v125, v125
    v_sub_f32 v125, v100, v124
    v_fmac_f32 v120, v125, v125
    v_sub_f32 v125, v101, v124
    v_fmac_f32 v121, v125, v125
    v_sub_f32 v125, v102, v124
    v_fmac_f32 v122, v125, v125
    v_sub_f32 v125, v103, v124
    v_fmac_f32 v123, v125, v125
    v_sub_f32 v125, v104, v124
    v_fmac_f32 v120, v125, v125
    v_sub_f32 v125, v105, v124
    v_fmac_f32 v121, v125, v125
    v_sub_f32 v125, v106, v124
    v_fmac_f32 v122, v125, v125
    v_sub_f32 v125, v107, v124
    v_fmac_f32 v123, v125, v125
    v_sub_f32 v125, v108, v124
    v_fmac_f32 v120, v125, v125
    v_sub_f32 v125, v109, v124
    v_fmac_f32 v121, v125, v125
    v_sub_f32 v125, v110, v124
    v_fmac_f32 v122, v125, v125
    v_sub_f32 v125, v111, v124
    v_fmac_f32 v123, v125, v125
    v_sub_f32 v125, v112, v124
    v_fmac_f32 v120, v125, v125
    v_sub_f32 v125, v113, v124
    v_fmac_f32 v121, v125, v125
    v_sub_f32 v125, v114, v124
    v_fmac_f32 v122, v125, v125
    v_sub_f32 v125, v115, v124
    v_fmac_f32 v123, v125, v125
    v_sub_f32 v125, v116, v124
    v_fmac_f32 v120, v125, v125
    v_sub_f32 v125, v117, v124
    v_fmac_f32 v121, v125, v125
    v_sub_f32 v125, v118, v124
    v_fmac_f32 v122, v125, v125
    v_sub_f32 v125, v119, v124
    v_fmac_f32 v123, v125, v125
    v_add_f32 v120, v120, v121
    v_add_f32 v122, v122, v123
    v_add_f32 v120, v120, v122
    s_nop 1
    v_add_f32_dpp v121, v120, v120 quad_perm:[1,0,3,2] row_mask:0xf bank_mask:0xf
    s_nop 1
    v_add_f32_dpp v120, v121, v121 quad_perm:[2,3,0,1] row_mask:0xf bank_mask:0xf
    s_nop 1
    v_add_f32_dpp v121, v120, v120 row_half_mirror row_mask:0xf bank_mask:0xf
    v_mul_f32 v125, s25, v121
    v_cvt_pk_bf16_f32 v126, v124, v125
    v_lshlrev_b32 v124, 16, v126
    v_and_b32 v125, 0xffff0000, v126
    s_mov_b32 s26, 0x3727c5ac
    v_add_f32 v125, s26, v125
    v_cvt_pk_bf16_f32 v125, v125, v125
    v_lshlrev_b32 v125, 16, v125
    v_sqrt_f32 v125, v125
    s_nop 0
    v_cvt_pk_bf16_f32 v125, v125, v125
    v_lshlrev_b32 v125, 16, v125
    v_rcp_f32 v126, v125
    s_nop 0

    v_sub_f32 v48, v48, v124
    v_sub_f32 v49, v49, v124
    v_cvt_pk_bf16_f32 v127, v48, v49
    v_lshlrev_b32 v48, 16, v127
    v_and_b32 v49, 0xffff0000, v127
    v_mul_f32 v120, v48, v126
    v_mul_f32 v121, v49, v126
    v_fma_f32 v122, -v120, v125, v48
    v_fma_f32 v123, -v121, v125, v49
    v_fmac_f32 v120, v122, v126
    v_fmac_f32 v121, v123, v126
    v_cvt_pk_bf16_f32 v8, v120, v121

    v_sub_f32 v50, v50, v124
    v_sub_f32 v51, v51, v124
    v_cvt_pk_bf16_f32 v127, v50, v51
    v_lshlrev_b32 v50, 16, v127
    v_and_b32 v51, 0xffff0000, v127
    v_mul_f32 v120, v50, v126
    v_mul_f32 v121, v51, v126
    v_fma_f32 v122, -v120, v125, v50
    v_fma_f32 v123, -v121, v125, v51
    v_fmac_f32 v120, v122, v126
    v_fmac_f32 v121, v123, v126
    v_cvt_pk_bf16_f32 v9, v120, v121

    v_sub_f32 v52, v52, v124
    v_sub_f32 v53, v53, v124
    v_cvt_pk_bf16_f32 v127, v52, v53
    v_lshlrev_b32 v52, 16, v127
    v_and_b32 v53, 0xffff0000, v127
    v_mul_f32 v120, v52, v126
    v_mul_f32 v121, v53, v126
    v_fma_f32 v122, -v120, v125, v52
    v_fma_f32 v123, -v121, v125, v53
    v_fmac_f32 v120, v122, v126
    v_fmac_f32 v121, v123, v126
    v_cvt_pk_bf16_f32 v10, v120, v121

    v_sub_f32 v54, v54, v124
    v_sub_f32 v55, v55, v124
    v_cvt_pk_bf16_f32 v127, v54, v55
    v_lshlrev_b32 v54, 16, v127
    v_and_b32 v55, 0xffff0000, v127
    v_mul_f32 v120, v54, v126
    v_mul_f32 v121, v55, v126
    v_fma_f32 v122, -v120, v125, v54
    v_fma_f32 v123, -v121, v125, v55
    v_fmac_f32 v120, v122, v126
    v_fmac_f32 v121, v123, v126
    v_cvt_pk_bf16_f32 v11, v120, v121

    v_sub_f32 v56, v56, v124
    v_sub_f32 v57, v57, v124
    v_cvt_pk_bf16_f32 v127, v56, v57
    v_lshlrev_b32 v56, 16, v127
    v_and_b32 v57, 0xffff0000, v127
    v_mul_f32 v120, v56, v126
    v_mul_f32 v121, v57, v126
    v_fma_f32 v122, -v120, v125, v56
    v_fma_f32 v123, -v121, v125, v57
    v_fmac_f32 v120, v122, v126
    v_fmac_f32 v121, v123, v126
    v_cvt_pk_bf16_f32 v12, v120, v121

    v_sub_f32 v58, v58, v124
    v_sub_f32 v59, v59, v124
    v_cvt_pk_bf16_f32 v127, v58, v59
    v_lshlrev_b32 v58, 16, v127
    v_and_b32 v59, 0xffff0000, v127
    v_mul_f32 v120, v58, v126
    v_mul_f32 v121, v59, v126
    v_fma_f32 v122, -v120, v125, v58
    v_fma_f32 v123, -v121, v125, v59
    v_fmac_f32 v120, v122, v126
    v_fmac_f32 v121, v123, v126
    v_cvt_pk_bf16_f32 v13, v120, v121

    v_sub_f32 v60, v60, v124
    v_sub_f32 v61, v61, v124
    v_cvt_pk_bf16_f32 v127, v60, v61
    v_lshlrev_b32 v60, 16, v127
    v_and_b32 v61, 0xffff0000, v127
    v_mul_f32 v120, v60, v126
    v_mul_f32 v121, v61, v126
    v_fma_f32 v122, -v120, v125, v60
    v_fma_f32 v123, -v121, v125, v61
    v_fmac_f32 v120, v122, v126
    v_fmac_f32 v121, v123, v126
    v_cvt_pk_bf16_f32 v14, v120, v121

    v_sub_f32 v62, v62, v124
    v_sub_f32 v63, v63, v124
    v_cvt_pk_bf16_f32 v127, v62, v63
    v_lshlrev_b32 v62, 16, v127
    v_and_b32 v63, 0xffff0000, v127
    v_mul_f32 v120, v62, v126
    v_mul_f32 v121, v63, v126
    v_fma_f32 v122, -v120, v125, v62
    v_fma_f32 v123, -v121, v125, v63
    v_fmac_f32 v120, v122, v126
    v_fmac_f32 v121, v123, v126
    v_cvt_pk_bf16_f32 v15, v120, v121

    v_sub_f32 v64, v64, v124
    v_sub_f32 v65, v65, v124
    v_cvt_pk_bf16_f32 v127, v64, v65
    v_lshlrev_b32 v64, 16, v127
    v_and_b32 v65, 0xffff0000, v127
    v_mul_f32 v120, v64, v126
    v_mul_f32 v121, v65, v126
    v_fma_f32 v122, -v120, v125, v64
    v_fma_f32 v123, -v121, v125, v65
    v_fmac_f32 v120, v122, v126
    v_fmac_f32 v121, v123, v126
    v_cvt_pk_bf16_f32 v16, v120, v121

    v_sub_f32 v66, v66, v124
    v_sub_f32 v67, v67, v124
    v_cvt_pk_bf16_f32 v127, v66, v67
    v_lshlrev_b32 v66, 16, v127
    v_and_b32 v67, 0xffff0000, v127
    v_mul_f32 v120, v66, v126
    v_mul_f32 v121, v67, v126
    v_fma_f32 v122, -v120, v125, v66
    v_fma_f32 v123, -v121, v125, v67
    v_fmac_f32 v120, v122, v126
    v_fmac_f32 v121, v123, v126
    v_cvt_pk_bf16_f32 v17, v120, v121

    v_sub_f32 v68, v68, v124
    v_sub_f32 v69, v69, v124
    v_cvt_pk_bf16_f32 v127, v68, v69
    v_lshlrev_b32 v68, 16, v127
    v_and_b32 v69, 0xffff0000, v127
    v_mul_f32 v120, v68, v126
    v_mul_f32 v121, v69, v126
    v_fma_f32 v122, -v120, v125, v68
    v_fma_f32 v123, -v121, v125, v69
    v_fmac_f32 v120, v122, v126
    v_fmac_f32 v121, v123, v126
    v_cvt_pk_bf16_f32 v18, v120, v121

    v_sub_f32 v70, v70, v124
    v_sub_f32 v71, v71, v124
    v_cvt_pk_bf16_f32 v127, v70, v71
    v_lshlrev_b32 v70, 16, v127
    v_and_b32 v71, 0xffff0000, v127
    v_mul_f32 v120, v70, v126
    v_mul_f32 v121, v71, v126
    v_fma_f32 v122, -v120, v125, v70
    v_fma_f32 v123, -v121, v125, v71
    v_fmac_f32 v120, v122, v126
    v_fmac_f32 v121, v123, v126
    v_cvt_pk_bf16_f32 v19, v120, v121

    v_sub_f32 v72, v72, v124
    v_sub_f32 v73, v73, v124
    v_cvt_pk_bf16_f32 v127, v72, v73
    v_lshlrev_b32 v72, 16, v127
    v_and_b32 v73, 0xffff0000, v127
    v_mul_f32 v120, v72, v126
    v_mul_f32 v121, v73, v126
    v_fma_f32 v122, -v120, v125, v72
    v_fma_f32 v123, -v121, v125, v73
    v_fmac_f32 v120, v122, v126
    v_fmac_f32 v121, v123, v126
    v_cvt_pk_bf16_f32 v20, v120, v121

    v_sub_f32 v74, v74, v124
    v_sub_f32 v75, v75, v124
    v_cvt_pk_bf16_f32 v127, v74, v75
    v_lshlrev_b32 v74, 16, v127
    v_and_b32 v75, 0xffff0000, v127
    v_mul_f32 v120, v74, v126
    v_mul_f32 v121, v75, v126
    v_fma_f32 v122, -v120, v125, v74
    v_fma_f32 v123, -v121, v125, v75
    v_fmac_f32 v120, v122, v126
    v_fmac_f32 v121, v123, v126
    v_cvt_pk_bf16_f32 v21, v120, v121

    v_sub_f32 v76, v76, v124
    v_sub_f32 v77, v77, v124
    v_cvt_pk_bf16_f32 v127, v76, v77
    v_lshlrev_b32 v76, 16, v127
    v_and_b32 v77, 0xffff0000, v127
    v_mul_f32 v120, v76, v126
    v_mul_f32 v121, v77, v126
    v_fma_f32 v122, -v120, v125, v76
    v_fma_f32 v123, -v121, v125, v77
    v_fmac_f32 v120, v122, v126
    v_fmac_f32 v121, v123, v126
    v_cvt_pk_bf16_f32 v22, v120, v121

    v_sub_f32 v78, v78, v124
    v_sub_f32 v79, v79, v124
    v_cvt_pk_bf16_f32 v127, v78, v79
    v_lshlrev_b32 v78, 16, v127
    v_and_b32 v79, 0xffff0000, v127
    v_mul_f32 v120, v78, v126
    v_mul_f32 v121, v79, v126
    v_fma_f32 v122, -v120, v125, v78
    v_fma_f32 v123, -v121, v125, v79
    v_fmac_f32 v120, v122, v126
    v_fmac_f32 v121, v123, v126
    v_cvt_pk_bf16_f32 v23, v120, v121

    v_sub_f32 v80, v80, v124
    v_sub_f32 v81, v81, v124
    v_cvt_pk_bf16_f32 v127, v80, v81
    v_lshlrev_b32 v80, 16, v127
    v_and_b32 v81, 0xffff0000, v127
    v_mul_f32 v120, v80, v126
    v_mul_f32 v121, v81, v126
    v_fma_f32 v122, -v120, v125, v80
    v_fma_f32 v123, -v121, v125, v81
    v_fmac_f32 v120, v122, v126
    v_fmac_f32 v121, v123, v126
    v_cvt_pk_bf16_f32 v24, v120, v121

    v_sub_f32 v82, v82, v124
    v_sub_f32 v83, v83, v124
    v_cvt_pk_bf16_f32 v127, v82, v83
    v_lshlrev_b32 v82, 16, v127
    v_and_b32 v83, 0xffff0000, v127
    v_mul_f32 v120, v82, v126
    v_mul_f32 v121, v83, v126
    v_fma_f32 v122, -v120, v125, v82
    v_fma_f32 v123, -v121, v125, v83
    v_fmac_f32 v120, v122, v126
    v_fmac_f32 v121, v123, v126
    v_cvt_pk_bf16_f32 v25, v120, v121

    v_sub_f32 v84, v84, v124
    v_sub_f32 v85, v85, v124
    v_cvt_pk_bf16_f32 v127, v84, v85
    v_lshlrev_b32 v84, 16, v127
    v_and_b32 v85, 0xffff0000, v127
    v_mul_f32 v120, v84, v126
    v_mul_f32 v121, v85, v126
    v_fma_f32 v122, -v120, v125, v84
    v_fma_f32 v123, -v121, v125, v85
    v_fmac_f32 v120, v122, v126
    v_fmac_f32 v121, v123, v126
    v_cvt_pk_bf16_f32 v26, v120, v121

    v_sub_f32 v86, v86, v124
    v_sub_f32 v87, v87, v124
    v_cvt_pk_bf16_f32 v127, v86, v87
    v_lshlrev_b32 v86, 16, v127
    v_and_b32 v87, 0xffff0000, v127
    v_mul_f32 v120, v86, v126
    v_mul_f32 v121, v87, v126
    v_fma_f32 v122, -v120, v125, v86
    v_fma_f32 v123, -v121, v125, v87
    v_fmac_f32 v120, v122, v126
    v_fmac_f32 v121, v123, v126
    v_cvt_pk_bf16_f32 v27, v120, v121

    v_sub_f32 v88, v88, v124
    v_sub_f32 v89, v89, v124
    v_cvt_pk_bf16_f32 v127, v88, v89
    v_lshlrev_b32 v88, 16, v127
    v_and_b32 v89, 0xffff0000, v127
    v_mul_f32 v120, v88, v126
    v_mul_f32 v121, v89, v126
    v_fma_f32 v122, -v120, v125, v88
    v_fma_f32 v123, -v121, v125, v89
    v_fmac_f32 v120, v122, v126
    v_fmac_f32 v121, v123, v126
    v_cvt_pk_bf16_f32 v28, v120, v121

    v_sub_f32 v90, v90, v124
    v_sub_f32 v91, v91, v124
    v_cvt_pk_bf16_f32 v127, v90, v91
    v_lshlrev_b32 v90, 16, v127
    v_and_b32 v91, 0xffff0000, v127
    v_mul_f32 v120, v90, v126
    v_mul_f32 v121, v91, v126
    v_fma_f32 v122, -v120, v125, v90
    v_fma_f32 v123, -v121, v125, v91
    v_fmac_f32 v120, v122, v126
    v_fmac_f32 v121, v123, v126
    v_cvt_pk_bf16_f32 v29, v120, v121

    v_sub_f32 v92, v92, v124
    v_sub_f32 v93, v93, v124
    v_cvt_pk_bf16_f32 v127, v92, v93
    v_lshlrev_b32 v92, 16, v127
    v_and_b32 v93, 0xffff0000, v127
    v_mul_f32 v120, v92, v126
    v_mul_f32 v121, v93, v126
    v_fma_f32 v122, -v120, v125, v92
    v_fma_f32 v123, -v121, v125, v93
    v_fmac_f32 v120, v122, v126
    v_fmac_f32 v121, v123, v126
    v_cvt_pk_bf16_f32 v30, v120, v121

    v_sub_f32 v94, v94, v124
    v_sub_f32 v95, v95, v124
    v_cvt_pk_bf16_f32 v127, v94, v95
    v_lshlrev_b32 v94, 16, v127
    v_and_b32 v95, 0xffff0000, v127
    v_mul_f32 v120, v94, v126
    v_mul_f32 v121, v95, v126
    v_fma_f32 v122, -v120, v125, v94
    v_fma_f32 v123, -v121, v125, v95
    v_fmac_f32 v120, v122, v126
    v_fmac_f32 v121, v123, v126
    v_cvt_pk_bf16_f32 v31, v120, v121

    v_sub_f32 v96, v96, v124
    v_sub_f32 v97, v97, v124
    v_cvt_pk_bf16_f32 v127, v96, v97
    v_lshlrev_b32 v96, 16, v127
    v_and_b32 v97, 0xffff0000, v127
    v_mul_f32 v120, v96, v126
    v_mul_f32 v121, v97, v126
    v_fma_f32 v122, -v120, v125, v96
    v_fma_f32 v123, -v121, v125, v97
    v_fmac_f32 v120, v122, v126
    v_fmac_f32 v121, v123, v126
    v_cvt_pk_bf16_f32 v32, v120, v121

    v_sub_f32 v98, v98, v124
    v_sub_f32 v99, v99, v124
    v_cvt_pk_bf16_f32 v127, v98, v99
    v_lshlrev_b32 v98, 16, v127
    v_and_b32 v99, 0xffff0000, v127
    v_mul_f32 v120, v98, v126
    v_mul_f32 v121, v99, v126
    v_fma_f32 v122, -v120, v125, v98
    v_fma_f32 v123, -v121, v125, v99
    v_fmac_f32 v120, v122, v126
    v_fmac_f32 v121, v123, v126
    v_cvt_pk_bf16_f32 v33, v120, v121

    v_sub_f32 v100, v100, v124
    v_sub_f32 v101, v101, v124
    v_cvt_pk_bf16_f32 v127, v100, v101
    v_lshlrev_b32 v100, 16, v127
    v_and_b32 v101, 0xffff0000, v127
    v_mul_f32 v120, v100, v126
    v_mul_f32 v121, v101, v126
    v_fma_f32 v122, -v120, v125, v100
    v_fma_f32 v123, -v121, v125, v101
    v_fmac_f32 v120, v122, v126
    v_fmac_f32 v121, v123, v126
    v_cvt_pk_bf16_f32 v34, v120, v121

    v_sub_f32 v102, v102, v124
    v_sub_f32 v103, v103, v124
    v_cvt_pk_bf16_f32 v127, v102, v103
    v_lshlrev_b32 v102, 16, v127
    v_and_b32 v103, 0xffff0000, v127
    v_mul_f32 v120, v102, v126
    v_mul_f32 v121, v103, v126
    v_fma_f32 v122, -v120, v125, v102
    v_fma_f32 v123, -v121, v125, v103
    v_fmac_f32 v120, v122, v126
    v_fmac_f32 v121, v123, v126
    v_cvt_pk_bf16_f32 v35, v120, v121

    v_sub_f32 v104, v104, v124
    v_sub_f32 v105, v105, v124
    v_cvt_pk_bf16_f32 v127, v104, v105
    v_lshlrev_b32 v104, 16, v127
    v_and_b32 v105, 0xffff0000, v127
    v_mul_f32 v120, v104, v126
    v_mul_f32 v121, v105, v126
    v_fma_f32 v122, -v120, v125, v104
    v_fma_f32 v123, -v121, v125, v105
    v_fmac_f32 v120, v122, v126
    v_fmac_f32 v121, v123, v126
    v_cvt_pk_bf16_f32 v36, v120, v121

    v_sub_f32 v106, v106, v124
    v_sub_f32 v107, v107, v124
    v_cvt_pk_bf16_f32 v127, v106, v107
    v_lshlrev_b32 v106, 16, v127
    v_and_b32 v107, 0xffff0000, v127
    v_mul_f32 v120, v106, v126
    v_mul_f32 v121, v107, v126
    v_fma_f32 v122, -v120, v125, v106
    v_fma_f32 v123, -v121, v125, v107
    v_fmac_f32 v120, v122, v126
    v_fmac_f32 v121, v123, v126
    v_cvt_pk_bf16_f32 v37, v120, v121

    v_sub_f32 v108, v108, v124
    v_sub_f32 v109, v109, v124
    v_cvt_pk_bf16_f32 v127, v108, v109
    v_lshlrev_b32 v108, 16, v127
    v_and_b32 v109, 0xffff0000, v127
    v_mul_f32 v120, v108, v126
    v_mul_f32 v121, v109, v126
    v_fma_f32 v122, -v120, v125, v108
    v_fma_f32 v123, -v121, v125, v109
    v_fmac_f32 v120, v122, v126
    v_fmac_f32 v121, v123, v126
    v_cvt_pk_bf16_f32 v38, v120, v121

    v_sub_f32 v110, v110, v124
    v_sub_f32 v111, v111, v124
    v_cvt_pk_bf16_f32 v127, v110, v111
    v_lshlrev_b32 v110, 16, v127
    v_and_b32 v111, 0xffff0000, v127
    v_mul_f32 v120, v110, v126
    v_mul_f32 v121, v111, v126
    v_fma_f32 v122, -v120, v125, v110
    v_fma_f32 v123, -v121, v125, v111
    v_fmac_f32 v120, v122, v126
    v_fmac_f32 v121, v123, v126
    v_cvt_pk_bf16_f32 v39, v120, v121

    v_sub_f32 v112, v112, v124
    v_sub_f32 v113, v113, v124
    v_cvt_pk_bf16_f32 v127, v112, v113
    v_lshlrev_b32 v112, 16, v127
    v_and_b32 v113, 0xffff0000, v127
    v_mul_f32 v120, v112, v126
    v_mul_f32 v121, v113, v126
    v_fma_f32 v122, -v120, v125, v112
    v_fma_f32 v123, -v121, v125, v113
    v_fmac_f32 v120, v122, v126
    v_fmac_f32 v121, v123, v126
    v_cvt_pk_bf16_f32 v40, v120, v121

    v_sub_f32 v114, v114, v124
    v_sub_f32 v115, v115, v124
    v_cvt_pk_bf16_f32 v127, v114, v115
    v_lshlrev_b32 v114, 16, v127
    v_and_b32 v115, 0xffff0000, v127
    v_mul_f32 v120, v114, v126
    v_mul_f32 v121, v115, v126
    v_fma_f32 v122, -v120, v125, v114
    v_fma_f32 v123, -v121, v125, v115
    v_fmac_f32 v120, v122, v126
    v_fmac_f32 v121, v123, v126
    v_cvt_pk_bf16_f32 v41, v120, v121

    v_sub_f32 v116, v116, v124
    v_sub_f32 v117, v117, v124
    v_cvt_pk_bf16_f32 v127, v116, v117
    v_lshlrev_b32 v116, 16, v127
    v_and_b32 v117, 0xffff0000, v127
    v_mul_f32 v120, v116, v126
    v_mul_f32 v121, v117, v126
    v_fma_f32 v122, -v120, v125, v116
    v_fma_f32 v123, -v121, v125, v117
    v_fmac_f32 v120, v122, v126
    v_fmac_f32 v121, v123, v126
    v_cvt_pk_bf16_f32 v42, v120, v121

    v_sub_f32 v118, v118, v124
    v_sub_f32 v119, v119, v124
    v_cvt_pk_bf16_f32 v127, v118, v119
    v_lshlrev_b32 v118, 16, v127
    v_and_b32 v119, 0xffff0000, v127
    v_mul_f32 v120, v118, v126
    v_mul_f32 v121, v119, v126
    v_fma_f32 v122, -v120, v125, v118
    v_fma_f32 v123, -v121, v125, v119
    v_fmac_f32 v120, v122, v126
    v_fmac_f32 v121, v123, v126
    v_cvt_pk_bf16_f32 v43, v120, v121

    s_movk_i32 s27, 0
    buffer_store_dwordx2 v[8:9], v4, s[20:23], s27 offen
    buffer_store_dwordx2 v[10:11], v4, s[20:23], s27 offen offset:256
    s_movk_i32 s27, 2048
    buffer_store_dwordx2 v[12:13], v4, s[20:23], s27 offen
    buffer_store_dwordx2 v[14:15], v4, s[20:23], s27 offen offset:256
    s_movk_i32 s27, 4096
    buffer_store_dwordx2 v[16:17], v4, s[20:23], s27 offen
    buffer_store_dwordx2 v[18:19], v4, s[20:23], s27 offen offset:256
    s_movk_i32 s27, 6144
    buffer_store_dwordx2 v[20:21], v4, s[20:23], s27 offen
    buffer_store_dwordx2 v[22:23], v4, s[20:23], s27 offen offset:256
    s_movk_i32 s27, 8192
    buffer_store_dwordx2 v[24:25], v4, s[20:23], s27 offen
    buffer_store_dwordx2 v[26:27], v4, s[20:23], s27 offen offset:256
    s_movk_i32 s27, 10240
    buffer_store_dwordx2 v[28:29], v4, s[20:23], s27 offen
    buffer_store_dwordx2 v[30:31], v4, s[20:23], s27 offen offset:256
    s_movk_i32 s27, 12288
    buffer_store_dwordx2 v[32:33], v4, s[20:23], s27 offen
    buffer_store_dwordx2 v[34:35], v4, s[20:23], s27 offen offset:256
    s_movk_i32 s27, 14336
    buffer_store_dwordx2 v[36:37], v4, s[20:23], s27 offen
    buffer_store_dwordx2 v[38:39], v4, s[20:23], s27 offen offset:256
    s_movk_i32 s27, 16384
    buffer_store_dwordx2 v[40:41], v4, s[20:23], s27 offen
    buffer_store_dwordx2 v[42:43], v4, s[20:23], s27 offen offset:256
    s_endpgm
prep_kv:
    s_mov_b32 s16, s6
    s_mov_b32 s17, s7
    s_mov_b32 s18, 2359296
    s_mov_b32 s19, 0x00020000
    s_mov_b32 s20, s8
    s_mov_b32 s21, s9
    s_mov_b32 s22, 2359296
    s_mov_b32 s23, 0x00020000
    s_mov_b32 s24, s10
    s_mov_b32 s25, s11
    s_mov_b32 s26, 4608
    s_mov_b32 s27, 0x00020000
    s_add_u32 s28, s12, 2359296
    s_addc_u32 s29, s13, 0
    s_mov_b32 s30, 2359296
    s_mov_b32 s31, 0x00020000
    v_lshrrev_b32 v1, 6, v0
    s_nop 0
    v_readfirstlane_b32 s32, v1
    s_sub_u32 s33, s2, 64
    s_lshl_b32 s33, s33, 2
    s_add_u32 s33, s33, s32
    s_mov_b32 s34, 0x1c71c71d
    s_mul_hi_u32 s35, s33, s34
    s_mul_i32 s36, s35, 9
    s_sub_u32 s36, s33, s36
    v_and_b32 v1, 63, v0
    v_and_b32 v2, 7, v1
    v_lshrrev_b32 v3, 3, v1
    s_lshl_b32 s37, s35, 5
    v_lshl_add_u32 v3, v3, 2, s37
    s_lshl_b32 s38, s36, 7
    v_lshl_add_u32 v4, v2, 4, s38
    s_movk_i32 s39, 1152
    v_mul_lo_u32 v5, v3, s39
    v_add_u32 v5, v5, v4
    v_subrev_u32 v6, 3456, v5

    buffer_load_dwordx4 v[16:19], v6, s[16:19], 0 offen
    buffer_load_dwordx4 v[20:23], v6, s[16:19], 0 offen offset:1152
    buffer_load_dwordx4 v[24:27], v6, s[16:19], 0 offen offset:2304
    buffer_load_dwordx4 v[28:31], v5, s[16:19], 0 offen offset:0
    buffer_load_dwordx4 v[32:35], v5, s[16:19], 0 offen offset:1152
    buffer_load_dwordx4 v[36:39], v5, s[16:19], 0 offen offset:2304
    buffer_load_dwordx4 v[40:43], v5, s[16:19], 0 offen offset:3456
    buffer_load_dwordx4 v[44:47], v5, s[20:23], 0 offen offset:0
    buffer_load_dwordx4 v[48:51], v5, s[20:23], 0 offen offset:1152
    buffer_load_dwordx4 v[52:55], v5, s[20:23], 0 offen offset:2304
    buffer_load_dwordx4 v[56:59], v5, s[20:23], 0 offen offset:3456
    v_lshlrev_b32 v7, 2, v4
    buffer_load_dwordx4 v[60:63], v7, s[24:27], 0 offen offset:0
    buffer_load_dwordx4 v[64:67], v7, s[24:27], 0 offen offset:16
    buffer_load_dwordx4 v[68:71], v7, s[24:27], 0 offen offset:32
    buffer_load_dwordx4 v[72:75], v7, s[24:27], 0 offen offset:48
    v_lshlrev_b32 v8, 11, v4
    v_and_b32 v9, 0xfffffff8, v3
    v_lshl_add_u32 v8, v9, 1, v8
    v_and_b32 v9, 4, v3
    v_lshlrev_b32 v9, 1, v9
    v_sub_u32 v9, 8, v9
    v_add_u32 v8, v8, v9
    s_waitcnt vmcnt(0)

    v_lshlrev_b32 v80, 16, v16
    v_and_b32 v81, 0xffff0000, v16
    v_lshlrev_b32 v82, 16, v20
    v_and_b32 v83, 0xffff0000, v20
    v_lshlrev_b32 v84, 16, v24
    v_and_b32 v85, 0xffff0000, v24
    v_lshlrev_b32 v86, 16, v28
    v_and_b32 v87, 0xffff0000, v28
    v_lshlrev_b32 v88, 16, v32
    v_and_b32 v89, 0xffff0000, v32
    v_lshlrev_b32 v90, 16, v36
    v_and_b32 v91, 0xffff0000, v36
    v_lshlrev_b32 v92, 16, v40
    v_and_b32 v93, 0xffff0000, v40
    v_lshlrev_b32 v104, 16, v44
    v_and_b32 v105, 0xffff0000, v44
    v_lshlrev_b32 v106, 16, v48
    v_and_b32 v107, 0xffff0000, v48
    v_lshlrev_b32 v108, 16, v52
    v_and_b32 v109, 0xffff0000, v52
    v_lshlrev_b32 v110, 16, v56
    v_and_b32 v111, 0xffff0000, v56
    v_lshlrev_b32 v96, 16, v60
    v_and_b32 v97, 0xffff0000, v60
    v_lshlrev_b32 v98, 16, v61
    v_and_b32 v99, 0xffff0000, v61
    v_lshlrev_b32 v100, 16, v62
    v_and_b32 v101, 0xffff0000, v62
    v_lshlrev_b32 v102, 16, v63
    v_and_b32 v103, 0xffff0000, v63
    v_mul_f32 v120, v80, v99
    v_mul_f32 v121, v81, v103
    v_cvt_pk_bf16_f32 v122, v120, v121
    v_lshlrev_b32 v112, 16, v122
    v_and_b32 v113, 0xffff0000, v122
    v_mul_f32 v120, v82, v98
    v_mul_f32 v121, v83, v102
    v_cvt_pk_bf16_f32 v122, v120, v121
    v_lshlrev_b32 v120, 16, v122
    v_and_b32 v121, 0xffff0000, v122
    v_add_f32 v120, v112, v120
    v_add_f32 v121, v113, v121
    v_cvt_pk_bf16_f32 v122, v120, v121
    v_lshlrev_b32 v112, 16, v122
    v_and_b32 v113, 0xffff0000, v122
    v_mul_f32 v120, v84, v97
    v_mul_f32 v121, v85, v101
    v_cvt_pk_bf16_f32 v122, v120, v121
    v_lshlrev_b32 v120, 16, v122
    v_and_b32 v121, 0xffff0000, v122
    v_add_f32 v120, v112, v120
    v_add_f32 v121, v113, v121
    v_cvt_pk_bf16_f32 v122, v120, v121
    v_lshlrev_b32 v112, 16, v122
    v_and_b32 v113, 0xffff0000, v122
    v_mul_f32 v120, v86, v96
    v_mul_f32 v121, v87, v100
    v_cvt_pk_bf16_f32 v122, v120, v121
    v_lshlrev_b32 v120, 16, v122
    v_and_b32 v121, 0xffff0000, v122
    v_add_f32 v120, v112, v120
    v_add_f32 v121, v113, v121
    v_cvt_pk_bf16_f32 v122, v120, v121
    v_lshlrev_b32 v112, 16, v122
    v_and_b32 v113, 0xffff0000, v122
    v_mul_f32 v112, v112, v104
    v_mul_f32 v113, v113, v105
    v_mul_f32 v120, v82, v99
    v_mul_f32 v121, v83, v103
    v_cvt_pk_bf16_f32 v122, v120, v121
    v_lshlrev_b32 v114, 16, v122
    v_and_b32 v115, 0xffff0000, v122
    v_mul_f32 v120, v84, v98
    v_mul_f32 v121, v85, v102
    v_cvt_pk_bf16_f32 v122, v120, v121
    v_lshlrev_b32 v120, 16, v122
    v_and_b32 v121, 0xffff0000, v122
    v_add_f32 v120, v114, v120
    v_add_f32 v121, v115, v121
    v_cvt_pk_bf16_f32 v122, v120, v121
    v_lshlrev_b32 v114, 16, v122
    v_and_b32 v115, 0xffff0000, v122
    v_mul_f32 v120, v86, v97
    v_mul_f32 v121, v87, v101
    v_cvt_pk_bf16_f32 v122, v120, v121
    v_lshlrev_b32 v120, 16, v122
    v_and_b32 v121, 0xffff0000, v122
    v_add_f32 v120, v114, v120
    v_add_f32 v121, v115, v121
    v_cvt_pk_bf16_f32 v122, v120, v121
    v_lshlrev_b32 v114, 16, v122
    v_and_b32 v115, 0xffff0000, v122
    v_mul_f32 v120, v88, v96
    v_mul_f32 v121, v89, v100
    v_cvt_pk_bf16_f32 v122, v120, v121
    v_lshlrev_b32 v120, 16, v122
    v_and_b32 v121, 0xffff0000, v122
    v_add_f32 v120, v114, v120
    v_add_f32 v121, v115, v121
    v_cvt_pk_bf16_f32 v122, v120, v121
    v_lshlrev_b32 v114, 16, v122
    v_and_b32 v115, 0xffff0000, v122
    v_mul_f32 v114, v114, v106
    v_mul_f32 v115, v115, v107
    v_mul_f32 v120, v84, v99
    v_mul_f32 v121, v85, v103
    v_cvt_pk_bf16_f32 v122, v120, v121
    v_lshlrev_b32 v116, 16, v122
    v_and_b32 v117, 0xffff0000, v122
    v_mul_f32 v120, v86, v98
    v_mul_f32 v121, v87, v102
    v_cvt_pk_bf16_f32 v122, v120, v121
    v_lshlrev_b32 v120, 16, v122
    v_and_b32 v121, 0xffff0000, v122
    v_add_f32 v120, v116, v120
    v_add_f32 v121, v117, v121
    v_cvt_pk_bf16_f32 v122, v120, v121
    v_lshlrev_b32 v116, 16, v122
    v_and_b32 v117, 0xffff0000, v122
    v_mul_f32 v120, v88, v97
    v_mul_f32 v121, v89, v101
    v_cvt_pk_bf16_f32 v122, v120, v121
    v_lshlrev_b32 v120, 16, v122
    v_and_b32 v121, 0xffff0000, v122
    v_add_f32 v120, v116, v120
    v_add_f32 v121, v117, v121
    v_cvt_pk_bf16_f32 v122, v120, v121
    v_lshlrev_b32 v116, 16, v122
    v_and_b32 v117, 0xffff0000, v122
    v_mul_f32 v120, v90, v96
    v_mul_f32 v121, v91, v100
    v_cvt_pk_bf16_f32 v122, v120, v121
    v_lshlrev_b32 v120, 16, v122
    v_and_b32 v121, 0xffff0000, v122
    v_add_f32 v120, v116, v120
    v_add_f32 v121, v117, v121
    v_cvt_pk_bf16_f32 v122, v120, v121
    v_lshlrev_b32 v116, 16, v122
    v_and_b32 v117, 0xffff0000, v122
    v_mul_f32 v116, v116, v108
    v_mul_f32 v117, v117, v109
    v_mul_f32 v120, v86, v99
    v_mul_f32 v121, v87, v103
    v_cvt_pk_bf16_f32 v122, v120, v121
    v_lshlrev_b32 v118, 16, v122
    v_and_b32 v119, 0xffff0000, v122
    v_mul_f32 v120, v88, v98
    v_mul_f32 v121, v89, v102
    v_cvt_pk_bf16_f32 v122, v120, v121
    v_lshlrev_b32 v120, 16, v122
    v_and_b32 v121, 0xffff0000, v122
    v_add_f32 v120, v118, v120
    v_add_f32 v121, v119, v121
    v_cvt_pk_bf16_f32 v122, v120, v121
    v_lshlrev_b32 v118, 16, v122
    v_and_b32 v119, 0xffff0000, v122
    v_mul_f32 v120, v90, v97
    v_mul_f32 v121, v91, v101
    v_cvt_pk_bf16_f32 v122, v120, v121
    v_lshlrev_b32 v120, 16, v122
    v_and_b32 v121, 0xffff0000, v122
    v_add_f32 v120, v118, v120
    v_add_f32 v121, v119, v121
    v_cvt_pk_bf16_f32 v122, v120, v121
    v_lshlrev_b32 v118, 16, v122
    v_and_b32 v119, 0xffff0000, v122
    v_mul_f32 v120, v92, v96
    v_mul_f32 v121, v93, v100
    v_cvt_pk_bf16_f32 v122, v120, v121
    v_lshlrev_b32 v120, 16, v122
    v_and_b32 v121, 0xffff0000, v122
    v_add_f32 v120, v118, v120
    v_add_f32 v121, v119, v121
    v_cvt_pk_bf16_f32 v122, v120, v121
    v_lshlrev_b32 v118, 16, v122
    v_and_b32 v119, 0xffff0000, v122
    v_mul_f32 v118, v118, v110
    v_mul_f32 v119, v119, v111
    v_cvt_pk_bf16_f32 v124, v118, v116
    v_cvt_pk_bf16_f32 v125, v114, v112
    v_cvt_pk_bf16_f32 v126, v119, v117
    v_cvt_pk_bf16_f32 v127, v115, v113
    s_movk_i32 s40, 0
    buffer_store_dwordx2 v[124:125], v8, s[28:31], s40 offen
    s_movk_i32 s40, 4096
    buffer_store_dwordx2 v[126:127], v8, s[28:31], s40 offen
    s_nop 1
    v_lshlrev_b32 v80, 16, v17
    v_and_b32 v81, 0xffff0000, v17
    v_lshlrev_b32 v82, 16, v21
    v_and_b32 v83, 0xffff0000, v21
    v_lshlrev_b32 v84, 16, v25
    v_and_b32 v85, 0xffff0000, v25
    v_lshlrev_b32 v86, 16, v29
    v_and_b32 v87, 0xffff0000, v29
    v_lshlrev_b32 v88, 16, v33
    v_and_b32 v89, 0xffff0000, v33
    v_lshlrev_b32 v90, 16, v37
    v_and_b32 v91, 0xffff0000, v37
    v_lshlrev_b32 v92, 16, v41
    v_and_b32 v93, 0xffff0000, v41
    v_lshlrev_b32 v104, 16, v45
    v_and_b32 v105, 0xffff0000, v45
    v_lshlrev_b32 v106, 16, v49
    v_and_b32 v107, 0xffff0000, v49
    v_lshlrev_b32 v108, 16, v53
    v_and_b32 v109, 0xffff0000, v53
    v_lshlrev_b32 v110, 16, v57
    v_and_b32 v111, 0xffff0000, v57
    v_lshlrev_b32 v96, 16, v64
    v_and_b32 v97, 0xffff0000, v64
    v_lshlrev_b32 v98, 16, v65
    v_and_b32 v99, 0xffff0000, v65
    v_lshlrev_b32 v100, 16, v66
    v_and_b32 v101, 0xffff0000, v66
    v_lshlrev_b32 v102, 16, v67
    v_and_b32 v103, 0xffff0000, v67
    v_mul_f32 v120, v80, v99
    v_mul_f32 v121, v81, v103
    v_cvt_pk_bf16_f32 v122, v120, v121
    v_lshlrev_b32 v112, 16, v122
    v_and_b32 v113, 0xffff0000, v122
    v_mul_f32 v120, v82, v98
    v_mul_f32 v121, v83, v102
    v_cvt_pk_bf16_f32 v122, v120, v121
    v_lshlrev_b32 v120, 16, v122
    v_and_b32 v121, 0xffff0000, v122
    v_add_f32 v120, v112, v120
    v_add_f32 v121, v113, v121
    v_cvt_pk_bf16_f32 v122, v120, v121
    v_lshlrev_b32 v112, 16, v122
    v_and_b32 v113, 0xffff0000, v122
    v_mul_f32 v120, v84, v97
    v_mul_f32 v121, v85, v101
    v_cvt_pk_bf16_f32 v122, v120, v121
    v_lshlrev_b32 v120, 16, v122
    v_and_b32 v121, 0xffff0000, v122
    v_add_f32 v120, v112, v120
    v_add_f32 v121, v113, v121
    v_cvt_pk_bf16_f32 v122, v120, v121
    v_lshlrev_b32 v112, 16, v122
    v_and_b32 v113, 0xffff0000, v122
    v_mul_f32 v120, v86, v96
    v_mul_f32 v121, v87, v100
    v_cvt_pk_bf16_f32 v122, v120, v121
    v_lshlrev_b32 v120, 16, v122
    v_and_b32 v121, 0xffff0000, v122
    v_add_f32 v120, v112, v120
    v_add_f32 v121, v113, v121
    v_cvt_pk_bf16_f32 v122, v120, v121
    v_lshlrev_b32 v112, 16, v122
    v_and_b32 v113, 0xffff0000, v122
    v_mul_f32 v112, v112, v104
    v_mul_f32 v113, v113, v105
    v_mul_f32 v120, v82, v99
    v_mul_f32 v121, v83, v103
    v_cvt_pk_bf16_f32 v122, v120, v121
    v_lshlrev_b32 v114, 16, v122
    v_and_b32 v115, 0xffff0000, v122
    v_mul_f32 v120, v84, v98
    v_mul_f32 v121, v85, v102
    v_cvt_pk_bf16_f32 v122, v120, v121
    v_lshlrev_b32 v120, 16, v122
    v_and_b32 v121, 0xffff0000, v122
    v_add_f32 v120, v114, v120
    v_add_f32 v121, v115, v121
    v_cvt_pk_bf16_f32 v122, v120, v121
    v_lshlrev_b32 v114, 16, v122
    v_and_b32 v115, 0xffff0000, v122
    v_mul_f32 v120, v86, v97
    v_mul_f32 v121, v87, v101
    v_cvt_pk_bf16_f32 v122, v120, v121
    v_lshlrev_b32 v120, 16, v122
    v_and_b32 v121, 0xffff0000, v122
    v_add_f32 v120, v114, v120
    v_add_f32 v121, v115, v121
    v_cvt_pk_bf16_f32 v122, v120, v121
    v_lshlrev_b32 v114, 16, v122
    v_and_b32 v115, 0xffff0000, v122
    v_mul_f32 v120, v88, v96
    v_mul_f32 v121, v89, v100
    v_cvt_pk_bf16_f32 v122, v120, v121
    v_lshlrev_b32 v120, 16, v122
    v_and_b32 v121, 0xffff0000, v122
    v_add_f32 v120, v114, v120
    v_add_f32 v121, v115, v121
    v_cvt_pk_bf16_f32 v122, v120, v121
    v_lshlrev_b32 v114, 16, v122
    v_and_b32 v115, 0xffff0000, v122
    v_mul_f32 v114, v114, v106
    v_mul_f32 v115, v115, v107
    v_mul_f32 v120, v84, v99
    v_mul_f32 v121, v85, v103
    v_cvt_pk_bf16_f32 v122, v120, v121
    v_lshlrev_b32 v116, 16, v122
    v_and_b32 v117, 0xffff0000, v122
    v_mul_f32 v120, v86, v98
    v_mul_f32 v121, v87, v102
    v_cvt_pk_bf16_f32 v122, v120, v121
    v_lshlrev_b32 v120, 16, v122
    v_and_b32 v121, 0xffff0000, v122
    v_add_f32 v120, v116, v120
    v_add_f32 v121, v117, v121
    v_cvt_pk_bf16_f32 v122, v120, v121
    v_lshlrev_b32 v116, 16, v122
    v_and_b32 v117, 0xffff0000, v122
    v_mul_f32 v120, v88, v97
    v_mul_f32 v121, v89, v101
    v_cvt_pk_bf16_f32 v122, v120, v121
    v_lshlrev_b32 v120, 16, v122
    v_and_b32 v121, 0xffff0000, v122
    v_add_f32 v120, v116, v120
    v_add_f32 v121, v117, v121
    v_cvt_pk_bf16_f32 v122, v120, v121
    v_lshlrev_b32 v116, 16, v122
    v_and_b32 v117, 0xffff0000, v122
    v_mul_f32 v120, v90, v96
    v_mul_f32 v121, v91, v100
    v_cvt_pk_bf16_f32 v122, v120, v121
    v_lshlrev_b32 v120, 16, v122
    v_and_b32 v121, 0xffff0000, v122
    v_add_f32 v120, v116, v120
    v_add_f32 v121, v117, v121
    v_cvt_pk_bf16_f32 v122, v120, v121
    v_lshlrev_b32 v116, 16, v122
    v_and_b32 v117, 0xffff0000, v122
    v_mul_f32 v116, v116, v108
    v_mul_f32 v117, v117, v109
    v_mul_f32 v120, v86, v99
    v_mul_f32 v121, v87, v103
    v_cvt_pk_bf16_f32 v122, v120, v121
    v_lshlrev_b32 v118, 16, v122
    v_and_b32 v119, 0xffff0000, v122
    v_mul_f32 v120, v88, v98
    v_mul_f32 v121, v89, v102
    v_cvt_pk_bf16_f32 v122, v120, v121
    v_lshlrev_b32 v120, 16, v122
    v_and_b32 v121, 0xffff0000, v122
    v_add_f32 v120, v118, v120
    v_add_f32 v121, v119, v121
    v_cvt_pk_bf16_f32 v122, v120, v121
    v_lshlrev_b32 v118, 16, v122
    v_and_b32 v119, 0xffff0000, v122
    v_mul_f32 v120, v90, v97
    v_mul_f32 v121, v91, v101
    v_cvt_pk_bf16_f32 v122, v120, v121
    v_lshlrev_b32 v120, 16, v122
    v_and_b32 v121, 0xffff0000, v122
    v_add_f32 v120, v118, v120
    v_add_f32 v121, v119, v121
    v_cvt_pk_bf16_f32 v122, v120, v121
    v_lshlrev_b32 v118, 16, v122
    v_and_b32 v119, 0xffff0000, v122
    v_mul_f32 v120, v92, v96
    v_mul_f32 v121, v93, v100
    v_cvt_pk_bf16_f32 v122, v120, v121
    v_lshlrev_b32 v120, 16, v122
    v_and_b32 v121, 0xffff0000, v122
    v_add_f32 v120, v118, v120
    v_add_f32 v121, v119, v121
    v_cvt_pk_bf16_f32 v122, v120, v121
    v_lshlrev_b32 v118, 16, v122
    v_and_b32 v119, 0xffff0000, v122
    v_mul_f32 v118, v118, v110
    v_mul_f32 v119, v119, v111
    v_cvt_pk_bf16_f32 v124, v118, v116
    v_cvt_pk_bf16_f32 v125, v114, v112
    v_cvt_pk_bf16_f32 v126, v119, v117
    v_cvt_pk_bf16_f32 v127, v115, v113
    s_movk_i32 s40, 8192
    buffer_store_dwordx2 v[124:125], v8, s[28:31], s40 offen
    s_movk_i32 s40, 12288
    buffer_store_dwordx2 v[126:127], v8, s[28:31], s40 offen
    s_nop 1
    v_lshlrev_b32 v80, 16, v18
    v_and_b32 v81, 0xffff0000, v18
    v_lshlrev_b32 v82, 16, v22
    v_and_b32 v83, 0xffff0000, v22
    v_lshlrev_b32 v84, 16, v26
    v_and_b32 v85, 0xffff0000, v26
    v_lshlrev_b32 v86, 16, v30
    v_and_b32 v87, 0xffff0000, v30
    v_lshlrev_b32 v88, 16, v34
    v_and_b32 v89, 0xffff0000, v34
    v_lshlrev_b32 v90, 16, v38
    v_and_b32 v91, 0xffff0000, v38
    v_lshlrev_b32 v92, 16, v42
    v_and_b32 v93, 0xffff0000, v42
    v_lshlrev_b32 v104, 16, v46
    v_and_b32 v105, 0xffff0000, v46
    v_lshlrev_b32 v106, 16, v50
    v_and_b32 v107, 0xffff0000, v50
    v_lshlrev_b32 v108, 16, v54
    v_and_b32 v109, 0xffff0000, v54
    v_lshlrev_b32 v110, 16, v58
    v_and_b32 v111, 0xffff0000, v58
    v_lshlrev_b32 v96, 16, v68
    v_and_b32 v97, 0xffff0000, v68
    v_lshlrev_b32 v98, 16, v69
    v_and_b32 v99, 0xffff0000, v69
    v_lshlrev_b32 v100, 16, v70
    v_and_b32 v101, 0xffff0000, v70
    v_lshlrev_b32 v102, 16, v71
    v_and_b32 v103, 0xffff0000, v71
    v_mul_f32 v120, v80, v99
    v_mul_f32 v121, v81, v103
    v_cvt_pk_bf16_f32 v122, v120, v121
    v_lshlrev_b32 v112, 16, v122
    v_and_b32 v113, 0xffff0000, v122
    v_mul_f32 v120, v82, v98
    v_mul_f32 v121, v83, v102
    v_cvt_pk_bf16_f32 v122, v120, v121
    v_lshlrev_b32 v120, 16, v122
    v_and_b32 v121, 0xffff0000, v122
    v_add_f32 v120, v112, v120
    v_add_f32 v121, v113, v121
    v_cvt_pk_bf16_f32 v122, v120, v121
    v_lshlrev_b32 v112, 16, v122
    v_and_b32 v113, 0xffff0000, v122
    v_mul_f32 v120, v84, v97
    v_mul_f32 v121, v85, v101
    v_cvt_pk_bf16_f32 v122, v120, v121
    v_lshlrev_b32 v120, 16, v122
    v_and_b32 v121, 0xffff0000, v122
    v_add_f32 v120, v112, v120
    v_add_f32 v121, v113, v121
    v_cvt_pk_bf16_f32 v122, v120, v121
    v_lshlrev_b32 v112, 16, v122
    v_and_b32 v113, 0xffff0000, v122
    v_mul_f32 v120, v86, v96
    v_mul_f32 v121, v87, v100
    v_cvt_pk_bf16_f32 v122, v120, v121
    v_lshlrev_b32 v120, 16, v122
    v_and_b32 v121, 0xffff0000, v122
    v_add_f32 v120, v112, v120
    v_add_f32 v121, v113, v121
    v_cvt_pk_bf16_f32 v122, v120, v121
    v_lshlrev_b32 v112, 16, v122
    v_and_b32 v113, 0xffff0000, v122
    v_mul_f32 v112, v112, v104
    v_mul_f32 v113, v113, v105
    v_mul_f32 v120, v82, v99
    v_mul_f32 v121, v83, v103
    v_cvt_pk_bf16_f32 v122, v120, v121
    v_lshlrev_b32 v114, 16, v122
    v_and_b32 v115, 0xffff0000, v122
    v_mul_f32 v120, v84, v98
    v_mul_f32 v121, v85, v102
    v_cvt_pk_bf16_f32 v122, v120, v121
    v_lshlrev_b32 v120, 16, v122
    v_and_b32 v121, 0xffff0000, v122
    v_add_f32 v120, v114, v120
    v_add_f32 v121, v115, v121
    v_cvt_pk_bf16_f32 v122, v120, v121
    v_lshlrev_b32 v114, 16, v122
    v_and_b32 v115, 0xffff0000, v122
    v_mul_f32 v120, v86, v97
    v_mul_f32 v121, v87, v101
    v_cvt_pk_bf16_f32 v122, v120, v121
    v_lshlrev_b32 v120, 16, v122
    v_and_b32 v121, 0xffff0000, v122
    v_add_f32 v120, v114, v120
    v_add_f32 v121, v115, v121
    v_cvt_pk_bf16_f32 v122, v120, v121
    v_lshlrev_b32 v114, 16, v122
    v_and_b32 v115, 0xffff0000, v122
    v_mul_f32 v120, v88, v96
    v_mul_f32 v121, v89, v100
    v_cvt_pk_bf16_f32 v122, v120, v121
    v_lshlrev_b32 v120, 16, v122
    v_and_b32 v121, 0xffff0000, v122
    v_add_f32 v120, v114, v120
    v_add_f32 v121, v115, v121
    v_cvt_pk_bf16_f32 v122, v120, v121
    v_lshlrev_b32 v114, 16, v122
    v_and_b32 v115, 0xffff0000, v122
    v_mul_f32 v114, v114, v106
    v_mul_f32 v115, v115, v107
    v_mul_f32 v120, v84, v99
    v_mul_f32 v121, v85, v103
    v_cvt_pk_bf16_f32 v122, v120, v121
    v_lshlrev_b32 v116, 16, v122
    v_and_b32 v117, 0xffff0000, v122
    v_mul_f32 v120, v86, v98
    v_mul_f32 v121, v87, v102
    v_cvt_pk_bf16_f32 v122, v120, v121
    v_lshlrev_b32 v120, 16, v122
    v_and_b32 v121, 0xffff0000, v122
    v_add_f32 v120, v116, v120
    v_add_f32 v121, v117, v121
    v_cvt_pk_bf16_f32 v122, v120, v121
    v_lshlrev_b32 v116, 16, v122
    v_and_b32 v117, 0xffff0000, v122
    v_mul_f32 v120, v88, v97
    v_mul_f32 v121, v89, v101
    v_cvt_pk_bf16_f32 v122, v120, v121
    v_lshlrev_b32 v120, 16, v122
    v_and_b32 v121, 0xffff0000, v122
    v_add_f32 v120, v116, v120
    v_add_f32 v121, v117, v121
    v_cvt_pk_bf16_f32 v122, v120, v121
    v_lshlrev_b32 v116, 16, v122
    v_and_b32 v117, 0xffff0000, v122
    v_mul_f32 v120, v90, v96
    v_mul_f32 v121, v91, v100
    v_cvt_pk_bf16_f32 v122, v120, v121
    v_lshlrev_b32 v120, 16, v122
    v_and_b32 v121, 0xffff0000, v122
    v_add_f32 v120, v116, v120
    v_add_f32 v121, v117, v121
    v_cvt_pk_bf16_f32 v122, v120, v121
    v_lshlrev_b32 v116, 16, v122
    v_and_b32 v117, 0xffff0000, v122
    v_mul_f32 v116, v116, v108
    v_mul_f32 v117, v117, v109
    v_mul_f32 v120, v86, v99
    v_mul_f32 v121, v87, v103
    v_cvt_pk_bf16_f32 v122, v120, v121
    v_lshlrev_b32 v118, 16, v122
    v_and_b32 v119, 0xffff0000, v122
    v_mul_f32 v120, v88, v98
    v_mul_f32 v121, v89, v102
    v_cvt_pk_bf16_f32 v122, v120, v121
    v_lshlrev_b32 v120, 16, v122
    v_and_b32 v121, 0xffff0000, v122
    v_add_f32 v120, v118, v120
    v_add_f32 v121, v119, v121
    v_cvt_pk_bf16_f32 v122, v120, v121
    v_lshlrev_b32 v118, 16, v122
    v_and_b32 v119, 0xffff0000, v122
    v_mul_f32 v120, v90, v97
    v_mul_f32 v121, v91, v101
    v_cvt_pk_bf16_f32 v122, v120, v121
    v_lshlrev_b32 v120, 16, v122
    v_and_b32 v121, 0xffff0000, v122
    v_add_f32 v120, v118, v120
    v_add_f32 v121, v119, v121
    v_cvt_pk_bf16_f32 v122, v120, v121
    v_lshlrev_b32 v118, 16, v122
    v_and_b32 v119, 0xffff0000, v122
    v_mul_f32 v120, v92, v96
    v_mul_f32 v121, v93, v100
    v_cvt_pk_bf16_f32 v122, v120, v121
    v_lshlrev_b32 v120, 16, v122
    v_and_b32 v121, 0xffff0000, v122
    v_add_f32 v120, v118, v120
    v_add_f32 v121, v119, v121
    v_cvt_pk_bf16_f32 v122, v120, v121
    v_lshlrev_b32 v118, 16, v122
    v_and_b32 v119, 0xffff0000, v122
    v_mul_f32 v118, v118, v110
    v_mul_f32 v119, v119, v111
    v_cvt_pk_bf16_f32 v124, v118, v116
    v_cvt_pk_bf16_f32 v125, v114, v112
    v_cvt_pk_bf16_f32 v126, v119, v117
    v_cvt_pk_bf16_f32 v127, v115, v113
    s_movk_i32 s40, 16384
    buffer_store_dwordx2 v[124:125], v8, s[28:31], s40 offen
    s_movk_i32 s40, 20480
    buffer_store_dwordx2 v[126:127], v8, s[28:31], s40 offen
    s_nop 1
    v_lshlrev_b32 v80, 16, v19
    v_and_b32 v81, 0xffff0000, v19
    v_lshlrev_b32 v82, 16, v23
    v_and_b32 v83, 0xffff0000, v23
    v_lshlrev_b32 v84, 16, v27
    v_and_b32 v85, 0xffff0000, v27
    v_lshlrev_b32 v86, 16, v31
    v_and_b32 v87, 0xffff0000, v31
    v_lshlrev_b32 v88, 16, v35
    v_and_b32 v89, 0xffff0000, v35
    v_lshlrev_b32 v90, 16, v39
    v_and_b32 v91, 0xffff0000, v39
    v_lshlrev_b32 v92, 16, v43
    v_and_b32 v93, 0xffff0000, v43
    v_lshlrev_b32 v104, 16, v47
    v_and_b32 v105, 0xffff0000, v47
    v_lshlrev_b32 v106, 16, v51
    v_and_b32 v107, 0xffff0000, v51
    v_lshlrev_b32 v108, 16, v55
    v_and_b32 v109, 0xffff0000, v55
    v_lshlrev_b32 v110, 16, v59
    v_and_b32 v111, 0xffff0000, v59
    v_lshlrev_b32 v96, 16, v72
    v_and_b32 v97, 0xffff0000, v72
    v_lshlrev_b32 v98, 16, v73
    v_and_b32 v99, 0xffff0000, v73
    v_lshlrev_b32 v100, 16, v74
    v_and_b32 v101, 0xffff0000, v74
    v_lshlrev_b32 v102, 16, v75
    v_and_b32 v103, 0xffff0000, v75
    v_mul_f32 v120, v80, v99
    v_mul_f32 v121, v81, v103
    v_cvt_pk_bf16_f32 v122, v120, v121
    v_lshlrev_b32 v112, 16, v122
    v_and_b32 v113, 0xffff0000, v122
    v_mul_f32 v120, v82, v98
    v_mul_f32 v121, v83, v102
    v_cvt_pk_bf16_f32 v122, v120, v121
    v_lshlrev_b32 v120, 16, v122
    v_and_b32 v121, 0xffff0000, v122
    v_add_f32 v120, v112, v120
    v_add_f32 v121, v113, v121
    v_cvt_pk_bf16_f32 v122, v120, v121
    v_lshlrev_b32 v112, 16, v122
    v_and_b32 v113, 0xffff0000, v122
    v_mul_f32 v120, v84, v97
    v_mul_f32 v121, v85, v101
    v_cvt_pk_bf16_f32 v122, v120, v121
    v_lshlrev_b32 v120, 16, v122
    v_and_b32 v121, 0xffff0000, v122
    v_add_f32 v120, v112, v120
    v_add_f32 v121, v113, v121
    v_cvt_pk_bf16_f32 v122, v120, v121
    v_lshlrev_b32 v112, 16, v122
    v_and_b32 v113, 0xffff0000, v122
    v_mul_f32 v120, v86, v96
    v_mul_f32 v121, v87, v100
    v_cvt_pk_bf16_f32 v122, v120, v121
    v_lshlrev_b32 v120, 16, v122
    v_and_b32 v121, 0xffff0000, v122
    v_add_f32 v120, v112, v120
    v_add_f32 v121, v113, v121
    v_cvt_pk_bf16_f32 v122, v120, v121
    v_lshlrev_b32 v112, 16, v122
    v_and_b32 v113, 0xffff0000, v122
    v_mul_f32 v112, v112, v104
    v_mul_f32 v113, v113, v105
    v_mul_f32 v120, v82, v99
    v_mul_f32 v121, v83, v103
    v_cvt_pk_bf16_f32 v122, v120, v121
    v_lshlrev_b32 v114, 16, v122
    v_and_b32 v115, 0xffff0000, v122
    v_mul_f32 v120, v84, v98
    v_mul_f32 v121, v85, v102
    v_cvt_pk_bf16_f32 v122, v120, v121
    v_lshlrev_b32 v120, 16, v122
    v_and_b32 v121, 0xffff0000, v122
    v_add_f32 v120, v114, v120
    v_add_f32 v121, v115, v121
    v_cvt_pk_bf16_f32 v122, v120, v121
    v_lshlrev_b32 v114, 16, v122
    v_and_b32 v115, 0xffff0000, v122
    v_mul_f32 v120, v86, v97
    v_mul_f32 v121, v87, v101
    v_cvt_pk_bf16_f32 v122, v120, v121
    v_lshlrev_b32 v120, 16, v122
    v_and_b32 v121, 0xffff0000, v122
    v_add_f32 v120, v114, v120
    v_add_f32 v121, v115, v121
    v_cvt_pk_bf16_f32 v122, v120, v121
    v_lshlrev_b32 v114, 16, v122
    v_and_b32 v115, 0xffff0000, v122
    v_mul_f32 v120, v88, v96
    v_mul_f32 v121, v89, v100
    v_cvt_pk_bf16_f32 v122, v120, v121
    v_lshlrev_b32 v120, 16, v122
    v_and_b32 v121, 0xffff0000, v122
    v_add_f32 v120, v114, v120
    v_add_f32 v121, v115, v121
    v_cvt_pk_bf16_f32 v122, v120, v121
    v_lshlrev_b32 v114, 16, v122
    v_and_b32 v115, 0xffff0000, v122
    v_mul_f32 v114, v114, v106
    v_mul_f32 v115, v115, v107
    v_mul_f32 v120, v84, v99
    v_mul_f32 v121, v85, v103
    v_cvt_pk_bf16_f32 v122, v120, v121
    v_lshlrev_b32 v116, 16, v122
    v_and_b32 v117, 0xffff0000, v122
    v_mul_f32 v120, v86, v98
    v_mul_f32 v121, v87, v102
    v_cvt_pk_bf16_f32 v122, v120, v121
    v_lshlrev_b32 v120, 16, v122
    v_and_b32 v121, 0xffff0000, v122
    v_add_f32 v120, v116, v120
    v_add_f32 v121, v117, v121
    v_cvt_pk_bf16_f32 v122, v120, v121
    v_lshlrev_b32 v116, 16, v122
    v_and_b32 v117, 0xffff0000, v122
    v_mul_f32 v120, v88, v97
    v_mul_f32 v121, v89, v101
    v_cvt_pk_bf16_f32 v122, v120, v121
    v_lshlrev_b32 v120, 16, v122
    v_and_b32 v121, 0xffff0000, v122
    v_add_f32 v120, v116, v120
    v_add_f32 v121, v117, v121
    v_cvt_pk_bf16_f32 v122, v120, v121
    v_lshlrev_b32 v116, 16, v122
    v_and_b32 v117, 0xffff0000, v122
    v_mul_f32 v120, v90, v96
    v_mul_f32 v121, v91, v100
    v_cvt_pk_bf16_f32 v122, v120, v121
    v_lshlrev_b32 v120, 16, v122
    v_and_b32 v121, 0xffff0000, v122
    v_add_f32 v120, v116, v120
    v_add_f32 v121, v117, v121
    v_cvt_pk_bf16_f32 v122, v120, v121
    v_lshlrev_b32 v116, 16, v122
    v_and_b32 v117, 0xffff0000, v122
    v_mul_f32 v116, v116, v108
    v_mul_f32 v117, v117, v109
    v_mul_f32 v120, v86, v99
    v_mul_f32 v121, v87, v103
    v_cvt_pk_bf16_f32 v122, v120, v121
    v_lshlrev_b32 v118, 16, v122
    v_and_b32 v119, 0xffff0000, v122
    v_mul_f32 v120, v88, v98
    v_mul_f32 v121, v89, v102
    v_cvt_pk_bf16_f32 v122, v120, v121
    v_lshlrev_b32 v120, 16, v122
    v_and_b32 v121, 0xffff0000, v122
    v_add_f32 v120, v118, v120
    v_add_f32 v121, v119, v121
    v_cvt_pk_bf16_f32 v122, v120, v121
    v_lshlrev_b32 v118, 16, v122
    v_and_b32 v119, 0xffff0000, v122
    v_mul_f32 v120, v90, v97
    v_mul_f32 v121, v91, v101
    v_cvt_pk_bf16_f32 v122, v120, v121
    v_lshlrev_b32 v120, 16, v122
    v_and_b32 v121, 0xffff0000, v122
    v_add_f32 v120, v118, v120
    v_add_f32 v121, v119, v121
    v_cvt_pk_bf16_f32 v122, v120, v121
    v_lshlrev_b32 v118, 16, v122
    v_and_b32 v119, 0xffff0000, v122
    v_mul_f32 v120, v92, v96
    v_mul_f32 v121, v93, v100
    v_cvt_pk_bf16_f32 v122, v120, v121
    v_lshlrev_b32 v120, 16, v122
    v_and_b32 v121, 0xffff0000, v122
    v_add_f32 v120, v118, v120
    v_add_f32 v121, v119, v121
    v_cvt_pk_bf16_f32 v122, v120, v121
    v_lshlrev_b32 v118, 16, v122
    v_and_b32 v119, 0xffff0000, v122
    v_mul_f32 v118, v118, v110
    v_mul_f32 v119, v119, v111
    v_cvt_pk_bf16_f32 v124, v118, v116
    v_cvt_pk_bf16_f32 v125, v114, v112
    v_cvt_pk_bf16_f32 v126, v119, v117
    v_cvt_pk_bf16_f32 v127, v115, v113
    s_movk_i32 s40, 24576
    buffer_store_dwordx2 v[124:125], v8, s[28:31], s40 offen
    s_movk_i32 s40, 28672
    buffer_store_dwordx2 v[126:127], v8, s[28:31], s40 offen
    s_nop 1
prep_done:
    s_endpgm
.globl gemm1_kernel
.p2align 8
.type gemm1_kernel,@function
gemm1_kernel:
    s_load_dwordx2 s[4:5], s[0:1], 96
    s_load_dwordx2 s[6:7], s[0:1], 56
    s_load_dwordx2 s[8:9], s[0:1], 64
    s_load_dwordx2 s[60:61], s[0:1], 0
    s_load_dwordx2 s[62:63], s[0:1], 8
    s_load_dwordx2 s[64:65], s[0:1], 16
    s_load_dwordx2 s[66:67], s[0:1], 24
    s_load_dwordx2 s[68:69], s[0:1], 88
    s_load_dwordx2 s[96:97], s[0:1], 72
    s_load_dwordx2 s[98:99], s[0:1], 32
    s_load_dwordx2 s[100:101], s[0:1], 40
    s_cmp_ge_u32 s2, 256
    s_cbranch_scc1 g1_done
    s_nop 0
    v_lshrrev_b32 v1, 6, v0
    s_nop 0
    v_readfirstlane_b32 s24, v1
    v_and_b32 v1, 63, v0
    s_and_b32 s25, s24, 3
    s_lshr_b32 s26, s24, 2
    s_and_b32 s28, s2, 7
    s_lshl_b32 s28, s28, 2
    s_lshr_b32 s27, s2, 3
    s_and_b32 s29, s27, 3
    s_add_u32 s28, s28, s29
    s_lshr_b32 s27, s27, 2
    s_waitcnt lgkmcnt(0)
    s_cmp_eq_u32 s26, 0
    s_cselect_b32 s6, s6, s8
    s_cselect_b32 s7, s7, s9

    s_mov_b32 s12, s4
    s_mov_b32 s13, s5
    s_mov_b32 s14, 2359296
    s_mov_b32 s15, 0x00020000
    s_mov_b32 s16, s6
    s_mov_b32 s17, s7
    s_mov_b32 s18, 5308416
    s_mov_b32 s19, 0x00020000
    s_add_u32 s20, s4, 4718592
    s_addc_u32 s21, s5, 0
    s_mov_b32 s22, 18874368
    s_mov_b32 s23, 0x00020000
    s_lshl_b32 s32, s27, 4
    s_lshl_b32 s33, s24, 1
    s_add_u32 s32, s32, s33
    s_mul_i32 s32, s32, 18432
    v_lshlrev_b32 v2, 4, v1
    v_add_u32 v2, s32, v2
    v_add_u32 v3, 18432, v2
    s_lshl_b32 s33, s25, 3
    s_mul_i32 s33, s33, 9216
    s_mul_i32 s34, s28, 288
    s_add_u32 s33, s33, s34

    v_add_u32 v20, 0, v1
    v_mul_u32_u24 v21, 3641, v20
    v_lshrrev_b32 v21, 16, v21
    v_mul_u32_u24 v22, 18, v21
    v_sub_u32 v22, v20, v22
    v_mul_u32_u24 v21, 9216, v21
    v_lshl_add_u32 v21, v22, 4, v21
    v_add_u32 v4, s33, v21

    v_add_u32 v20, 64, v1
    v_mul_u32_u24 v21, 3641, v20
    v_lshrrev_b32 v21, 16, v21
    v_mul_u32_u24 v22, 18, v21
    v_sub_u32 v22, v20, v22
    v_mul_u32_u24 v21, 9216, v21
    v_lshl_add_u32 v21, v22, 4, v21
    v_add_u32 v5, s33, v21

    v_add_u32 v20, 128, v1
    v_mul_u32_u24 v21, 3641, v20
    v_lshrrev_b32 v21, 16, v21
    v_mul_u32_u24 v22, 18, v21
    v_sub_u32 v22, v20, v22
    v_mul_u32_u24 v21, 9216, v21
    v_lshl_add_u32 v21, v22, 4, v21
    v_add_u32 v6, s33, v21

    s_lshl_b32 s30, s24, 11
    s_mul_i32 s31, s26, 9216
    s_mul_i32 s34, s25, 2304
    s_add_u32 s31, s31, s34
    s_add_u32 s31, s31, 16384
    s_lshl_b32 s34, s25, 12
    v_lshlrev_b32 v8, 4, v1
    v_add_u32 v8, s34, v8
    v_lshrrev_b32 v12, 2, v1
    v_mul_u32_u24 v12, 288, v12
    v_and_b32 v13, 3, v1
    v_lshl_add_u32 v12, v13, 3, v12
    s_mul_i32 s34, s26, 9216
    s_add_u32 s34, s34, 16384
    v_add_u32 v12, s34, v12

    v_add_u32 v9, 34816, v8
    v_add_u32 v13, 34816, v12
    v_add_u32 v10, 69632, v8
    v_add_u32 v14, 69632, v12
    v_add_u32 v11, 104448, v8
    v_add_u32 v15, 104448, v12
    s_lshl_b32 s34, s27, 4
    s_lshl_b32 s35, s25, 2
    s_add_u32 s34, s34, s35
    s_mul_i32 s34, s34, 144
    s_mul_i32 s35, s28, 9
    s_lshr_b32 s35, s35, 1
    s_add_u32 s34, s34, s35
    s_lshl_b32 s34, s34, 10
    v_lshlrev_b32 v16, 4, v1
    v_add_u32 v16, s34, v16
    s_mul_i32 s34, s24, 9216
    v_lshlrev_b32 v17, 3, v1
    v_add_u32 v17, s34, v17
    s_xor_b32 s35, s24, 4
    s_mul_i32 s35, s35, 9216
    v_lshlrev_b32 v18, 3, v1
    v_add_u32 v18, s35, v18

    s_mov_b32 s36, 0
    s_add_u32 m0, s30, 0
    s_mov_b32 s37, 0
    buffer_load_dwordx4 v2, s[12:15], s36 offen lds
    s_add_u32 m0, s30, 1024
    s_nop 0
    buffer_load_dwordx4 v3, s[12:15], s36 offen lds
    s_add_u32 m0, s31, 0
    s_nop 0
    buffer_load_dwordx4 v4, s[16:19], s37 offen lds
    s_add_u32 m0, s31, 1024
    s_nop 0
    buffer_load_dwordx4 v5, s[16:19], s37 offen lds
    s_add_u32 m0, s31, 2048
    s_mov_b64 exec, 0xffff
    buffer_load_dwordx4 v6, s[16:19], s37 offen lds
    s_mov_b64 exec, -1
    s_mov_b32 s36, 1024
    s_add_u32 m0, s30, 34816
    s_mov_b32 s37, 294912
    buffer_load_dwordx4 v2, s[12:15], s36 offen lds
    s_add_u32 m0, s30, 35840
    s_nop 0
    buffer_load_dwordx4 v3, s[12:15], s36 offen lds
    s_add_u32 m0, s31, 34816
    s_nop 0
    buffer_load_dwordx4 v4, s[16:19], s37 offen lds
    s_add_u32 m0, s31, 35840
    s_nop 0
    buffer_load_dwordx4 v5, s[16:19], s37 offen lds
    s_add_u32 m0, s31, 36864
    s_mov_b64 exec, 0xffff
    buffer_load_dwordx4 v6, s[16:19], s37 offen lds
    s_mov_b64 exec, -1
    s_mov_b32 s36, 2048
    s_add_u32 m0, s30, 69632
    s_mov_b32 s37, 589824
    buffer_load_dwordx4 v2, s[12:15], s36 offen lds
    s_add_u32 m0, s30, 70656
    s_nop 0
    buffer_load_dwordx4 v3, s[12:15], s36 offen lds
    s_add_u32 m0, s31, 69632
    s_nop 0
    buffer_load_dwordx4 v4, s[16:19], s37 offen lds
    s_add_u32 m0, s31, 70656
    s_nop 0
    buffer_load_dwordx4 v5, s[16:19], s37 offen lds
    s_add_u32 m0, s31, 71680
    s_mov_b64 exec, 0xffff
    buffer_load_dwordx4 v6, s[16:19], s37 offen lds
    s_mov_b64 exec, -1
    s_waitcnt vmcnt(10)
    s_barrier
    ds_read_b128 v[44:47], v8 offset:0
    ds_read_b128 v[48:51], v8 offset:1024
    ds_read_b128 v[52:55], v8 offset:2048
    ds_read_b128 v[56:59], v8 offset:3072
    ds_read_b64_tr_b16 v[76:77], v12 offset:0
    ds_read_b64_tr_b16 v[78:79], v12 offset:4608
    ds_read_b64_tr_b16 v[80:81], v12 offset:32
    ds_read_b64_tr_b16 v[82:83], v12 offset:4640
    ds_read_b64_tr_b16 v[84:85], v12 offset:64
    ds_read_b64_tr_b16 v[86:87], v12 offset:4672
    ds_read_b64_tr_b16 v[88:89], v12 offset:96
    ds_read_b64_tr_b16 v[90:91], v12 offset:4704
    ds_read_b64_tr_b16 v[92:93], v12 offset:128
    ds_read_b64_tr_b16 v[94:95], v12 offset:4736
    ds_read_b64_tr_b16 v[96:97], v12 offset:160
    ds_read_b64_tr_b16 v[98:99], v12 offset:4768
    ds_read_b64_tr_b16 v[100:101], v12 offset:192
    ds_read_b64_tr_b16 v[102:103], v12 offset:4800
    ds_read_b64_tr_b16 v[104:105], v12 offset:224
    ds_read_b64_tr_b16 v[106:107], v12 offset:4832
    ds_read_b64_tr_b16 v[108:109], v12 offset:256
    ds_read_b64_tr_b16 v[110:111], v12 offset:4864
    s_waitcnt lgkmcnt(0)
    v_mfma_f32_16x16x32_bf16 v[112:115], v[76:79], v[44:47], 0
    v_mfma_f32_16x16x32_bf16 v[148:151], v[76:79], v[48:51], 0
    v_mfma_f32_16x16x32_bf16 v[184:187], v[76:79], v[52:55], 0
    v_mfma_f32_16x16x32_bf16 v[220:223], v[76:79], v[56:59], 0
    s_waitcnt vmcnt(5)
    s_barrier
    ds_read_b128 v[60:63], v9 offset:0
    ds_read_b128 v[64:67], v9 offset:1024
    ds_read_b128 v[68:71], v9 offset:2048
    ds_read_b128 v[72:75], v9 offset:3072
    ds_read_b64_tr_b16 v[76:77], v13 offset:0
    ds_read_b64_tr_b16 v[78:79], v13 offset:4608
    v_mfma_f32_16x16x32_bf16 v[116:119], v[80:83], v[44:47], 0
    v_mfma_f32_16x16x32_bf16 v[152:155], v[80:83], v[48:51], 0
    v_mfma_f32_16x16x32_bf16 v[188:191], v[80:83], v[52:55], 0
    v_mfma_f32_16x16x32_bf16 v[224:227], v[80:83], v[56:59], 0
    ds_read_b64_tr_b16 v[80:81], v13 offset:32
    ds_read_b64_tr_b16 v[82:83], v13 offset:4640
    s_mov_b32 s36, 3072
    s_add_u32 m0, s30, 104448
    s_mov_b32 s37, 884736
    buffer_load_dwordx4 v2, s[12:15], s36 offen lds
    v_mfma_f32_16x16x32_bf16 v[120:123], v[84:87], v[44:47], 0
    v_mfma_f32_16x16x32_bf16 v[156:159], v[84:87], v[48:51], 0
    v_mfma_f32_16x16x32_bf16 v[192:195], v[84:87], v[52:55], 0
    v_mfma_f32_16x16x32_bf16 v[228:231], v[84:87], v[56:59], 0
    ds_read_b64_tr_b16 v[84:85], v13 offset:64
    ds_read_b64_tr_b16 v[86:87], v13 offset:4672
    s_add_u32 m0, s30, 105472
    s_nop 0
    buffer_load_dwordx4 v3, s[12:15], s36 offen lds
    v_mfma_f32_16x16x32_bf16 v[124:127], v[88:91], v[44:47], 0
    v_mfma_f32_16x16x32_bf16 v[160:163], v[88:91], v[48:51], 0
    v_mfma_f32_16x16x32_bf16 v[196:199], v[88:91], v[52:55], 0
    v_mfma_f32_16x16x32_bf16 v[232:235], v[88:91], v[56:59], 0
    ds_read_b64_tr_b16 v[88:89], v13 offset:96
    ds_read_b64_tr_b16 v[90:91], v13 offset:4704
    s_add_u32 m0, s31, 104448
    s_nop 0
    buffer_load_dwordx4 v4, s[16:19], s37 offen lds
    v_mfma_f32_16x16x32_bf16 v[128:131], v[92:95], v[44:47], 0
    v_mfma_f32_16x16x32_bf16 v[164:167], v[92:95], v[48:51], 0
    v_mfma_f32_16x16x32_bf16 v[200:203], v[92:95], v[52:55], 0
    v_mfma_f32_16x16x32_bf16 v[236:239], v[92:95], v[56:59], 0
    ds_read_b64_tr_b16 v[92:93], v13 offset:128
    ds_read_b64_tr_b16 v[94:95], v13 offset:4736
    s_add_u32 m0, s31, 105472
    s_nop 0
    buffer_load_dwordx4 v5, s[16:19], s37 offen lds
    v_mfma_f32_16x16x32_bf16 v[132:135], v[96:99], v[44:47], 0
    v_mfma_f32_16x16x32_bf16 v[168:171], v[96:99], v[48:51], 0
    v_mfma_f32_16x16x32_bf16 v[204:207], v[96:99], v[52:55], 0
    v_mfma_f32_16x16x32_bf16 v[240:243], v[96:99], v[56:59], 0
    ds_read_b64_tr_b16 v[96:97], v13 offset:160
    ds_read_b64_tr_b16 v[98:99], v13 offset:4768
    s_add_u32 m0, s31, 106496
    s_mov_b64 exec, 0xffff
    buffer_load_dwordx4 v6, s[16:19], s37 offen lds
    s_mov_b64 exec, -1
    v_mfma_f32_16x16x32_bf16 v[136:139], v[100:103], v[44:47], 0
    v_mfma_f32_16x16x32_bf16 v[172:175], v[100:103], v[48:51], 0
    v_mfma_f32_16x16x32_bf16 v[208:211], v[100:103], v[52:55], 0
    v_mfma_f32_16x16x32_bf16 v[244:247], v[100:103], v[56:59], 0
    ds_read_b64_tr_b16 v[100:101], v13 offset:192
    ds_read_b64_tr_b16 v[102:103], v13 offset:4800
    v_mfma_f32_16x16x32_bf16 v[140:143], v[104:107], v[44:47], 0
    v_mfma_f32_16x16x32_bf16 v[176:179], v[104:107], v[48:51], 0
    v_mfma_f32_16x16x32_bf16 v[212:215], v[104:107], v[52:55], 0
    v_mfma_f32_16x16x32_bf16 v[248:251], v[104:107], v[56:59], 0
    ds_read_b64_tr_b16 v[104:105], v13 offset:224
    ds_read_b64_tr_b16 v[106:107], v13 offset:4832
    v_mfma_f32_16x16x32_bf16 v[144:147], v[108:111], v[44:47], 0
    v_mfma_f32_16x16x32_bf16 v[180:183], v[108:111], v[48:51], 0
    v_mfma_f32_16x16x32_bf16 v[216:219], v[108:111], v[52:55], 0
    v_mfma_f32_16x16x32_bf16 v[252:255], v[108:111], v[56:59], 0
    ds_read_b64_tr_b16 v[108:109], v13 offset:256
    ds_read_b64_tr_b16 v[110:111], v13 offset:4864
    s_waitcnt lgkmcnt(12)
    v_mfma_f32_16x16x32_bf16 v[112:115], v[76:79], v[60:63], v[112:115]
    v_mfma_f32_16x16x32_bf16 v[148:151], v[76:79], v[64:67], v[148:151]
    v_mfma_f32_16x16x32_bf16 v[184:187], v[76:79], v[68:71], v[184:187]
    v_mfma_f32_16x16x32_bf16 v[220:223], v[76:79], v[72:75], v[220:223]
    s_waitcnt vmcnt(5)
    s_barrier
    ds_read_b128 v[44:47], v10 offset:0
    ds_read_b128 v[48:51], v10 offset:1024
    ds_read_b128 v[52:55], v10 offset:2048
    ds_read_b128 v[56:59], v10 offset:3072
    ds_read_b64_tr_b16 v[76:77], v14 offset:0
    ds_read_b64_tr_b16 v[78:79], v14 offset:4608
    s_waitcnt lgkmcnt(12)
    v_mfma_f32_16x16x32_bf16 v[116:119], v[80:83], v[60:63], v[116:119]
    v_mfma_f32_16x16x32_bf16 v[152:155], v[80:83], v[64:67], v[152:155]
    v_mfma_f32_16x16x32_bf16 v[188:191], v[80:83], v[68:71], v[188:191]
    v_mfma_f32_16x16x32_bf16 v[224:227], v[80:83], v[72:75], v[224:227]
    ds_read_b64_tr_b16 v[80:81], v14 offset:32
    ds_read_b64_tr_b16 v[82:83], v14 offset:4640
    s_mov_b32 s36, 4096
    s_add_u32 m0, s30, 0
    s_mov_b32 s37, 1179648
    buffer_load_dwordx4 v2, s[12:15], s36 offen lds
    s_waitcnt lgkmcnt(12)
    v_mfma_f32_16x16x32_bf16 v[120:123], v[84:87], v[60:63], v[120:123]
    v_mfma_f32_16x16x32_bf16 v[156:159], v[84:87], v[64:67], v[156:159]
    v_mfma_f32_16x16x32_bf16 v[192:195], v[84:87], v[68:71], v[192:195]
    v_mfma_f32_16x16x32_bf16 v[228:231], v[84:87], v[72:75], v[228:231]
    ds_read_b64_tr_b16 v[84:85], v14 offset:64
    ds_read_b64_tr_b16 v[86:87], v14 offset:4672
    s_add_u32 m0, s30, 1024
    s_nop 0
    buffer_load_dwordx4 v3, s[12:15], s36 offen lds
    s_waitcnt lgkmcnt(12)
    v_mfma_f32_16x16x32_bf16 v[124:127], v[88:91], v[60:63], v[124:127]
    v_mfma_f32_16x16x32_bf16 v[160:163], v[88:91], v[64:67], v[160:163]
    v_mfma_f32_16x16x32_bf16 v[196:199], v[88:91], v[68:71], v[196:199]
    v_mfma_f32_16x16x32_bf16 v[232:235], v[88:91], v[72:75], v[232:235]
    ds_read_b64_tr_b16 v[88:89], v14 offset:96
    ds_read_b64_tr_b16 v[90:91], v14 offset:4704
    s_add_u32 m0, s31, 0
    s_nop 0
    buffer_load_dwordx4 v4, s[16:19], s37 offen lds
    s_waitcnt lgkmcnt(12)
    v_mfma_f32_16x16x32_bf16 v[128:131], v[92:95], v[60:63], v[128:131]
    v_mfma_f32_16x16x32_bf16 v[164:167], v[92:95], v[64:67], v[164:167]
    v_mfma_f32_16x16x32_bf16 v[200:203], v[92:95], v[68:71], v[200:203]
    v_mfma_f32_16x16x32_bf16 v[236:239], v[92:95], v[72:75], v[236:239]
    ds_read_b64_tr_b16 v[92:93], v14 offset:128
    ds_read_b64_tr_b16 v[94:95], v14 offset:4736
    s_add_u32 m0, s31, 1024
    s_nop 0
    buffer_load_dwordx4 v5, s[16:19], s37 offen lds
    s_waitcnt lgkmcnt(12)
    v_mfma_f32_16x16x32_bf16 v[132:135], v[96:99], v[60:63], v[132:135]
    v_mfma_f32_16x16x32_bf16 v[168:171], v[96:99], v[64:67], v[168:171]
    v_mfma_f32_16x16x32_bf16 v[204:207], v[96:99], v[68:71], v[204:207]
    v_mfma_f32_16x16x32_bf16 v[240:243], v[96:99], v[72:75], v[240:243]
    ds_read_b64_tr_b16 v[96:97], v14 offset:160
    ds_read_b64_tr_b16 v[98:99], v14 offset:4768
    s_add_u32 m0, s31, 2048
    s_mov_b64 exec, 0xffff
    buffer_load_dwordx4 v6, s[16:19], s37 offen lds
    s_mov_b64 exec, -1
    s_waitcnt lgkmcnt(12)
    v_mfma_f32_16x16x32_bf16 v[136:139], v[100:103], v[60:63], v[136:139]
    v_mfma_f32_16x16x32_bf16 v[172:175], v[100:103], v[64:67], v[172:175]
    v_mfma_f32_16x16x32_bf16 v[208:211], v[100:103], v[68:71], v[208:211]
    v_mfma_f32_16x16x32_bf16 v[244:247], v[100:103], v[72:75], v[244:247]
    ds_read_b64_tr_b16 v[100:101], v14 offset:192
    ds_read_b64_tr_b16 v[102:103], v14 offset:4800
    s_waitcnt lgkmcnt(12)
    v_mfma_f32_16x16x32_bf16 v[140:143], v[104:107], v[60:63], v[140:143]
    v_mfma_f32_16x16x32_bf16 v[176:179], v[104:107], v[64:67], v[176:179]
    v_mfma_f32_16x16x32_bf16 v[212:215], v[104:107], v[68:71], v[212:215]
    v_mfma_f32_16x16x32_bf16 v[248:251], v[104:107], v[72:75], v[248:251]
    ds_read_b64_tr_b16 v[104:105], v14 offset:224
    ds_read_b64_tr_b16 v[106:107], v14 offset:4832
    s_waitcnt lgkmcnt(12)
    v_mfma_f32_16x16x32_bf16 v[144:147], v[108:111], v[60:63], v[144:147]
    v_mfma_f32_16x16x32_bf16 v[180:183], v[108:111], v[64:67], v[180:183]
    v_mfma_f32_16x16x32_bf16 v[216:219], v[108:111], v[68:71], v[216:219]
    v_mfma_f32_16x16x32_bf16 v[252:255], v[108:111], v[72:75], v[252:255]
    ds_read_b64_tr_b16 v[108:109], v14 offset:256
    ds_read_b64_tr_b16 v[110:111], v14 offset:4864
    s_waitcnt lgkmcnt(12)
    v_mfma_f32_16x16x32_bf16 v[112:115], v[76:79], v[44:47], v[112:115]
    v_mfma_f32_16x16x32_bf16 v[148:151], v[76:79], v[48:51], v[148:151]
    v_mfma_f32_16x16x32_bf16 v[184:187], v[76:79], v[52:55], v[184:187]
    v_mfma_f32_16x16x32_bf16 v[220:223], v[76:79], v[56:59], v[220:223]
    s_waitcnt vmcnt(5)
    s_barrier
    ds_read_b128 v[60:63], v11 offset:0
    ds_read_b128 v[64:67], v11 offset:1024
    ds_read_b128 v[68:71], v11 offset:2048
    ds_read_b128 v[72:75], v11 offset:3072
    ds_read_b64_tr_b16 v[76:77], v15 offset:0
    ds_read_b64_tr_b16 v[78:79], v15 offset:4608
    s_waitcnt lgkmcnt(12)
    v_mfma_f32_16x16x32_bf16 v[116:119], v[80:83], v[44:47], v[116:119]
    v_mfma_f32_16x16x32_bf16 v[152:155], v[80:83], v[48:51], v[152:155]
    v_mfma_f32_16x16x32_bf16 v[188:191], v[80:83], v[52:55], v[188:191]
    v_mfma_f32_16x16x32_bf16 v[224:227], v[80:83], v[56:59], v[224:227]
    ds_read_b64_tr_b16 v[80:81], v15 offset:32
    ds_read_b64_tr_b16 v[82:83], v15 offset:4640
    s_mov_b32 s36, 5120
    s_add_u32 m0, s30, 34816
    s_mov_b32 s37, 1474560
    buffer_load_dwordx4 v2, s[12:15], s36 offen lds
    s_waitcnt lgkmcnt(12)
    v_mfma_f32_16x16x32_bf16 v[120:123], v[84:87], v[44:47], v[120:123]
    v_mfma_f32_16x16x32_bf16 v[156:159], v[84:87], v[48:51], v[156:159]
    v_mfma_f32_16x16x32_bf16 v[192:195], v[84:87], v[52:55], v[192:195]
    v_mfma_f32_16x16x32_bf16 v[228:231], v[84:87], v[56:59], v[228:231]
    ds_read_b64_tr_b16 v[84:85], v15 offset:64
    ds_read_b64_tr_b16 v[86:87], v15 offset:4672
    s_add_u32 m0, s30, 35840
    s_nop 0
    buffer_load_dwordx4 v3, s[12:15], s36 offen lds
    s_waitcnt lgkmcnt(12)
    v_mfma_f32_16x16x32_bf16 v[124:127], v[88:91], v[44:47], v[124:127]
    v_mfma_f32_16x16x32_bf16 v[160:163], v[88:91], v[48:51], v[160:163]
    v_mfma_f32_16x16x32_bf16 v[196:199], v[88:91], v[52:55], v[196:199]
    v_mfma_f32_16x16x32_bf16 v[232:235], v[88:91], v[56:59], v[232:235]
    ds_read_b64_tr_b16 v[88:89], v15 offset:96
    ds_read_b64_tr_b16 v[90:91], v15 offset:4704
    s_add_u32 m0, s31, 34816
    s_nop 0
    buffer_load_dwordx4 v4, s[16:19], s37 offen lds
    s_waitcnt lgkmcnt(12)
    v_mfma_f32_16x16x32_bf16 v[128:131], v[92:95], v[44:47], v[128:131]
    v_mfma_f32_16x16x32_bf16 v[164:167], v[92:95], v[48:51], v[164:167]
    v_mfma_f32_16x16x32_bf16 v[200:203], v[92:95], v[52:55], v[200:203]
    v_mfma_f32_16x16x32_bf16 v[236:239], v[92:95], v[56:59], v[236:239]
    ds_read_b64_tr_b16 v[92:93], v15 offset:128
    ds_read_b64_tr_b16 v[94:95], v15 offset:4736
    s_add_u32 m0, s31, 35840
    s_nop 0
    buffer_load_dwordx4 v5, s[16:19], s37 offen lds
    s_waitcnt lgkmcnt(12)
    v_mfma_f32_16x16x32_bf16 v[132:135], v[96:99], v[44:47], v[132:135]
    v_mfma_f32_16x16x32_bf16 v[168:171], v[96:99], v[48:51], v[168:171]
    v_mfma_f32_16x16x32_bf16 v[204:207], v[96:99], v[52:55], v[204:207]
    v_mfma_f32_16x16x32_bf16 v[240:243], v[96:99], v[56:59], v[240:243]
    ds_read_b64_tr_b16 v[96:97], v15 offset:160
    ds_read_b64_tr_b16 v[98:99], v15 offset:4768
    s_add_u32 m0, s31, 36864
    s_mov_b64 exec, 0xffff
    buffer_load_dwordx4 v6, s[16:19], s37 offen lds
    s_mov_b64 exec, -1
    s_waitcnt lgkmcnt(12)
    v_mfma_f32_16x16x32_bf16 v[136:139], v[100:103], v[44:47], v[136:139]
    v_mfma_f32_16x16x32_bf16 v[172:175], v[100:103], v[48:51], v[172:175]
    v_mfma_f32_16x16x32_bf16 v[208:211], v[100:103], v[52:55], v[208:211]
    v_mfma_f32_16x16x32_bf16 v[244:247], v[100:103], v[56:59], v[244:247]
    ds_read_b64_tr_b16 v[100:101], v15 offset:192
    ds_read_b64_tr_b16 v[102:103], v15 offset:4800
    s_waitcnt lgkmcnt(12)
    v_mfma_f32_16x16x32_bf16 v[140:143], v[104:107], v[44:47], v[140:143]
    v_mfma_f32_16x16x32_bf16 v[176:179], v[104:107], v[48:51], v[176:179]
    v_mfma_f32_16x16x32_bf16 v[212:215], v[104:107], v[52:55], v[212:215]
    v_mfma_f32_16x16x32_bf16 v[248:251], v[104:107], v[56:59], v[248:251]
    ds_read_b64_tr_b16 v[104:105], v15 offset:224
    ds_read_b64_tr_b16 v[106:107], v15 offset:4832
    s_waitcnt lgkmcnt(12)
    v_mfma_f32_16x16x32_bf16 v[144:147], v[108:111], v[44:47], v[144:147]
    v_mfma_f32_16x16x32_bf16 v[180:183], v[108:111], v[48:51], v[180:183]
    v_mfma_f32_16x16x32_bf16 v[216:219], v[108:111], v[52:55], v[216:219]
    v_mfma_f32_16x16x32_bf16 v[252:255], v[108:111], v[56:59], v[252:255]
    ds_read_b64_tr_b16 v[108:109], v15 offset:256
    ds_read_b64_tr_b16 v[110:111], v15 offset:4864
    s_waitcnt lgkmcnt(12)
    v_mfma_f32_16x16x32_bf16 v[112:115], v[76:79], v[60:63], v[112:115]
    v_mfma_f32_16x16x32_bf16 v[148:151], v[76:79], v[64:67], v[148:151]
    v_mfma_f32_16x16x32_bf16 v[184:187], v[76:79], v[68:71], v[184:187]
    v_mfma_f32_16x16x32_bf16 v[220:223], v[76:79], v[72:75], v[220:223]
    s_waitcnt vmcnt(5)
    s_barrier
    ds_read_b128 v[44:47], v8 offset:0
    ds_read_b128 v[48:51], v8 offset:1024
    ds_read_b128 v[52:55], v8 offset:2048
    ds_read_b128 v[56:59], v8 offset:3072
    ds_read_b64_tr_b16 v[76:77], v12 offset:0
    ds_read_b64_tr_b16 v[78:79], v12 offset:4608
    s_waitcnt lgkmcnt(12)
    v_mfma_f32_16x16x32_bf16 v[116:119], v[80:83], v[60:63], v[116:119]
    v_mfma_f32_16x16x32_bf16 v[152:155], v[80:83], v[64:67], v[152:155]
    v_mfma_f32_16x16x32_bf16 v[188:191], v[80:83], v[68:71], v[188:191]
    v_mfma_f32_16x16x32_bf16 v[224:227], v[80:83], v[72:75], v[224:227]
    ds_read_b64_tr_b16 v[80:81], v12 offset:32
    ds_read_b64_tr_b16 v[82:83], v12 offset:4640
    s_mov_b32 s36, 6144
    s_add_u32 m0, s30, 69632
    s_mov_b32 s37, 1769472
    buffer_load_dwordx4 v2, s[12:15], s36 offen lds
    s_waitcnt lgkmcnt(12)
    v_mfma_f32_16x16x32_bf16 v[120:123], v[84:87], v[60:63], v[120:123]
    v_mfma_f32_16x16x32_bf16 v[156:159], v[84:87], v[64:67], v[156:159]
    v_mfma_f32_16x16x32_bf16 v[192:195], v[84:87], v[68:71], v[192:195]
    v_mfma_f32_16x16x32_bf16 v[228:231], v[84:87], v[72:75], v[228:231]
    ds_read_b64_tr_b16 v[84:85], v12 offset:64
    ds_read_b64_tr_b16 v[86:87], v12 offset:4672
    s_add_u32 m0, s30, 70656
    s_nop 0
    buffer_load_dwordx4 v3, s[12:15], s36 offen lds
    s_waitcnt lgkmcnt(12)
    v_mfma_f32_16x16x32_bf16 v[124:127], v[88:91], v[60:63], v[124:127]
    v_mfma_f32_16x16x32_bf16 v[160:163], v[88:91], v[64:67], v[160:163]
    v_mfma_f32_16x16x32_bf16 v[196:199], v[88:91], v[68:71], v[196:199]
    v_mfma_f32_16x16x32_bf16 v[232:235], v[88:91], v[72:75], v[232:235]
    ds_read_b64_tr_b16 v[88:89], v12 offset:96
    ds_read_b64_tr_b16 v[90:91], v12 offset:4704
    s_add_u32 m0, s31, 69632
    s_nop 0
    buffer_load_dwordx4 v4, s[16:19], s37 offen lds
    s_waitcnt lgkmcnt(12)
    v_mfma_f32_16x16x32_bf16 v[128:131], v[92:95], v[60:63], v[128:131]
    v_mfma_f32_16x16x32_bf16 v[164:167], v[92:95], v[64:67], v[164:167]
    v_mfma_f32_16x16x32_bf16 v[200:203], v[92:95], v[68:71], v[200:203]
    v_mfma_f32_16x16x32_bf16 v[236:239], v[92:95], v[72:75], v[236:239]
    ds_read_b64_tr_b16 v[92:93], v12 offset:128
    ds_read_b64_tr_b16 v[94:95], v12 offset:4736
    s_add_u32 m0, s31, 70656
    s_nop 0
    buffer_load_dwordx4 v5, s[16:19], s37 offen lds
    s_waitcnt lgkmcnt(12)
    v_mfma_f32_16x16x32_bf16 v[132:135], v[96:99], v[60:63], v[132:135]
    v_mfma_f32_16x16x32_bf16 v[168:171], v[96:99], v[64:67], v[168:171]
    v_mfma_f32_16x16x32_bf16 v[204:207], v[96:99], v[68:71], v[204:207]
    v_mfma_f32_16x16x32_bf16 v[240:243], v[96:99], v[72:75], v[240:243]
    ds_read_b64_tr_b16 v[96:97], v12 offset:160
    ds_read_b64_tr_b16 v[98:99], v12 offset:4768
    s_add_u32 m0, s31, 71680
    s_mov_b64 exec, 0xffff
    buffer_load_dwordx4 v6, s[16:19], s37 offen lds
    s_mov_b64 exec, -1
    s_waitcnt lgkmcnt(12)
    v_mfma_f32_16x16x32_bf16 v[136:139], v[100:103], v[60:63], v[136:139]
    v_mfma_f32_16x16x32_bf16 v[172:175], v[100:103], v[64:67], v[172:175]
    v_mfma_f32_16x16x32_bf16 v[208:211], v[100:103], v[68:71], v[208:211]
    v_mfma_f32_16x16x32_bf16 v[244:247], v[100:103], v[72:75], v[244:247]
    ds_read_b64_tr_b16 v[100:101], v12 offset:192
    ds_read_b64_tr_b16 v[102:103], v12 offset:4800
    s_waitcnt lgkmcnt(12)
    v_mfma_f32_16x16x32_bf16 v[140:143], v[104:107], v[60:63], v[140:143]
    v_mfma_f32_16x16x32_bf16 v[176:179], v[104:107], v[64:67], v[176:179]
    v_mfma_f32_16x16x32_bf16 v[212:215], v[104:107], v[68:71], v[212:215]
    v_mfma_f32_16x16x32_bf16 v[248:251], v[104:107], v[72:75], v[248:251]
    ds_read_b64_tr_b16 v[104:105], v12 offset:224
    ds_read_b64_tr_b16 v[106:107], v12 offset:4832
    s_waitcnt lgkmcnt(12)
    v_mfma_f32_16x16x32_bf16 v[144:147], v[108:111], v[60:63], v[144:147]
    v_mfma_f32_16x16x32_bf16 v[180:183], v[108:111], v[64:67], v[180:183]
    v_mfma_f32_16x16x32_bf16 v[216:219], v[108:111], v[68:71], v[216:219]
    v_mfma_f32_16x16x32_bf16 v[252:255], v[108:111], v[72:75], v[252:255]
    ds_read_b64_tr_b16 v[108:109], v12 offset:256
    ds_read_b64_tr_b16 v[110:111], v12 offset:4864
    s_waitcnt lgkmcnt(12)
    v_mfma_f32_16x16x32_bf16 v[112:115], v[76:79], v[44:47], v[112:115]
    v_mfma_f32_16x16x32_bf16 v[148:151], v[76:79], v[48:51], v[148:151]
    v_mfma_f32_16x16x32_bf16 v[184:187], v[76:79], v[52:55], v[184:187]
    v_mfma_f32_16x16x32_bf16 v[220:223], v[76:79], v[56:59], v[220:223]
    s_waitcnt vmcnt(5)
    s_barrier
    ds_read_b128 v[60:63], v9 offset:0
    ds_read_b128 v[64:67], v9 offset:1024
    ds_read_b128 v[68:71], v9 offset:2048
    ds_read_b128 v[72:75], v9 offset:3072
    ds_read_b64_tr_b16 v[76:77], v13 offset:0
    ds_read_b64_tr_b16 v[78:79], v13 offset:4608
    s_waitcnt lgkmcnt(12)
    v_mfma_f32_16x16x32_bf16 v[116:119], v[80:83], v[44:47], v[116:119]
    v_mfma_f32_16x16x32_bf16 v[152:155], v[80:83], v[48:51], v[152:155]
    v_mfma_f32_16x16x32_bf16 v[188:191], v[80:83], v[52:55], v[188:191]
    v_mfma_f32_16x16x32_bf16 v[224:227], v[80:83], v[56:59], v[224:227]
    ds_read_b64_tr_b16 v[80:81], v13 offset:32
    ds_read_b64_tr_b16 v[82:83], v13 offset:4640
    s_mov_b32 s36, 7168
    s_add_u32 m0, s30, 104448
    s_mov_b32 s37, 2064384
    buffer_load_dwordx4 v2, s[12:15], s36 offen lds
    s_waitcnt lgkmcnt(12)
    v_mfma_f32_16x16x32_bf16 v[120:123], v[84:87], v[44:47], v[120:123]
    v_mfma_f32_16x16x32_bf16 v[156:159], v[84:87], v[48:51], v[156:159]
    v_mfma_f32_16x16x32_bf16 v[192:195], v[84:87], v[52:55], v[192:195]
    v_mfma_f32_16x16x32_bf16 v[228:231], v[84:87], v[56:59], v[228:231]
    ds_read_b64_tr_b16 v[84:85], v13 offset:64
    ds_read_b64_tr_b16 v[86:87], v13 offset:4672
    s_add_u32 m0, s30, 105472
    s_nop 0
    buffer_load_dwordx4 v3, s[12:15], s36 offen lds
    s_waitcnt lgkmcnt(12)
    v_mfma_f32_16x16x32_bf16 v[124:127], v[88:91], v[44:47], v[124:127]
    v_mfma_f32_16x16x32_bf16 v[160:163], v[88:91], v[48:51], v[160:163]
    v_mfma_f32_16x16x32_bf16 v[196:199], v[88:91], v[52:55], v[196:199]
    v_mfma_f32_16x16x32_bf16 v[232:235], v[88:91], v[56:59], v[232:235]
    ds_read_b64_tr_b16 v[88:89], v13 offset:96
    ds_read_b64_tr_b16 v[90:91], v13 offset:4704
    s_add_u32 m0, s31, 104448
    s_nop 0
    buffer_load_dwordx4 v4, s[16:19], s37 offen lds
    s_waitcnt lgkmcnt(12)
    v_mfma_f32_16x16x32_bf16 v[128:131], v[92:95], v[44:47], v[128:131]
    v_mfma_f32_16x16x32_bf16 v[164:167], v[92:95], v[48:51], v[164:167]
    v_mfma_f32_16x16x32_bf16 v[200:203], v[92:95], v[52:55], v[200:203]
    v_mfma_f32_16x16x32_bf16 v[236:239], v[92:95], v[56:59], v[236:239]
    ds_read_b64_tr_b16 v[92:93], v13 offset:128
    ds_read_b64_tr_b16 v[94:95], v13 offset:4736
    s_add_u32 m0, s31, 105472
    s_nop 0
    buffer_load_dwordx4 v5, s[16:19], s37 offen lds
    s_waitcnt lgkmcnt(12)
    v_mfma_f32_16x16x32_bf16 v[132:135], v[96:99], v[44:47], v[132:135]
    v_mfma_f32_16x16x32_bf16 v[168:171], v[96:99], v[48:51], v[168:171]
    v_mfma_f32_16x16x32_bf16 v[204:207], v[96:99], v[52:55], v[204:207]
    v_mfma_f32_16x16x32_bf16 v[240:243], v[96:99], v[56:59], v[240:243]
    ds_read_b64_tr_b16 v[96:97], v13 offset:160
    ds_read_b64_tr_b16 v[98:99], v13 offset:4768
    s_add_u32 m0, s31, 106496
    s_mov_b64 exec, 0xffff
    buffer_load_dwordx4 v6, s[16:19], s37 offen lds
    s_mov_b64 exec, -1
    s_waitcnt lgkmcnt(12)
    v_mfma_f32_16x16x32_bf16 v[136:139], v[100:103], v[44:47], v[136:139]
    v_mfma_f32_16x16x32_bf16 v[172:175], v[100:103], v[48:51], v[172:175]
    v_mfma_f32_16x16x32_bf16 v[208:211], v[100:103], v[52:55], v[208:211]
    v_mfma_f32_16x16x32_bf16 v[244:247], v[100:103], v[56:59], v[244:247]
    ds_read_b64_tr_b16 v[100:101], v13 offset:192
    ds_read_b64_tr_b16 v[102:103], v13 offset:4800
    s_waitcnt lgkmcnt(12)
    v_mfma_f32_16x16x32_bf16 v[140:143], v[104:107], v[44:47], v[140:143]
    v_mfma_f32_16x16x32_bf16 v[176:179], v[104:107], v[48:51], v[176:179]
    v_mfma_f32_16x16x32_bf16 v[212:215], v[104:107], v[52:55], v[212:215]
    v_mfma_f32_16x16x32_bf16 v[248:251], v[104:107], v[56:59], v[248:251]
    ds_read_b64_tr_b16 v[104:105], v13 offset:224
    ds_read_b64_tr_b16 v[106:107], v13 offset:4832
    s_waitcnt lgkmcnt(12)
    v_mfma_f32_16x16x32_bf16 v[144:147], v[108:111], v[44:47], v[144:147]
    v_mfma_f32_16x16x32_bf16 v[180:183], v[108:111], v[48:51], v[180:183]
    v_mfma_f32_16x16x32_bf16 v[216:219], v[108:111], v[52:55], v[216:219]
    v_mfma_f32_16x16x32_bf16 v[252:255], v[108:111], v[56:59], v[252:255]
    ds_read_b64_tr_b16 v[108:109], v13 offset:256
    ds_read_b64_tr_b16 v[110:111], v13 offset:4864
    s_waitcnt lgkmcnt(12)
    v_mfma_f32_16x16x32_bf16 v[112:115], v[76:79], v[60:63], v[112:115]
    v_mfma_f32_16x16x32_bf16 v[148:151], v[76:79], v[64:67], v[148:151]
    v_mfma_f32_16x16x32_bf16 v[184:187], v[76:79], v[68:71], v[184:187]
    v_mfma_f32_16x16x32_bf16 v[220:223], v[76:79], v[72:75], v[220:223]
    s_waitcnt vmcnt(5)
    s_barrier
    ds_read_b128 v[44:47], v10 offset:0
    ds_read_b128 v[48:51], v10 offset:1024
    ds_read_b128 v[52:55], v10 offset:2048
    ds_read_b128 v[56:59], v10 offset:3072
    ds_read_b64_tr_b16 v[76:77], v14 offset:0
    ds_read_b64_tr_b16 v[78:79], v14 offset:4608
    s_waitcnt lgkmcnt(12)
    v_mfma_f32_16x16x32_bf16 v[116:119], v[80:83], v[60:63], v[116:119]
    v_mfma_f32_16x16x32_bf16 v[152:155], v[80:83], v[64:67], v[152:155]
    v_mfma_f32_16x16x32_bf16 v[188:191], v[80:83], v[68:71], v[188:191]
    v_mfma_f32_16x16x32_bf16 v[224:227], v[80:83], v[72:75], v[224:227]
    ds_read_b64_tr_b16 v[80:81], v14 offset:32
    ds_read_b64_tr_b16 v[82:83], v14 offset:4640
    s_mov_b32 s36, 8192
    s_add_u32 m0, s30, 0
    s_mov_b32 s37, 2359296
    buffer_load_dwordx4 v2, s[12:15], s36 offen lds
    s_waitcnt lgkmcnt(12)
    v_mfma_f32_16x16x32_bf16 v[120:123], v[84:87], v[60:63], v[120:123]
    v_mfma_f32_16x16x32_bf16 v[156:159], v[84:87], v[64:67], v[156:159]
    v_mfma_f32_16x16x32_bf16 v[192:195], v[84:87], v[68:71], v[192:195]
    v_mfma_f32_16x16x32_bf16 v[228:231], v[84:87], v[72:75], v[228:231]
    ds_read_b64_tr_b16 v[84:85], v14 offset:64
    ds_read_b64_tr_b16 v[86:87], v14 offset:4672
    s_add_u32 m0, s30, 1024
    s_nop 0
    buffer_load_dwordx4 v3, s[12:15], s36 offen lds
    s_waitcnt lgkmcnt(12)
    v_mfma_f32_16x16x32_bf16 v[124:127], v[88:91], v[60:63], v[124:127]
    v_mfma_f32_16x16x32_bf16 v[160:163], v[88:91], v[64:67], v[160:163]
    v_mfma_f32_16x16x32_bf16 v[196:199], v[88:91], v[68:71], v[196:199]
    v_mfma_f32_16x16x32_bf16 v[232:235], v[88:91], v[72:75], v[232:235]
    ds_read_b64_tr_b16 v[88:89], v14 offset:96
    ds_read_b64_tr_b16 v[90:91], v14 offset:4704
    s_add_u32 m0, s31, 0
    s_nop 0
    buffer_load_dwordx4 v4, s[16:19], s37 offen lds
    s_waitcnt lgkmcnt(12)
    v_mfma_f32_16x16x32_bf16 v[128:131], v[92:95], v[60:63], v[128:131]
    v_mfma_f32_16x16x32_bf16 v[164:167], v[92:95], v[64:67], v[164:167]
    v_mfma_f32_16x16x32_bf16 v[200:203], v[92:95], v[68:71], v[200:203]
    v_mfma_f32_16x16x32_bf16 v[236:239], v[92:95], v[72:75], v[236:239]
    ds_read_b64_tr_b16 v[92:93], v14 offset:128
    ds_read_b64_tr_b16 v[94:95], v14 offset:4736
    s_add_u32 m0, s31, 1024
    s_nop 0
    buffer_load_dwordx4 v5, s[16:19], s37 offen lds
    s_waitcnt lgkmcnt(12)
    v_mfma_f32_16x16x32_bf16 v[132:135], v[96:99], v[60:63], v[132:135]
    v_mfma_f32_16x16x32_bf16 v[168:171], v[96:99], v[64:67], v[168:171]
    v_mfma_f32_16x16x32_bf16 v[204:207], v[96:99], v[68:71], v[204:207]
    v_mfma_f32_16x16x32_bf16 v[240:243], v[96:99], v[72:75], v[240:243]
    ds_read_b64_tr_b16 v[96:97], v14 offset:160
    ds_read_b64_tr_b16 v[98:99], v14 offset:4768
    s_add_u32 m0, s31, 2048
    s_mov_b64 exec, 0xffff
    buffer_load_dwordx4 v6, s[16:19], s37 offen lds
    s_mov_b64 exec, -1
    s_waitcnt lgkmcnt(12)
    v_mfma_f32_16x16x32_bf16 v[136:139], v[100:103], v[60:63], v[136:139]
    v_mfma_f32_16x16x32_bf16 v[172:175], v[100:103], v[64:67], v[172:175]
    v_mfma_f32_16x16x32_bf16 v[208:211], v[100:103], v[68:71], v[208:211]
    v_mfma_f32_16x16x32_bf16 v[244:247], v[100:103], v[72:75], v[244:247]
    ds_read_b64_tr_b16 v[100:101], v14 offset:192
    ds_read_b64_tr_b16 v[102:103], v14 offset:4800
    s_waitcnt lgkmcnt(12)
    v_mfma_f32_16x16x32_bf16 v[140:143], v[104:107], v[60:63], v[140:143]
    v_mfma_f32_16x16x32_bf16 v[176:179], v[104:107], v[64:67], v[176:179]
    v_mfma_f32_16x16x32_bf16 v[212:215], v[104:107], v[68:71], v[212:215]
    v_mfma_f32_16x16x32_bf16 v[248:251], v[104:107], v[72:75], v[248:251]
    ds_read_b64_tr_b16 v[104:105], v14 offset:224
    ds_read_b64_tr_b16 v[106:107], v14 offset:4832
    s_waitcnt lgkmcnt(12)
    v_mfma_f32_16x16x32_bf16 v[144:147], v[108:111], v[60:63], v[144:147]
    v_mfma_f32_16x16x32_bf16 v[180:183], v[108:111], v[64:67], v[180:183]
    v_mfma_f32_16x16x32_bf16 v[216:219], v[108:111], v[68:71], v[216:219]
    v_mfma_f32_16x16x32_bf16 v[252:255], v[108:111], v[72:75], v[252:255]
    ds_read_b64_tr_b16 v[108:109], v14 offset:256
    ds_read_b64_tr_b16 v[110:111], v14 offset:4864
    s_waitcnt lgkmcnt(12)
    v_mfma_f32_16x16x32_bf16 v[112:115], v[76:79], v[44:47], v[112:115]
    v_mfma_f32_16x16x32_bf16 v[148:151], v[76:79], v[48:51], v[148:151]
    v_mfma_f32_16x16x32_bf16 v[184:187], v[76:79], v[52:55], v[184:187]
    v_mfma_f32_16x16x32_bf16 v[220:223], v[76:79], v[56:59], v[220:223]
    s_waitcnt vmcnt(5)
    s_barrier
    ds_read_b128 v[60:63], v11 offset:0
    ds_read_b128 v[64:67], v11 offset:1024
    ds_read_b128 v[68:71], v11 offset:2048
    ds_read_b128 v[72:75], v11 offset:3072
    ds_read_b64_tr_b16 v[76:77], v15 offset:0
    ds_read_b64_tr_b16 v[78:79], v15 offset:4608
    s_waitcnt lgkmcnt(12)
    v_mfma_f32_16x16x32_bf16 v[116:119], v[80:83], v[44:47], v[116:119]
    v_mfma_f32_16x16x32_bf16 v[152:155], v[80:83], v[48:51], v[152:155]
    v_mfma_f32_16x16x32_bf16 v[188:191], v[80:83], v[52:55], v[188:191]
    v_mfma_f32_16x16x32_bf16 v[224:227], v[80:83], v[56:59], v[224:227]
    ds_read_b64_tr_b16 v[80:81], v15 offset:32
    ds_read_b64_tr_b16 v[82:83], v15 offset:4640
    s_mov_b32 s36, 9216
    s_add_u32 m0, s30, 34816
    s_mov_b32 s37, 2654208
    buffer_load_dwordx4 v2, s[12:15], s36 offen lds
    s_waitcnt lgkmcnt(12)
    v_mfma_f32_16x16x32_bf16 v[120:123], v[84:87], v[44:47], v[120:123]
    v_mfma_f32_16x16x32_bf16 v[156:159], v[84:87], v[48:51], v[156:159]
    v_mfma_f32_16x16x32_bf16 v[192:195], v[84:87], v[52:55], v[192:195]
    v_mfma_f32_16x16x32_bf16 v[228:231], v[84:87], v[56:59], v[228:231]
    ds_read_b64_tr_b16 v[84:85], v15 offset:64
    ds_read_b64_tr_b16 v[86:87], v15 offset:4672
    s_add_u32 m0, s30, 35840
    s_nop 0
    buffer_load_dwordx4 v3, s[12:15], s36 offen lds
    s_waitcnt lgkmcnt(12)
    v_mfma_f32_16x16x32_bf16 v[124:127], v[88:91], v[44:47], v[124:127]
    v_mfma_f32_16x16x32_bf16 v[160:163], v[88:91], v[48:51], v[160:163]
    v_mfma_f32_16x16x32_bf16 v[196:199], v[88:91], v[52:55], v[196:199]
    v_mfma_f32_16x16x32_bf16 v[232:235], v[88:91], v[56:59], v[232:235]
    ds_read_b64_tr_b16 v[88:89], v15 offset:96
    ds_read_b64_tr_b16 v[90:91], v15 offset:4704
    s_add_u32 m0, s31, 34816
    s_nop 0
    buffer_load_dwordx4 v4, s[16:19], s37 offen lds
    s_waitcnt lgkmcnt(12)
    v_mfma_f32_16x16x32_bf16 v[128:131], v[92:95], v[44:47], v[128:131]
    v_mfma_f32_16x16x32_bf16 v[164:167], v[92:95], v[48:51], v[164:167]
    v_mfma_f32_16x16x32_bf16 v[200:203], v[92:95], v[52:55], v[200:203]
    v_mfma_f32_16x16x32_bf16 v[236:239], v[92:95], v[56:59], v[236:239]
    ds_read_b64_tr_b16 v[92:93], v15 offset:128
    ds_read_b64_tr_b16 v[94:95], v15 offset:4736
    s_add_u32 m0, s31, 35840
    s_nop 0
    buffer_load_dwordx4 v5, s[16:19], s37 offen lds
    s_waitcnt lgkmcnt(12)
    v_mfma_f32_16x16x32_bf16 v[132:135], v[96:99], v[44:47], v[132:135]
    v_mfma_f32_16x16x32_bf16 v[168:171], v[96:99], v[48:51], v[168:171]
    v_mfma_f32_16x16x32_bf16 v[204:207], v[96:99], v[52:55], v[204:207]
    v_mfma_f32_16x16x32_bf16 v[240:243], v[96:99], v[56:59], v[240:243]
    ds_read_b64_tr_b16 v[96:97], v15 offset:160
    ds_read_b64_tr_b16 v[98:99], v15 offset:4768
    s_add_u32 m0, s31, 36864
    s_mov_b64 exec, 0xffff
    buffer_load_dwordx4 v6, s[16:19], s37 offen lds
    s_mov_b64 exec, -1
    s_waitcnt lgkmcnt(12)
    v_mfma_f32_16x16x32_bf16 v[136:139], v[100:103], v[44:47], v[136:139]
    v_mfma_f32_16x16x32_bf16 v[172:175], v[100:103], v[48:51], v[172:175]
    v_mfma_f32_16x16x32_bf16 v[208:211], v[100:103], v[52:55], v[208:211]
    v_mfma_f32_16x16x32_bf16 v[244:247], v[100:103], v[56:59], v[244:247]
    ds_read_b64_tr_b16 v[100:101], v15 offset:192
    ds_read_b64_tr_b16 v[102:103], v15 offset:4800
    s_waitcnt lgkmcnt(12)
    v_mfma_f32_16x16x32_bf16 v[140:143], v[104:107], v[44:47], v[140:143]
    v_mfma_f32_16x16x32_bf16 v[176:179], v[104:107], v[48:51], v[176:179]
    v_mfma_f32_16x16x32_bf16 v[212:215], v[104:107], v[52:55], v[212:215]
    v_mfma_f32_16x16x32_bf16 v[248:251], v[104:107], v[56:59], v[248:251]
    ds_read_b64_tr_b16 v[104:105], v15 offset:224
    ds_read_b64_tr_b16 v[106:107], v15 offset:4832
    s_waitcnt lgkmcnt(12)
    v_mfma_f32_16x16x32_bf16 v[144:147], v[108:111], v[44:47], v[144:147]
    v_mfma_f32_16x16x32_bf16 v[180:183], v[108:111], v[48:51], v[180:183]
    v_mfma_f32_16x16x32_bf16 v[216:219], v[108:111], v[52:55], v[216:219]
    v_mfma_f32_16x16x32_bf16 v[252:255], v[108:111], v[56:59], v[252:255]
    ds_read_b64_tr_b16 v[108:109], v15 offset:256
    ds_read_b64_tr_b16 v[110:111], v15 offset:4864
    s_waitcnt lgkmcnt(12)
    v_mfma_f32_16x16x32_bf16 v[112:115], v[76:79], v[60:63], v[112:115]
    v_mfma_f32_16x16x32_bf16 v[148:151], v[76:79], v[64:67], v[148:151]
    v_mfma_f32_16x16x32_bf16 v[184:187], v[76:79], v[68:71], v[184:187]
    v_mfma_f32_16x16x32_bf16 v[220:223], v[76:79], v[72:75], v[220:223]
    s_waitcnt vmcnt(5)
    s_barrier
    ds_read_b128 v[44:47], v8 offset:0
    ds_read_b128 v[48:51], v8 offset:1024
    ds_read_b128 v[52:55], v8 offset:2048
    ds_read_b128 v[56:59], v8 offset:3072
    ds_read_b64_tr_b16 v[76:77], v12 offset:0
    ds_read_b64_tr_b16 v[78:79], v12 offset:4608
    s_waitcnt lgkmcnt(12)
    v_mfma_f32_16x16x32_bf16 v[116:119], v[80:83], v[60:63], v[116:119]
    v_mfma_f32_16x16x32_bf16 v[152:155], v[80:83], v[64:67], v[152:155]
    v_mfma_f32_16x16x32_bf16 v[188:191], v[80:83], v[68:71], v[188:191]
    v_mfma_f32_16x16x32_bf16 v[224:227], v[80:83], v[72:75], v[224:227]
    ds_read_b64_tr_b16 v[80:81], v12 offset:32
    ds_read_b64_tr_b16 v[82:83], v12 offset:4640
    s_mov_b32 s36, 10240
    s_add_u32 m0, s30, 69632
    s_mov_b32 s37, 2949120
    buffer_load_dwordx4 v2, s[12:15], s36 offen lds
    s_waitcnt lgkmcnt(12)
    v_mfma_f32_16x16x32_bf16 v[120:123], v[84:87], v[60:63], v[120:123]
    v_mfma_f32_16x16x32_bf16 v[156:159], v[84:87], v[64:67], v[156:159]
    v_mfma_f32_16x16x32_bf16 v[192:195], v[84:87], v[68:71], v[192:195]
    v_mfma_f32_16x16x32_bf16 v[228:231], v[84:87], v[72:75], v[228:231]
    ds_read_b64_tr_b16 v[84:85], v12 offset:64
    ds_read_b64_tr_b16 v[86:87], v12 offset:4672
    s_add_u32 m0, s30, 70656
    s_nop 0
    buffer_load_dwordx4 v3, s[12:15], s36 offen lds
    s_waitcnt lgkmcnt(12)
    v_mfma_f32_16x16x32_bf16 v[124:127], v[88:91], v[60:63], v[124:127]
    v_mfma_f32_16x16x32_bf16 v[160:163], v[88:91], v[64:67], v[160:163]
    v_mfma_f32_16x16x32_bf16 v[196:199], v[88:91], v[68:71], v[196:199]
    v_mfma_f32_16x16x32_bf16 v[232:235], v[88:91], v[72:75], v[232:235]
    ds_read_b64_tr_b16 v[88:89], v12 offset:96
    ds_read_b64_tr_b16 v[90:91], v12 offset:4704
    s_add_u32 m0, s31, 69632
    s_nop 0
    buffer_load_dwordx4 v4, s[16:19], s37 offen lds
    s_waitcnt lgkmcnt(12)
    v_mfma_f32_16x16x32_bf16 v[128:131], v[92:95], v[60:63], v[128:131]
    v_mfma_f32_16x16x32_bf16 v[164:167], v[92:95], v[64:67], v[164:167]
    v_mfma_f32_16x16x32_bf16 v[200:203], v[92:95], v[68:71], v[200:203]
    v_mfma_f32_16x16x32_bf16 v[236:239], v[92:95], v[72:75], v[236:239]
    ds_read_b64_tr_b16 v[92:93], v12 offset:128
    ds_read_b64_tr_b16 v[94:95], v12 offset:4736
    s_add_u32 m0, s31, 70656
    s_nop 0
    buffer_load_dwordx4 v5, s[16:19], s37 offen lds
    s_waitcnt lgkmcnt(12)
    v_mfma_f32_16x16x32_bf16 v[132:135], v[96:99], v[60:63], v[132:135]
    v_mfma_f32_16x16x32_bf16 v[168:171], v[96:99], v[64:67], v[168:171]
    v_mfma_f32_16x16x32_bf16 v[204:207], v[96:99], v[68:71], v[204:207]
    v_mfma_f32_16x16x32_bf16 v[240:243], v[96:99], v[72:75], v[240:243]
    ds_read_b64_tr_b16 v[96:97], v12 offset:160
    ds_read_b64_tr_b16 v[98:99], v12 offset:4768
    s_add_u32 m0, s31, 71680
    s_mov_b64 exec, 0xffff
    buffer_load_dwordx4 v6, s[16:19], s37 offen lds
    s_mov_b64 exec, -1
    s_waitcnt lgkmcnt(12)
    v_mfma_f32_16x16x32_bf16 v[136:139], v[100:103], v[60:63], v[136:139]
    v_mfma_f32_16x16x32_bf16 v[172:175], v[100:103], v[64:67], v[172:175]
    v_mfma_f32_16x16x32_bf16 v[208:211], v[100:103], v[68:71], v[208:211]
    v_mfma_f32_16x16x32_bf16 v[244:247], v[100:103], v[72:75], v[244:247]
    ds_read_b64_tr_b16 v[100:101], v12 offset:192
    ds_read_b64_tr_b16 v[102:103], v12 offset:4800
    s_waitcnt lgkmcnt(12)
    v_mfma_f32_16x16x32_bf16 v[140:143], v[104:107], v[60:63], v[140:143]
    v_mfma_f32_16x16x32_bf16 v[176:179], v[104:107], v[64:67], v[176:179]
    v_mfma_f32_16x16x32_bf16 v[212:215], v[104:107], v[68:71], v[212:215]
    v_mfma_f32_16x16x32_bf16 v[248:251], v[104:107], v[72:75], v[248:251]
    ds_read_b64_tr_b16 v[104:105], v12 offset:224
    ds_read_b64_tr_b16 v[106:107], v12 offset:4832
    s_waitcnt lgkmcnt(12)
    v_mfma_f32_16x16x32_bf16 v[144:147], v[108:111], v[60:63], v[144:147]
    v_mfma_f32_16x16x32_bf16 v[180:183], v[108:111], v[64:67], v[180:183]
    v_mfma_f32_16x16x32_bf16 v[216:219], v[108:111], v[68:71], v[216:219]
    v_mfma_f32_16x16x32_bf16 v[252:255], v[108:111], v[72:75], v[252:255]
    ds_read_b64_tr_b16 v[108:109], v12 offset:256
    ds_read_b64_tr_b16 v[110:111], v12 offset:4864
    s_waitcnt lgkmcnt(12)
    v_mfma_f32_16x16x32_bf16 v[112:115], v[76:79], v[44:47], v[112:115]
    v_mfma_f32_16x16x32_bf16 v[148:151], v[76:79], v[48:51], v[148:151]
    v_mfma_f32_16x16x32_bf16 v[184:187], v[76:79], v[52:55], v[184:187]
    v_mfma_f32_16x16x32_bf16 v[220:223], v[76:79], v[56:59], v[220:223]
    s_waitcnt vmcnt(5)
    s_barrier
    ds_read_b128 v[60:63], v9 offset:0
    ds_read_b128 v[64:67], v9 offset:1024
    ds_read_b128 v[68:71], v9 offset:2048
    ds_read_b128 v[72:75], v9 offset:3072
    ds_read_b64_tr_b16 v[76:77], v13 offset:0
    ds_read_b64_tr_b16 v[78:79], v13 offset:4608
    s_waitcnt lgkmcnt(12)
    v_mfma_f32_16x16x32_bf16 v[116:119], v[80:83], v[44:47], v[116:119]
    v_mfma_f32_16x16x32_bf16 v[152:155], v[80:83], v[48:51], v[152:155]
    v_mfma_f32_16x16x32_bf16 v[188:191], v[80:83], v[52:55], v[188:191]
    v_mfma_f32_16x16x32_bf16 v[224:227], v[80:83], v[56:59], v[224:227]
    ds_read_b64_tr_b16 v[80:81], v13 offset:32
    ds_read_b64_tr_b16 v[82:83], v13 offset:4640
    s_mov_b32 s36, 11264
    s_add_u32 m0, s30, 104448
    s_mov_b32 s37, 3244032
    buffer_load_dwordx4 v2, s[12:15], s36 offen lds
    s_waitcnt lgkmcnt(12)
    v_mfma_f32_16x16x32_bf16 v[120:123], v[84:87], v[44:47], v[120:123]
    v_mfma_f32_16x16x32_bf16 v[156:159], v[84:87], v[48:51], v[156:159]
    v_mfma_f32_16x16x32_bf16 v[192:195], v[84:87], v[52:55], v[192:195]
    v_mfma_f32_16x16x32_bf16 v[228:231], v[84:87], v[56:59], v[228:231]
    ds_read_b64_tr_b16 v[84:85], v13 offset:64
    ds_read_b64_tr_b16 v[86:87], v13 offset:4672
    s_add_u32 m0, s30, 105472
    s_nop 0
    buffer_load_dwordx4 v3, s[12:15], s36 offen lds
    s_waitcnt lgkmcnt(12)
    v_mfma_f32_16x16x32_bf16 v[124:127], v[88:91], v[44:47], v[124:127]
    v_mfma_f32_16x16x32_bf16 v[160:163], v[88:91], v[48:51], v[160:163]
    v_mfma_f32_16x16x32_bf16 v[196:199], v[88:91], v[52:55], v[196:199]
    v_mfma_f32_16x16x32_bf16 v[232:235], v[88:91], v[56:59], v[232:235]
    ds_read_b64_tr_b16 v[88:89], v13 offset:96
    ds_read_b64_tr_b16 v[90:91], v13 offset:4704
    s_add_u32 m0, s31, 104448
    s_nop 0
    buffer_load_dwordx4 v4, s[16:19], s37 offen lds
    s_waitcnt lgkmcnt(12)
    v_mfma_f32_16x16x32_bf16 v[128:131], v[92:95], v[44:47], v[128:131]
    v_mfma_f32_16x16x32_bf16 v[164:167], v[92:95], v[48:51], v[164:167]
    v_mfma_f32_16x16x32_bf16 v[200:203], v[92:95], v[52:55], v[200:203]
    v_mfma_f32_16x16x32_bf16 v[236:239], v[92:95], v[56:59], v[236:239]
    ds_read_b64_tr_b16 v[92:93], v13 offset:128
    ds_read_b64_tr_b16 v[94:95], v13 offset:4736
    s_add_u32 m0, s31, 105472
    s_nop 0
    buffer_load_dwordx4 v5, s[16:19], s37 offen lds
    s_waitcnt lgkmcnt(12)
    v_mfma_f32_16x16x32_bf16 v[132:135], v[96:99], v[44:47], v[132:135]
    v_mfma_f32_16x16x32_bf16 v[168:171], v[96:99], v[48:51], v[168:171]
    v_mfma_f32_16x16x32_bf16 v[204:207], v[96:99], v[52:55], v[204:207]
    v_mfma_f32_16x16x32_bf16 v[240:243], v[96:99], v[56:59], v[240:243]
    ds_read_b64_tr_b16 v[96:97], v13 offset:160
    ds_read_b64_tr_b16 v[98:99], v13 offset:4768
    s_add_u32 m0, s31, 106496
    s_mov_b64 exec, 0xffff
    buffer_load_dwordx4 v6, s[16:19], s37 offen lds
    s_mov_b64 exec, -1
    s_waitcnt lgkmcnt(12)
    v_mfma_f32_16x16x32_bf16 v[136:139], v[100:103], v[44:47], v[136:139]
    v_mfma_f32_16x16x32_bf16 v[172:175], v[100:103], v[48:51], v[172:175]
    v_mfma_f32_16x16x32_bf16 v[208:211], v[100:103], v[52:55], v[208:211]
    v_mfma_f32_16x16x32_bf16 v[244:247], v[100:103], v[56:59], v[244:247]
    ds_read_b64_tr_b16 v[100:101], v13 offset:192
    ds_read_b64_tr_b16 v[102:103], v13 offset:4800
    s_waitcnt lgkmcnt(12)
    v_mfma_f32_16x16x32_bf16 v[140:143], v[104:107], v[44:47], v[140:143]
    v_mfma_f32_16x16x32_bf16 v[176:179], v[104:107], v[48:51], v[176:179]
    v_mfma_f32_16x16x32_bf16 v[212:215], v[104:107], v[52:55], v[212:215]
    v_mfma_f32_16x16x32_bf16 v[248:251], v[104:107], v[56:59], v[248:251]
    ds_read_b64_tr_b16 v[104:105], v13 offset:224
    ds_read_b64_tr_b16 v[106:107], v13 offset:4832
    s_waitcnt lgkmcnt(12)
    v_mfma_f32_16x16x32_bf16 v[144:147], v[108:111], v[44:47], v[144:147]
    v_mfma_f32_16x16x32_bf16 v[180:183], v[108:111], v[48:51], v[180:183]
    v_mfma_f32_16x16x32_bf16 v[216:219], v[108:111], v[52:55], v[216:219]
    v_mfma_f32_16x16x32_bf16 v[252:255], v[108:111], v[56:59], v[252:255]
    ds_read_b64_tr_b16 v[108:109], v13 offset:256
    ds_read_b64_tr_b16 v[110:111], v13 offset:4864
    s_waitcnt lgkmcnt(12)
    v_mfma_f32_16x16x32_bf16 v[112:115], v[76:79], v[60:63], v[112:115]
    v_mfma_f32_16x16x32_bf16 v[148:151], v[76:79], v[64:67], v[148:151]
    v_mfma_f32_16x16x32_bf16 v[184:187], v[76:79], v[68:71], v[184:187]
    v_mfma_f32_16x16x32_bf16 v[220:223], v[76:79], v[72:75], v[220:223]
    s_waitcnt vmcnt(5)
    s_barrier
    ds_read_b128 v[44:47], v10 offset:0
    ds_read_b128 v[48:51], v10 offset:1024
    ds_read_b128 v[52:55], v10 offset:2048
    ds_read_b128 v[56:59], v10 offset:3072
    ds_read_b64_tr_b16 v[76:77], v14 offset:0
    ds_read_b64_tr_b16 v[78:79], v14 offset:4608
    s_waitcnt lgkmcnt(12)
    v_mfma_f32_16x16x32_bf16 v[116:119], v[80:83], v[60:63], v[116:119]
    v_mfma_f32_16x16x32_bf16 v[152:155], v[80:83], v[64:67], v[152:155]
    v_mfma_f32_16x16x32_bf16 v[188:191], v[80:83], v[68:71], v[188:191]
    v_mfma_f32_16x16x32_bf16 v[224:227], v[80:83], v[72:75], v[224:227]
    ds_read_b64_tr_b16 v[80:81], v14 offset:32
    ds_read_b64_tr_b16 v[82:83], v14 offset:4640
    s_mov_b32 s36, 12288
    s_add_u32 m0, s30, 0
    s_mov_b32 s37, 3538944
    buffer_load_dwordx4 v2, s[12:15], s36 offen lds
    s_waitcnt lgkmcnt(12)
    v_mfma_f32_16x16x32_bf16 v[120:123], v[84:87], v[60:63], v[120:123]
    v_mfma_f32_16x16x32_bf16 v[156:159], v[84:87], v[64:67], v[156:159]
    v_mfma_f32_16x16x32_bf16 v[192:195], v[84:87], v[68:71], v[192:195]
    v_mfma_f32_16x16x32_bf16 v[228:231], v[84:87], v[72:75], v[228:231]
    ds_read_b64_tr_b16 v[84:85], v14 offset:64
    ds_read_b64_tr_b16 v[86:87], v14 offset:4672
    s_add_u32 m0, s30, 1024
    s_nop 0
    buffer_load_dwordx4 v3, s[12:15], s36 offen lds
    s_waitcnt lgkmcnt(12)
    v_mfma_f32_16x16x32_bf16 v[124:127], v[88:91], v[60:63], v[124:127]
    v_mfma_f32_16x16x32_bf16 v[160:163], v[88:91], v[64:67], v[160:163]
    v_mfma_f32_16x16x32_bf16 v[196:199], v[88:91], v[68:71], v[196:199]
    v_mfma_f32_16x16x32_bf16 v[232:235], v[88:91], v[72:75], v[232:235]
    ds_read_b64_tr_b16 v[88:89], v14 offset:96
    ds_read_b64_tr_b16 v[90:91], v14 offset:4704
    s_add_u32 m0, s31, 0
    s_nop 0
    buffer_load_dwordx4 v4, s[16:19], s37 offen lds
    s_waitcnt lgkmcnt(12)
    v_mfma_f32_16x16x32_bf16 v[128:131], v[92:95], v[60:63], v[128:131]
    v_mfma_f32_16x16x32_bf16 v[164:167], v[92:95], v[64:67], v[164:167]
    v_mfma_f32_16x16x32_bf16 v[200:203], v[92:95], v[68:71], v[200:203]
    v_mfma_f32_16x16x32_bf16 v[236:239], v[92:95], v[72:75], v[236:239]
    ds_read_b64_tr_b16 v[92:93], v14 offset:128
    ds_read_b64_tr_b16 v[94:95], v14 offset:4736
    s_add_u32 m0, s31, 1024
    s_nop 0
    buffer_load_dwordx4 v5, s[16:19], s37 offen lds
    s_waitcnt lgkmcnt(12)
    v_mfma_f32_16x16x32_bf16 v[132:135], v[96:99], v[60:63], v[132:135]
    v_mfma_f32_16x16x32_bf16 v[168:171], v[96:99], v[64:67], v[168:171]
    v_mfma_f32_16x16x32_bf16 v[204:207], v[96:99], v[68:71], v[204:207]
    v_mfma_f32_16x16x32_bf16 v[240:243], v[96:99], v[72:75], v[240:243]
    ds_read_b64_tr_b16 v[96:97], v14 offset:160
    ds_read_b64_tr_b16 v[98:99], v14 offset:4768
    s_add_u32 m0, s31, 2048
    s_mov_b64 exec, 0xffff
    buffer_load_dwordx4 v6, s[16:19], s37 offen lds
    s_mov_b64 exec, -1
    s_waitcnt lgkmcnt(12)
    v_mfma_f32_16x16x32_bf16 v[136:139], v[100:103], v[60:63], v[136:139]
    v_mfma_f32_16x16x32_bf16 v[172:175], v[100:103], v[64:67], v[172:175]
    v_mfma_f32_16x16x32_bf16 v[208:211], v[100:103], v[68:71], v[208:211]
    v_mfma_f32_16x16x32_bf16 v[244:247], v[100:103], v[72:75], v[244:247]
    ds_read_b64_tr_b16 v[100:101], v14 offset:192
    ds_read_b64_tr_b16 v[102:103], v14 offset:4800
    s_waitcnt lgkmcnt(12)
    v_mfma_f32_16x16x32_bf16 v[140:143], v[104:107], v[60:63], v[140:143]
    v_mfma_f32_16x16x32_bf16 v[176:179], v[104:107], v[64:67], v[176:179]
    v_mfma_f32_16x16x32_bf16 v[212:215], v[104:107], v[68:71], v[212:215]
    v_mfma_f32_16x16x32_bf16 v[248:251], v[104:107], v[72:75], v[248:251]
    ds_read_b64_tr_b16 v[104:105], v14 offset:224
    ds_read_b64_tr_b16 v[106:107], v14 offset:4832
    s_waitcnt lgkmcnt(12)
    v_mfma_f32_16x16x32_bf16 v[144:147], v[108:111], v[60:63], v[144:147]
    v_mfma_f32_16x16x32_bf16 v[180:183], v[108:111], v[64:67], v[180:183]
    v_mfma_f32_16x16x32_bf16 v[216:219], v[108:111], v[68:71], v[216:219]
    v_mfma_f32_16x16x32_bf16 v[252:255], v[108:111], v[72:75], v[252:255]
    ds_read_b64_tr_b16 v[108:109], v14 offset:256
    ds_read_b64_tr_b16 v[110:111], v14 offset:4864
    s_waitcnt lgkmcnt(12)
    v_mfma_f32_16x16x32_bf16 v[112:115], v[76:79], v[44:47], v[112:115]
    v_mfma_f32_16x16x32_bf16 v[148:151], v[76:79], v[48:51], v[148:151]
    v_mfma_f32_16x16x32_bf16 v[184:187], v[76:79], v[52:55], v[184:187]
    v_mfma_f32_16x16x32_bf16 v[220:223], v[76:79], v[56:59], v[220:223]
    s_waitcnt vmcnt(5)
    s_barrier
    ds_read_b128 v[60:63], v11 offset:0
    ds_read_b128 v[64:67], v11 offset:1024
    ds_read_b128 v[68:71], v11 offset:2048
    ds_read_b128 v[72:75], v11 offset:3072
    ds_read_b64_tr_b16 v[76:77], v15 offset:0
    ds_read_b64_tr_b16 v[78:79], v15 offset:4608
    s_waitcnt lgkmcnt(12)
    v_mfma_f32_16x16x32_bf16 v[116:119], v[80:83], v[44:47], v[116:119]
    v_mfma_f32_16x16x32_bf16 v[152:155], v[80:83], v[48:51], v[152:155]
    v_mfma_f32_16x16x32_bf16 v[188:191], v[80:83], v[52:55], v[188:191]
    v_mfma_f32_16x16x32_bf16 v[224:227], v[80:83], v[56:59], v[224:227]
    ds_read_b64_tr_b16 v[80:81], v15 offset:32
    ds_read_b64_tr_b16 v[82:83], v15 offset:4640
    s_mov_b32 s36, 13312
    s_add_u32 m0, s30, 34816
    s_mov_b32 s37, 3833856
    buffer_load_dwordx4 v2, s[12:15], s36 offen lds
    s_waitcnt lgkmcnt(12)
    v_mfma_f32_16x16x32_bf16 v[120:123], v[84:87], v[44:47], v[120:123]
    v_mfma_f32_16x16x32_bf16 v[156:159], v[84:87], v[48:51], v[156:159]
    v_mfma_f32_16x16x32_bf16 v[192:195], v[84:87], v[52:55], v[192:195]
    v_mfma_f32_16x16x32_bf16 v[228:231], v[84:87], v[56:59], v[228:231]
    ds_read_b64_tr_b16 v[84:85], v15 offset:64
    ds_read_b64_tr_b16 v[86:87], v15 offset:4672
    s_add_u32 m0, s30, 35840
    s_nop 0
    buffer_load_dwordx4 v3, s[12:15], s36 offen lds
    s_waitcnt lgkmcnt(12)
    v_mfma_f32_16x16x32_bf16 v[124:127], v[88:91], v[44:47], v[124:127]
    v_mfma_f32_16x16x32_bf16 v[160:163], v[88:91], v[48:51], v[160:163]
    v_mfma_f32_16x16x32_bf16 v[196:199], v[88:91], v[52:55], v[196:199]
    v_mfma_f32_16x16x32_bf16 v[232:235], v[88:91], v[56:59], v[232:235]
    ds_read_b64_tr_b16 v[88:89], v15 offset:96
    ds_read_b64_tr_b16 v[90:91], v15 offset:4704
    s_add_u32 m0, s31, 34816
    s_nop 0
    buffer_load_dwordx4 v4, s[16:19], s37 offen lds
    s_waitcnt lgkmcnt(12)
    v_mfma_f32_16x16x32_bf16 v[128:131], v[92:95], v[44:47], v[128:131]
    v_mfma_f32_16x16x32_bf16 v[164:167], v[92:95], v[48:51], v[164:167]
    v_mfma_f32_16x16x32_bf16 v[200:203], v[92:95], v[52:55], v[200:203]
    v_mfma_f32_16x16x32_bf16 v[236:239], v[92:95], v[56:59], v[236:239]
    ds_read_b64_tr_b16 v[92:93], v15 offset:128
    ds_read_b64_tr_b16 v[94:95], v15 offset:4736
    s_add_u32 m0, s31, 35840
    s_nop 0
    buffer_load_dwordx4 v5, s[16:19], s37 offen lds
    s_waitcnt lgkmcnt(12)
    v_mfma_f32_16x16x32_bf16 v[132:135], v[96:99], v[44:47], v[132:135]
    v_mfma_f32_16x16x32_bf16 v[168:171], v[96:99], v[48:51], v[168:171]
    v_mfma_f32_16x16x32_bf16 v[204:207], v[96:99], v[52:55], v[204:207]
    v_mfma_f32_16x16x32_bf16 v[240:243], v[96:99], v[56:59], v[240:243]
    ds_read_b64_tr_b16 v[96:97], v15 offset:160
    ds_read_b64_tr_b16 v[98:99], v15 offset:4768
    s_add_u32 m0, s31, 36864
    s_mov_b64 exec, 0xffff
    buffer_load_dwordx4 v6, s[16:19], s37 offen lds
    s_mov_b64 exec, -1
    s_waitcnt lgkmcnt(12)
    v_mfma_f32_16x16x32_bf16 v[136:139], v[100:103], v[44:47], v[136:139]
    v_mfma_f32_16x16x32_bf16 v[172:175], v[100:103], v[48:51], v[172:175]
    v_mfma_f32_16x16x32_bf16 v[208:211], v[100:103], v[52:55], v[208:211]
    v_mfma_f32_16x16x32_bf16 v[244:247], v[100:103], v[56:59], v[244:247]
    ds_read_b64_tr_b16 v[100:101], v15 offset:192
    ds_read_b64_tr_b16 v[102:103], v15 offset:4800
    s_waitcnt lgkmcnt(12)
    v_mfma_f32_16x16x32_bf16 v[140:143], v[104:107], v[44:47], v[140:143]
    v_mfma_f32_16x16x32_bf16 v[176:179], v[104:107], v[48:51], v[176:179]
    v_mfma_f32_16x16x32_bf16 v[212:215], v[104:107], v[52:55], v[212:215]
    v_mfma_f32_16x16x32_bf16 v[248:251], v[104:107], v[56:59], v[248:251]
    ds_read_b64_tr_b16 v[104:105], v15 offset:224
    ds_read_b64_tr_b16 v[106:107], v15 offset:4832
    s_waitcnt lgkmcnt(12)
    v_mfma_f32_16x16x32_bf16 v[144:147], v[108:111], v[44:47], v[144:147]
    v_mfma_f32_16x16x32_bf16 v[180:183], v[108:111], v[48:51], v[180:183]
    v_mfma_f32_16x16x32_bf16 v[216:219], v[108:111], v[52:55], v[216:219]
    v_mfma_f32_16x16x32_bf16 v[252:255], v[108:111], v[56:59], v[252:255]
    ds_read_b64_tr_b16 v[108:109], v15 offset:256
    ds_read_b64_tr_b16 v[110:111], v15 offset:4864
    s_waitcnt lgkmcnt(12)
    v_mfma_f32_16x16x32_bf16 v[112:115], v[76:79], v[60:63], v[112:115]
    v_mfma_f32_16x16x32_bf16 v[148:151], v[76:79], v[64:67], v[148:151]
    v_mfma_f32_16x16x32_bf16 v[184:187], v[76:79], v[68:71], v[184:187]
    v_mfma_f32_16x16x32_bf16 v[220:223], v[76:79], v[72:75], v[220:223]
    s_waitcnt vmcnt(5)
    s_barrier
    ds_read_b128 v[44:47], v8 offset:0
    ds_read_b128 v[48:51], v8 offset:1024
    ds_read_b128 v[52:55], v8 offset:2048
    ds_read_b128 v[56:59], v8 offset:3072
    ds_read_b64_tr_b16 v[76:77], v12 offset:0
    ds_read_b64_tr_b16 v[78:79], v12 offset:4608
    s_waitcnt lgkmcnt(12)
    v_mfma_f32_16x16x32_bf16 v[116:119], v[80:83], v[60:63], v[116:119]
    v_mfma_f32_16x16x32_bf16 v[152:155], v[80:83], v[64:67], v[152:155]
    v_mfma_f32_16x16x32_bf16 v[188:191], v[80:83], v[68:71], v[188:191]
    v_mfma_f32_16x16x32_bf16 v[224:227], v[80:83], v[72:75], v[224:227]
    ds_read_b64_tr_b16 v[80:81], v12 offset:32
    ds_read_b64_tr_b16 v[82:83], v12 offset:4640
    s_mov_b32 s36, 14336
    s_add_u32 m0, s30, 69632
    s_mov_b32 s37, 4128768
    buffer_load_dwordx4 v2, s[12:15], s36 offen lds
    s_waitcnt lgkmcnt(12)
    v_mfma_f32_16x16x32_bf16 v[120:123], v[84:87], v[60:63], v[120:123]
    v_mfma_f32_16x16x32_bf16 v[156:159], v[84:87], v[64:67], v[156:159]
    v_mfma_f32_16x16x32_bf16 v[192:195], v[84:87], v[68:71], v[192:195]
    v_mfma_f32_16x16x32_bf16 v[228:231], v[84:87], v[72:75], v[228:231]
    ds_read_b64_tr_b16 v[84:85], v12 offset:64
    ds_read_b64_tr_b16 v[86:87], v12 offset:4672
    s_add_u32 m0, s30, 70656
    s_nop 0
    buffer_load_dwordx4 v3, s[12:15], s36 offen lds
    s_waitcnt lgkmcnt(12)
    v_mfma_f32_16x16x32_bf16 v[124:127], v[88:91], v[60:63], v[124:127]
    v_mfma_f32_16x16x32_bf16 v[160:163], v[88:91], v[64:67], v[160:163]
    v_mfma_f32_16x16x32_bf16 v[196:199], v[88:91], v[68:71], v[196:199]
    v_mfma_f32_16x16x32_bf16 v[232:235], v[88:91], v[72:75], v[232:235]
    ds_read_b64_tr_b16 v[88:89], v12 offset:96
    ds_read_b64_tr_b16 v[90:91], v12 offset:4704
    s_add_u32 m0, s31, 69632
    s_nop 0
    buffer_load_dwordx4 v4, s[16:19], s37 offen lds
    s_waitcnt lgkmcnt(12)
    v_mfma_f32_16x16x32_bf16 v[128:131], v[92:95], v[60:63], v[128:131]
    v_mfma_f32_16x16x32_bf16 v[164:167], v[92:95], v[64:67], v[164:167]
    v_mfma_f32_16x16x32_bf16 v[200:203], v[92:95], v[68:71], v[200:203]
    v_mfma_f32_16x16x32_bf16 v[236:239], v[92:95], v[72:75], v[236:239]
    ds_read_b64_tr_b16 v[92:93], v12 offset:128
    ds_read_b64_tr_b16 v[94:95], v12 offset:4736
    s_add_u32 m0, s31, 70656
    s_nop 0
    buffer_load_dwordx4 v5, s[16:19], s37 offen lds
    s_waitcnt lgkmcnt(12)
    v_mfma_f32_16x16x32_bf16 v[132:135], v[96:99], v[60:63], v[132:135]
    v_mfma_f32_16x16x32_bf16 v[168:171], v[96:99], v[64:67], v[168:171]
    v_mfma_f32_16x16x32_bf16 v[204:207], v[96:99], v[68:71], v[204:207]
    v_mfma_f32_16x16x32_bf16 v[240:243], v[96:99], v[72:75], v[240:243]
    ds_read_b64_tr_b16 v[96:97], v12 offset:160
    ds_read_b64_tr_b16 v[98:99], v12 offset:4768
    s_add_u32 m0, s31, 71680
    s_mov_b64 exec, 0xffff
    buffer_load_dwordx4 v6, s[16:19], s37 offen lds
    s_mov_b64 exec, -1
    s_waitcnt lgkmcnt(12)
    v_mfma_f32_16x16x32_bf16 v[136:139], v[100:103], v[60:63], v[136:139]
    v_mfma_f32_16x16x32_bf16 v[172:175], v[100:103], v[64:67], v[172:175]
    v_mfma_f32_16x16x32_bf16 v[208:211], v[100:103], v[68:71], v[208:211]
    v_mfma_f32_16x16x32_bf16 v[244:247], v[100:103], v[72:75], v[244:247]
    ds_read_b64_tr_b16 v[100:101], v12 offset:192
    ds_read_b64_tr_b16 v[102:103], v12 offset:4800
    s_waitcnt lgkmcnt(12)
    v_mfma_f32_16x16x32_bf16 v[140:143], v[104:107], v[60:63], v[140:143]
    v_mfma_f32_16x16x32_bf16 v[176:179], v[104:107], v[64:67], v[176:179]
    v_mfma_f32_16x16x32_bf16 v[212:215], v[104:107], v[68:71], v[212:215]
    v_mfma_f32_16x16x32_bf16 v[248:251], v[104:107], v[72:75], v[248:251]
    ds_read_b64_tr_b16 v[104:105], v12 offset:224
    ds_read_b64_tr_b16 v[106:107], v12 offset:4832
    s_waitcnt lgkmcnt(12)
    v_mfma_f32_16x16x32_bf16 v[144:147], v[108:111], v[60:63], v[144:147]
    v_mfma_f32_16x16x32_bf16 v[180:183], v[108:111], v[64:67], v[180:183]
    v_mfma_f32_16x16x32_bf16 v[216:219], v[108:111], v[68:71], v[216:219]
    v_mfma_f32_16x16x32_bf16 v[252:255], v[108:111], v[72:75], v[252:255]
    ds_read_b64_tr_b16 v[108:109], v12 offset:256
    ds_read_b64_tr_b16 v[110:111], v12 offset:4864
    s_waitcnt lgkmcnt(12)
    v_mfma_f32_16x16x32_bf16 v[112:115], v[76:79], v[44:47], v[112:115]
    v_mfma_f32_16x16x32_bf16 v[148:151], v[76:79], v[48:51], v[148:151]
    v_mfma_f32_16x16x32_bf16 v[184:187], v[76:79], v[52:55], v[184:187]
    v_mfma_f32_16x16x32_bf16 v[220:223], v[76:79], v[56:59], v[220:223]
    s_waitcnt vmcnt(5)
    s_barrier
    ds_read_b128 v[60:63], v9 offset:0
    ds_read_b128 v[64:67], v9 offset:1024
    ds_read_b128 v[68:71], v9 offset:2048
    ds_read_b128 v[72:75], v9 offset:3072
    ds_read_b64_tr_b16 v[76:77], v13 offset:0
    ds_read_b64_tr_b16 v[78:79], v13 offset:4608
    s_waitcnt lgkmcnt(12)
    v_mfma_f32_16x16x32_bf16 v[116:119], v[80:83], v[44:47], v[116:119]
    v_mfma_f32_16x16x32_bf16 v[152:155], v[80:83], v[48:51], v[152:155]
    v_mfma_f32_16x16x32_bf16 v[188:191], v[80:83], v[52:55], v[188:191]
    v_mfma_f32_16x16x32_bf16 v[224:227], v[80:83], v[56:59], v[224:227]
    ds_read_b64_tr_b16 v[80:81], v13 offset:32
    ds_read_b64_tr_b16 v[82:83], v13 offset:4640
    s_mov_b32 s36, 15360
    s_add_u32 m0, s30, 104448
    s_mov_b32 s37, 4423680
    buffer_load_dwordx4 v2, s[12:15], s36 offen lds
    s_waitcnt lgkmcnt(12)
    v_mfma_f32_16x16x32_bf16 v[120:123], v[84:87], v[44:47], v[120:123]
    v_mfma_f32_16x16x32_bf16 v[156:159], v[84:87], v[48:51], v[156:159]
    v_mfma_f32_16x16x32_bf16 v[192:195], v[84:87], v[52:55], v[192:195]
    v_mfma_f32_16x16x32_bf16 v[228:231], v[84:87], v[56:59], v[228:231]
    ds_read_b64_tr_b16 v[84:85], v13 offset:64
    ds_read_b64_tr_b16 v[86:87], v13 offset:4672
    s_add_u32 m0, s30, 105472
    s_nop 0
    buffer_load_dwordx4 v3, s[12:15], s36 offen lds
    s_waitcnt lgkmcnt(12)
    v_mfma_f32_16x16x32_bf16 v[124:127], v[88:91], v[44:47], v[124:127]
    v_mfma_f32_16x16x32_bf16 v[160:163], v[88:91], v[48:51], v[160:163]
    v_mfma_f32_16x16x32_bf16 v[196:199], v[88:91], v[52:55], v[196:199]
    v_mfma_f32_16x16x32_bf16 v[232:235], v[88:91], v[56:59], v[232:235]
    ds_read_b64_tr_b16 v[88:89], v13 offset:96
    ds_read_b64_tr_b16 v[90:91], v13 offset:4704
    s_add_u32 m0, s31, 104448
    s_nop 0
    buffer_load_dwordx4 v4, s[16:19], s37 offen lds
    s_waitcnt lgkmcnt(12)
    v_mfma_f32_16x16x32_bf16 v[128:131], v[92:95], v[44:47], v[128:131]
    v_mfma_f32_16x16x32_bf16 v[164:167], v[92:95], v[48:51], v[164:167]
    v_mfma_f32_16x16x32_bf16 v[200:203], v[92:95], v[52:55], v[200:203]
    v_mfma_f32_16x16x32_bf16 v[236:239], v[92:95], v[56:59], v[236:239]
    ds_read_b64_tr_b16 v[92:93], v13 offset:128
    ds_read_b64_tr_b16 v[94:95], v13 offset:4736
    s_add_u32 m0, s31, 105472
    s_nop 0
    buffer_load_dwordx4 v5, s[16:19], s37 offen lds
    s_waitcnt lgkmcnt(12)
    v_mfma_f32_16x16x32_bf16 v[132:135], v[96:99], v[44:47], v[132:135]
    v_mfma_f32_16x16x32_bf16 v[168:171], v[96:99], v[48:51], v[168:171]
    v_mfma_f32_16x16x32_bf16 v[204:207], v[96:99], v[52:55], v[204:207]
    v_mfma_f32_16x16x32_bf16 v[240:243], v[96:99], v[56:59], v[240:243]
    ds_read_b64_tr_b16 v[96:97], v13 offset:160
    ds_read_b64_tr_b16 v[98:99], v13 offset:4768
    s_add_u32 m0, s31, 106496
    s_mov_b64 exec, 0xffff
    buffer_load_dwordx4 v6, s[16:19], s37 offen lds
    s_mov_b64 exec, -1
    s_waitcnt lgkmcnt(12)
    v_mfma_f32_16x16x32_bf16 v[136:139], v[100:103], v[44:47], v[136:139]
    v_mfma_f32_16x16x32_bf16 v[172:175], v[100:103], v[48:51], v[172:175]
    v_mfma_f32_16x16x32_bf16 v[208:211], v[100:103], v[52:55], v[208:211]
    v_mfma_f32_16x16x32_bf16 v[244:247], v[100:103], v[56:59], v[244:247]
    ds_read_b64_tr_b16 v[100:101], v13 offset:192
    ds_read_b64_tr_b16 v[102:103], v13 offset:4800
    s_waitcnt lgkmcnt(12)
    v_mfma_f32_16x16x32_bf16 v[140:143], v[104:107], v[44:47], v[140:143]
    v_mfma_f32_16x16x32_bf16 v[176:179], v[104:107], v[48:51], v[176:179]
    v_mfma_f32_16x16x32_bf16 v[212:215], v[104:107], v[52:55], v[212:215]
    v_mfma_f32_16x16x32_bf16 v[248:251], v[104:107], v[56:59], v[248:251]
    ds_read_b64_tr_b16 v[104:105], v13 offset:224
    ds_read_b64_tr_b16 v[106:107], v13 offset:4832
    s_waitcnt lgkmcnt(12)
    v_mfma_f32_16x16x32_bf16 v[144:147], v[108:111], v[44:47], v[144:147]
    v_mfma_f32_16x16x32_bf16 v[180:183], v[108:111], v[48:51], v[180:183]
    v_mfma_f32_16x16x32_bf16 v[216:219], v[108:111], v[52:55], v[216:219]
    v_mfma_f32_16x16x32_bf16 v[252:255], v[108:111], v[56:59], v[252:255]
    ds_read_b64_tr_b16 v[108:109], v13 offset:256
    ds_read_b64_tr_b16 v[110:111], v13 offset:4864
    s_waitcnt lgkmcnt(12)
    v_mfma_f32_16x16x32_bf16 v[112:115], v[76:79], v[60:63], v[112:115]
    v_mfma_f32_16x16x32_bf16 v[148:151], v[76:79], v[64:67], v[148:151]
    v_mfma_f32_16x16x32_bf16 v[184:187], v[76:79], v[68:71], v[184:187]
    v_mfma_f32_16x16x32_bf16 v[220:223], v[76:79], v[72:75], v[220:223]
    s_waitcnt vmcnt(5)
    s_barrier
    ds_read_b128 v[44:47], v10 offset:0
    ds_read_b128 v[48:51], v10 offset:1024
    ds_read_b128 v[52:55], v10 offset:2048
    ds_read_b128 v[56:59], v10 offset:3072
    ds_read_b64_tr_b16 v[76:77], v14 offset:0
    ds_read_b64_tr_b16 v[78:79], v14 offset:4608
    s_waitcnt lgkmcnt(12)
    v_mfma_f32_16x16x32_bf16 v[116:119], v[80:83], v[60:63], v[116:119]
    v_mfma_f32_16x16x32_bf16 v[152:155], v[80:83], v[64:67], v[152:155]
    v_mfma_f32_16x16x32_bf16 v[188:191], v[80:83], v[68:71], v[188:191]
    v_mfma_f32_16x16x32_bf16 v[224:227], v[80:83], v[72:75], v[224:227]
    ds_read_b64_tr_b16 v[80:81], v14 offset:32
    ds_read_b64_tr_b16 v[82:83], v14 offset:4640
    s_mov_b32 s36, 16384
    s_add_u32 m0, s30, 0
    s_mov_b32 s37, 4718592
    buffer_load_dwordx4 v2, s[12:15], s36 offen lds
    s_waitcnt lgkmcnt(12)
    v_mfma_f32_16x16x32_bf16 v[120:123], v[84:87], v[60:63], v[120:123]
    v_mfma_f32_16x16x32_bf16 v[156:159], v[84:87], v[64:67], v[156:159]
    v_mfma_f32_16x16x32_bf16 v[192:195], v[84:87], v[68:71], v[192:195]
    v_mfma_f32_16x16x32_bf16 v[228:231], v[84:87], v[72:75], v[228:231]
    ds_read_b64_tr_b16 v[84:85], v14 offset:64
    ds_read_b64_tr_b16 v[86:87], v14 offset:4672
    s_add_u32 m0, s30, 1024
    s_nop 0
    buffer_load_dwordx4 v3, s[12:15], s36 offen lds
    s_waitcnt lgkmcnt(12)
    v_mfma_f32_16x16x32_bf16 v[124:127], v[88:91], v[60:63], v[124:127]
    v_mfma_f32_16x16x32_bf16 v[160:163], v[88:91], v[64:67], v[160:163]
    v_mfma_f32_16x16x32_bf16 v[196:199], v[88:91], v[68:71], v[196:199]
    v_mfma_f32_16x16x32_bf16 v[232:235], v[88:91], v[72:75], v[232:235]
    ds_read_b64_tr_b16 v[88:89], v14 offset:96
    ds_read_b64_tr_b16 v[90:91], v14 offset:4704
    s_add_u32 m0, s31, 0
    s_nop 0
    buffer_load_dwordx4 v4, s[16:19], s37 offen lds
    s_waitcnt lgkmcnt(12)
    v_mfma_f32_16x16x32_bf16 v[128:131], v[92:95], v[60:63], v[128:131]
    v_mfma_f32_16x16x32_bf16 v[164:167], v[92:95], v[64:67], v[164:167]
    v_mfma_f32_16x16x32_bf16 v[200:203], v[92:95], v[68:71], v[200:203]
    v_mfma_f32_16x16x32_bf16 v[236:239], v[92:95], v[72:75], v[236:239]
    ds_read_b64_tr_b16 v[92:93], v14 offset:128
    ds_read_b64_tr_b16 v[94:95], v14 offset:4736
    s_add_u32 m0, s31, 1024
    s_nop 0
    buffer_load_dwordx4 v5, s[16:19], s37 offen lds
    s_waitcnt lgkmcnt(12)
    v_mfma_f32_16x16x32_bf16 v[132:135], v[96:99], v[60:63], v[132:135]
    v_mfma_f32_16x16x32_bf16 v[168:171], v[96:99], v[64:67], v[168:171]
    v_mfma_f32_16x16x32_bf16 v[204:207], v[96:99], v[68:71], v[204:207]
    v_mfma_f32_16x16x32_bf16 v[240:243], v[96:99], v[72:75], v[240:243]
    ds_read_b64_tr_b16 v[96:97], v14 offset:160
    ds_read_b64_tr_b16 v[98:99], v14 offset:4768
    s_add_u32 m0, s31, 2048
    s_mov_b64 exec, 0xffff
    buffer_load_dwordx4 v6, s[16:19], s37 offen lds
    s_mov_b64 exec, -1
    s_waitcnt lgkmcnt(12)
    v_mfma_f32_16x16x32_bf16 v[136:139], v[100:103], v[60:63], v[136:139]
    v_mfma_f32_16x16x32_bf16 v[172:175], v[100:103], v[64:67], v[172:175]
    v_mfma_f32_16x16x32_bf16 v[208:211], v[100:103], v[68:71], v[208:211]
    v_mfma_f32_16x16x32_bf16 v[244:247], v[100:103], v[72:75], v[244:247]
    ds_read_b64_tr_b16 v[100:101], v14 offset:192
    ds_read_b64_tr_b16 v[102:103], v14 offset:4800
    s_waitcnt lgkmcnt(12)
    v_mfma_f32_16x16x32_bf16 v[140:143], v[104:107], v[60:63], v[140:143]
    v_mfma_f32_16x16x32_bf16 v[176:179], v[104:107], v[64:67], v[176:179]
    v_mfma_f32_16x16x32_bf16 v[212:215], v[104:107], v[68:71], v[212:215]
    v_mfma_f32_16x16x32_bf16 v[248:251], v[104:107], v[72:75], v[248:251]
    ds_read_b64_tr_b16 v[104:105], v14 offset:224
    ds_read_b64_tr_b16 v[106:107], v14 offset:4832
    s_waitcnt lgkmcnt(12)
    v_mfma_f32_16x16x32_bf16 v[144:147], v[108:111], v[60:63], v[144:147]
    v_mfma_f32_16x16x32_bf16 v[180:183], v[108:111], v[64:67], v[180:183]
    v_mfma_f32_16x16x32_bf16 v[216:219], v[108:111], v[68:71], v[216:219]
    v_mfma_f32_16x16x32_bf16 v[252:255], v[108:111], v[72:75], v[252:255]
    ds_read_b64_tr_b16 v[108:109], v14 offset:256
    ds_read_b64_tr_b16 v[110:111], v14 offset:4864
    s_waitcnt lgkmcnt(12)
    v_mfma_f32_16x16x32_bf16 v[112:115], v[76:79], v[44:47], v[112:115]
    v_mfma_f32_16x16x32_bf16 v[148:151], v[76:79], v[48:51], v[148:151]
    v_mfma_f32_16x16x32_bf16 v[184:187], v[76:79], v[52:55], v[184:187]
    v_mfma_f32_16x16x32_bf16 v[220:223], v[76:79], v[56:59], v[220:223]
    s_waitcnt vmcnt(5)
    s_barrier
    ds_read_b128 v[60:63], v11 offset:0
    ds_read_b128 v[64:67], v11 offset:1024
    ds_read_b128 v[68:71], v11 offset:2048
    ds_read_b128 v[72:75], v11 offset:3072
    ds_read_b64_tr_b16 v[76:77], v15 offset:0
    ds_read_b64_tr_b16 v[78:79], v15 offset:4608
    s_waitcnt lgkmcnt(12)
    v_mfma_f32_16x16x32_bf16 v[116:119], v[80:83], v[44:47], v[116:119]
    v_mfma_f32_16x16x32_bf16 v[152:155], v[80:83], v[48:51], v[152:155]
    v_mfma_f32_16x16x32_bf16 v[188:191], v[80:83], v[52:55], v[188:191]
    v_mfma_f32_16x16x32_bf16 v[224:227], v[80:83], v[56:59], v[224:227]
    ds_read_b64_tr_b16 v[80:81], v15 offset:32
    ds_read_b64_tr_b16 v[82:83], v15 offset:4640
    s_mov_b32 s36, 17408
    s_add_u32 m0, s30, 34816
    s_mov_b32 s37, 5013504
    buffer_load_dwordx4 v2, s[12:15], s36 offen lds
    s_waitcnt lgkmcnt(12)
    v_mfma_f32_16x16x32_bf16 v[120:123], v[84:87], v[44:47], v[120:123]
    v_mfma_f32_16x16x32_bf16 v[156:159], v[84:87], v[48:51], v[156:159]
    v_mfma_f32_16x16x32_bf16 v[192:195], v[84:87], v[52:55], v[192:195]
    v_mfma_f32_16x16x32_bf16 v[228:231], v[84:87], v[56:59], v[228:231]
    ds_read_b64_tr_b16 v[84:85], v15 offset:64
    ds_read_b64_tr_b16 v[86:87], v15 offset:4672
    s_add_u32 m0, s30, 35840
    s_nop 0
    buffer_load_dwordx4 v3, s[12:15], s36 offen lds
    s_waitcnt lgkmcnt(12)
    v_mfma_f32_16x16x32_bf16 v[124:127], v[88:91], v[44:47], v[124:127]
    v_mfma_f32_16x16x32_bf16 v[160:163], v[88:91], v[48:51], v[160:163]
    v_mfma_f32_16x16x32_bf16 v[196:199], v[88:91], v[52:55], v[196:199]
    v_mfma_f32_16x16x32_bf16 v[232:235], v[88:91], v[56:59], v[232:235]
    ds_read_b64_tr_b16 v[88:89], v15 offset:96
    ds_read_b64_tr_b16 v[90:91], v15 offset:4704
    s_add_u32 m0, s31, 34816
    s_nop 0
    buffer_load_dwordx4 v4, s[16:19], s37 offen lds
    s_waitcnt lgkmcnt(12)
    v_mfma_f32_16x16x32_bf16 v[128:131], v[92:95], v[44:47], v[128:131]
    v_mfma_f32_16x16x32_bf16 v[164:167], v[92:95], v[48:51], v[164:167]
    v_mfma_f32_16x16x32_bf16 v[200:203], v[92:95], v[52:55], v[200:203]
    v_mfma_f32_16x16x32_bf16 v[236:239], v[92:95], v[56:59], v[236:239]
    ds_read_b64_tr_b16 v[92:93], v15 offset:128
    ds_read_b64_tr_b16 v[94:95], v15 offset:4736
    s_add_u32 m0, s31, 35840
    s_nop 0
    buffer_load_dwordx4 v5, s[16:19], s37 offen lds
    s_waitcnt lgkmcnt(12)
    v_mfma_f32_16x16x32_bf16 v[132:135], v[96:99], v[44:47], v[132:135]
    v_mfma_f32_16x16x32_bf16 v[168:171], v[96:99], v[48:51], v[168:171]
    v_mfma_f32_16x16x32_bf16 v[204:207], v[96:99], v[52:55], v[204:207]
    v_mfma_f32_16x16x32_bf16 v[240:243], v[96:99], v[56:59], v[240:243]
    ds_read_b64_tr_b16 v[96:97], v15 offset:160
    ds_read_b64_tr_b16 v[98:99], v15 offset:4768
    s_add_u32 m0, s31, 36864
    s_mov_b64 exec, 0xffff
    buffer_load_dwordx4 v6, s[16:19], s37 offen lds
    s_mov_b64 exec, -1
    s_waitcnt lgkmcnt(12)
    v_mfma_f32_16x16x32_bf16 v[136:139], v[100:103], v[44:47], v[136:139]
    v_mfma_f32_16x16x32_bf16 v[172:175], v[100:103], v[48:51], v[172:175]
    v_mfma_f32_16x16x32_bf16 v[208:211], v[100:103], v[52:55], v[208:211]
    v_mfma_f32_16x16x32_bf16 v[244:247], v[100:103], v[56:59], v[244:247]
    ds_read_b64_tr_b16 v[100:101], v15 offset:192
    ds_read_b64_tr_b16 v[102:103], v15 offset:4800
    s_waitcnt lgkmcnt(12)
    v_mfma_f32_16x16x32_bf16 v[140:143], v[104:107], v[44:47], v[140:143]
    v_mfma_f32_16x16x32_bf16 v[176:179], v[104:107], v[48:51], v[176:179]
    v_mfma_f32_16x16x32_bf16 v[212:215], v[104:107], v[52:55], v[212:215]
    v_mfma_f32_16x16x32_bf16 v[248:251], v[104:107], v[56:59], v[248:251]
    ds_read_b64_tr_b16 v[104:105], v15 offset:224
    ds_read_b64_tr_b16 v[106:107], v15 offset:4832
    s_waitcnt lgkmcnt(12)
    v_mfma_f32_16x16x32_bf16 v[144:147], v[108:111], v[44:47], v[144:147]
    v_mfma_f32_16x16x32_bf16 v[180:183], v[108:111], v[48:51], v[180:183]
    v_mfma_f32_16x16x32_bf16 v[216:219], v[108:111], v[52:55], v[216:219]
    v_mfma_f32_16x16x32_bf16 v[252:255], v[108:111], v[56:59], v[252:255]
    ds_read_b64_tr_b16 v[108:109], v15 offset:256
    ds_read_b64_tr_b16 v[110:111], v15 offset:4864
    s_waitcnt lgkmcnt(12)
    v_mfma_f32_16x16x32_bf16 v[112:115], v[76:79], v[60:63], v[112:115]
    v_mfma_f32_16x16x32_bf16 v[148:151], v[76:79], v[64:67], v[148:151]
    v_mfma_f32_16x16x32_bf16 v[184:187], v[76:79], v[68:71], v[184:187]
    v_mfma_f32_16x16x32_bf16 v[220:223], v[76:79], v[72:75], v[220:223]
    s_waitcnt vmcnt(5)
    s_barrier
    ds_read_b128 v[44:47], v8 offset:0
    ds_read_b128 v[48:51], v8 offset:1024
    ds_read_b128 v[52:55], v8 offset:2048
    ds_read_b128 v[56:59], v8 offset:3072
    ds_read_b64_tr_b16 v[76:77], v12 offset:0
    ds_read_b64_tr_b16 v[78:79], v12 offset:4608
    s_waitcnt lgkmcnt(12)
    v_mfma_f32_16x16x32_bf16 v[116:119], v[80:83], v[60:63], v[116:119]
    v_mfma_f32_16x16x32_bf16 v[152:155], v[80:83], v[64:67], v[152:155]
    v_mfma_f32_16x16x32_bf16 v[188:191], v[80:83], v[68:71], v[188:191]
    v_mfma_f32_16x16x32_bf16 v[224:227], v[80:83], v[72:75], v[224:227]
    ds_read_b64_tr_b16 v[80:81], v12 offset:32
    ds_read_b64_tr_b16 v[82:83], v12 offset:4640
    s_waitcnt lgkmcnt(12)
    v_mfma_f32_16x16x32_bf16 v[120:123], v[84:87], v[60:63], v[120:123]
    v_mfma_f32_16x16x32_bf16 v[156:159], v[84:87], v[64:67], v[156:159]
    v_mfma_f32_16x16x32_bf16 v[192:195], v[84:87], v[68:71], v[192:195]
    v_mfma_f32_16x16x32_bf16 v[228:231], v[84:87], v[72:75], v[228:231]
    ds_read_b64_tr_b16 v[84:85], v12 offset:64
    ds_read_b64_tr_b16 v[86:87], v12 offset:4672
    s_waitcnt lgkmcnt(12)
    v_mfma_f32_16x16x32_bf16 v[124:127], v[88:91], v[60:63], v[124:127]
    v_mfma_f32_16x16x32_bf16 v[160:163], v[88:91], v[64:67], v[160:163]
    v_mfma_f32_16x16x32_bf16 v[196:199], v[88:91], v[68:71], v[196:199]
    v_mfma_f32_16x16x32_bf16 v[232:235], v[88:91], v[72:75], v[232:235]
    ds_read_b64_tr_b16 v[88:89], v12 offset:96
    ds_read_b64_tr_b16 v[90:91], v12 offset:4704
    s_waitcnt lgkmcnt(12)
    v_mfma_f32_16x16x32_bf16 v[128:131], v[92:95], v[60:63], v[128:131]
    v_mfma_f32_16x16x32_bf16 v[164:167], v[92:95], v[64:67], v[164:167]
    v_mfma_f32_16x16x32_bf16 v[200:203], v[92:95], v[68:71], v[200:203]
    v_mfma_f32_16x16x32_bf16 v[236:239], v[92:95], v[72:75], v[236:239]
    ds_read_b64_tr_b16 v[92:93], v12 offset:128
    ds_read_b64_tr_b16 v[94:95], v12 offset:4736
    s_waitcnt lgkmcnt(12)
    v_mfma_f32_16x16x32_bf16 v[132:135], v[96:99], v[60:63], v[132:135]
    v_mfma_f32_16x16x32_bf16 v[168:171], v[96:99], v[64:67], v[168:171]
    v_mfma_f32_16x16x32_bf16 v[204:207], v[96:99], v[68:71], v[204:207]
    v_mfma_f32_16x16x32_bf16 v[240:243], v[96:99], v[72:75], v[240:243]
    ds_read_b64_tr_b16 v[96:97], v12 offset:160
    ds_read_b64_tr_b16 v[98:99], v12 offset:4768
    s_waitcnt lgkmcnt(12)
    v_mfma_f32_16x16x32_bf16 v[136:139], v[100:103], v[60:63], v[136:139]
    v_mfma_f32_16x16x32_bf16 v[172:175], v[100:103], v[64:67], v[172:175]
    v_mfma_f32_16x16x32_bf16 v[208:211], v[100:103], v[68:71], v[208:211]
    v_mfma_f32_16x16x32_bf16 v[244:247], v[100:103], v[72:75], v[244:247]
    ds_read_b64_tr_b16 v[100:101], v12 offset:192
    ds_read_b64_tr_b16 v[102:103], v12 offset:4800
    s_waitcnt lgkmcnt(12)
    v_mfma_f32_16x16x32_bf16 v[140:143], v[104:107], v[60:63], v[140:143]
    v_mfma_f32_16x16x32_bf16 v[176:179], v[104:107], v[64:67], v[176:179]
    v_mfma_f32_16x16x32_bf16 v[212:215], v[104:107], v[68:71], v[212:215]
    v_mfma_f32_16x16x32_bf16 v[248:251], v[104:107], v[72:75], v[248:251]
    ds_read_b64_tr_b16 v[104:105], v12 offset:224
    ds_read_b64_tr_b16 v[106:107], v12 offset:4832
    s_waitcnt lgkmcnt(12)
    v_mfma_f32_16x16x32_bf16 v[144:147], v[108:111], v[60:63], v[144:147]
    v_mfma_f32_16x16x32_bf16 v[180:183], v[108:111], v[64:67], v[180:183]
    v_mfma_f32_16x16x32_bf16 v[216:219], v[108:111], v[68:71], v[216:219]
    v_mfma_f32_16x16x32_bf16 v[252:255], v[108:111], v[72:75], v[252:255]
    ds_read_b64_tr_b16 v[108:109], v12 offset:256
    ds_read_b64_tr_b16 v[110:111], v12 offset:4864
    s_waitcnt lgkmcnt(12)
    v_mfma_f32_16x16x32_bf16 v[112:115], v[76:79], v[44:47], v[112:115]
    v_mfma_f32_16x16x32_bf16 v[148:151], v[76:79], v[48:51], v[148:151]
    v_mfma_f32_16x16x32_bf16 v[184:187], v[76:79], v[52:55], v[184:187]
    v_mfma_f32_16x16x32_bf16 v[220:223], v[76:79], v[56:59], v[220:223]
    s_waitcnt vmcnt(0)
    s_barrier
    ds_read_b128 v[60:63], v9 offset:0
    ds_read_b128 v[64:67], v9 offset:1024
    ds_read_b128 v[68:71], v9 offset:2048
    ds_read_b128 v[72:75], v9 offset:3072
    s_mov_b32 s76, s96
    s_mov_b32 s77, s97
    s_mov_b32 s78, 5308416
    s_mov_b32 s79, 0x00020000
    s_mov_b32 s80, s98
    s_mov_b32 s81, s99
    s_mov_b32 s82, 2359296
    s_mov_b32 s83, 0x00020000
    s_and_b32 s84, s2, 3
    s_mul_i32 s84, s84, 1327104
    s_lshr_b32 s85, s2, 3
    s_mul_i32 s85, s85, 41472
    s_add_u32 s84, s84, s85
    s_mul_i32 s85, s24, 5184
    s_add_u32 s84, s84, s85
    v_lshlrev_b32 v20, 4, v1
    v_add_u32 v20, s84, v20
    s_mul_i32 s84, s2, 9216
    s_lshl_b32 s85, s24, 11
    s_add_u32 s84, s84, s85
    v_lshlrev_b32 v21, 4, v1
    v_add_u32 v21, s84, v21

    buffer_load_dwordx4 v[28:31], v20, s[76:79], 0 offen offset:0
    buffer_load_dwordx4 v[28:31], v20, s[76:79], 0 offen offset:1024
    buffer_load_dwordx4 v[28:31], v20, s[76:79], 0 offen offset:2048
    buffer_load_dwordx4 v[28:31], v20, s[76:79], 0 offen offset:3072
    v_add_u32 v20, 4096, v20
    buffer_load_dwordx4 v[28:31], v20, s[76:79], 0 offen offset:0
    buffer_load_dwordx4 v[28:31], v20, s[76:79], 0 offen offset:1024
    buffer_load_dwordx4 v[28:31], v21, s[80:83], 0 offen offset:0
    buffer_load_dwordx4 v[28:31], v21, s[80:83], 0 offen offset:1024
    ds_read_b64_tr_b16 v[76:77], v13 offset:0
    ds_read_b64_tr_b16 v[78:79], v13 offset:4608
    s_waitcnt lgkmcnt(12)
    v_mfma_f32_16x16x32_bf16 v[116:119], v[80:83], v[44:47], v[116:119]
    v_mfma_f32_16x16x32_bf16 v[152:155], v[80:83], v[48:51], v[152:155]
    v_mfma_f32_16x16x32_bf16 v[188:191], v[80:83], v[52:55], v[188:191]
    v_mfma_f32_16x16x32_bf16 v[224:227], v[80:83], v[56:59], v[224:227]
    ds_read_b64_tr_b16 v[80:81], v13 offset:32
    ds_read_b64_tr_b16 v[82:83], v13 offset:4640
    s_waitcnt lgkmcnt(12)
    v_mfma_f32_16x16x32_bf16 v[120:123], v[84:87], v[44:47], v[120:123]
    v_mfma_f32_16x16x32_bf16 v[156:159], v[84:87], v[48:51], v[156:159]
    v_mfma_f32_16x16x32_bf16 v[192:195], v[84:87], v[52:55], v[192:195]
    v_mfma_f32_16x16x32_bf16 v[228:231], v[84:87], v[56:59], v[228:231]
    ds_read_b64_tr_b16 v[84:85], v13 offset:64
    ds_read_b64_tr_b16 v[86:87], v13 offset:4672
    s_waitcnt lgkmcnt(12)
    v_mfma_f32_16x16x32_bf16 v[124:127], v[88:91], v[44:47], v[124:127]
    v_mfma_f32_16x16x32_bf16 v[160:163], v[88:91], v[48:51], v[160:163]
    v_mfma_f32_16x16x32_bf16 v[196:199], v[88:91], v[52:55], v[196:199]
    v_mfma_f32_16x16x32_bf16 v[232:235], v[88:91], v[56:59], v[232:235]
    ds_read_b64_tr_b16 v[88:89], v13 offset:96
    ds_read_b64_tr_b16 v[90:91], v13 offset:4704
    s_waitcnt lgkmcnt(12)
    v_mfma_f32_16x16x32_bf16 v[128:131], v[92:95], v[44:47], v[128:131]
    v_mfma_f32_16x16x32_bf16 v[164:167], v[92:95], v[48:51], v[164:167]
    v_mfma_f32_16x16x32_bf16 v[200:203], v[92:95], v[52:55], v[200:203]
    v_mfma_f32_16x16x32_bf16 v[236:239], v[92:95], v[56:59], v[236:239]
    ds_read_b64_tr_b16 v[92:93], v13 offset:128
    ds_read_b64_tr_b16 v[94:95], v13 offset:4736
    s_waitcnt lgkmcnt(12)
    v_mfma_f32_16x16x32_bf16 v[132:135], v[96:99], v[44:47], v[132:135]
    v_mfma_f32_16x16x32_bf16 v[168:171], v[96:99], v[48:51], v[168:171]
    v_mfma_f32_16x16x32_bf16 v[204:207], v[96:99], v[52:55], v[204:207]
    v_mfma_f32_16x16x32_bf16 v[240:243], v[96:99], v[56:59], v[240:243]
    ds_read_b64_tr_b16 v[96:97], v13 offset:160
    ds_read_b64_tr_b16 v[98:99], v13 offset:4768
    s_waitcnt lgkmcnt(12)
    v_mfma_f32_16x16x32_bf16 v[136:139], v[100:103], v[44:47], v[136:139]
    v_mfma_f32_16x16x32_bf16 v[172:175], v[100:103], v[48:51], v[172:175]
    v_mfma_f32_16x16x32_bf16 v[208:211], v[100:103], v[52:55], v[208:211]
    v_mfma_f32_16x16x32_bf16 v[244:247], v[100:103], v[56:59], v[244:247]
    ds_read_b64_tr_b16 v[100:101], v13 offset:192
    ds_read_b64_tr_b16 v[102:103], v13 offset:4800
    s_waitcnt lgkmcnt(12)
    v_mfma_f32_16x16x32_bf16 v[140:143], v[104:107], v[44:47], v[140:143]
    v_mfma_f32_16x16x32_bf16 v[176:179], v[104:107], v[48:51], v[176:179]
    v_mfma_f32_16x16x32_bf16 v[212:215], v[104:107], v[52:55], v[212:215]
    v_mfma_f32_16x16x32_bf16 v[248:251], v[104:107], v[56:59], v[248:251]
    ds_read_b64_tr_b16 v[104:105], v13 offset:224
    ds_read_b64_tr_b16 v[106:107], v13 offset:4832
    s_waitcnt lgkmcnt(12)
    v_mfma_f32_16x16x32_bf16 v[144:147], v[108:111], v[44:47], v[144:147]
    v_mfma_f32_16x16x32_bf16 v[180:183], v[108:111], v[48:51], v[180:183]
    v_mfma_f32_16x16x32_bf16 v[216:219], v[108:111], v[52:55], v[216:219]
    v_mfma_f32_16x16x32_bf16 v[252:255], v[108:111], v[56:59], v[252:255]
    ds_read_b64_tr_b16 v[108:109], v13 offset:256
    ds_read_b64_tr_b16 v[110:111], v13 offset:4864
    s_waitcnt lgkmcnt(15)
    v_mfma_f32_16x16x32_bf16 v[112:115], v[76:79], v[60:63], v[112:115]
    v_mfma_f32_16x16x32_bf16 v[148:151], v[76:79], v[64:67], v[148:151]
    v_mfma_f32_16x16x32_bf16 v[184:187], v[76:79], v[68:71], v[184:187]
    v_mfma_f32_16x16x32_bf16 v[220:223], v[76:79], v[72:75], v[220:223]
    s_waitcnt lgkmcnt(14)
    v_mfma_f32_16x16x32_bf16 v[116:119], v[80:83], v[60:63], v[116:119]
    v_mfma_f32_16x16x32_bf16 v[152:155], v[80:83], v[64:67], v[152:155]
    v_mfma_f32_16x16x32_bf16 v[188:191], v[80:83], v[68:71], v[188:191]
    v_mfma_f32_16x16x32_bf16 v[224:227], v[80:83], v[72:75], v[224:227]
    s_waitcnt lgkmcnt(12)
    v_mfma_f32_16x16x32_bf16 v[120:123], v[84:87], v[60:63], v[120:123]
    v_mfma_f32_16x16x32_bf16 v[156:159], v[84:87], v[64:67], v[156:159]
    v_mfma_f32_16x16x32_bf16 v[192:195], v[84:87], v[68:71], v[192:195]
    v_mfma_f32_16x16x32_bf16 v[228:231], v[84:87], v[72:75], v[228:231]
    s_waitcnt lgkmcnt(10)
    v_mfma_f32_16x16x32_bf16 v[124:127], v[88:91], v[60:63], v[124:127]
    v_mfma_f32_16x16x32_bf16 v[160:163], v[88:91], v[64:67], v[160:163]
    v_mfma_f32_16x16x32_bf16 v[196:199], v[88:91], v[68:71], v[196:199]
    v_mfma_f32_16x16x32_bf16 v[232:235], v[88:91], v[72:75], v[232:235]
    s_waitcnt lgkmcnt(8)
    v_mfma_f32_16x16x32_bf16 v[128:131], v[92:95], v[60:63], v[128:131]
    v_mfma_f32_16x16x32_bf16 v[164:167], v[92:95], v[64:67], v[164:167]
    v_mfma_f32_16x16x32_bf16 v[200:203], v[92:95], v[68:71], v[200:203]
    v_mfma_f32_16x16x32_bf16 v[236:239], v[92:95], v[72:75], v[236:239]
    s_waitcnt lgkmcnt(6)
    v_mfma_f32_16x16x32_bf16 v[132:135], v[96:99], v[60:63], v[132:135]
    v_mfma_f32_16x16x32_bf16 v[168:171], v[96:99], v[64:67], v[168:171]
    v_mfma_f32_16x16x32_bf16 v[204:207], v[96:99], v[68:71], v[204:207]
    v_mfma_f32_16x16x32_bf16 v[240:243], v[96:99], v[72:75], v[240:243]
    s_waitcnt lgkmcnt(4)
    v_mfma_f32_16x16x32_bf16 v[136:139], v[100:103], v[60:63], v[136:139]
    v_mfma_f32_16x16x32_bf16 v[172:175], v[100:103], v[64:67], v[172:175]
    v_mfma_f32_16x16x32_bf16 v[208:211], v[100:103], v[68:71], v[208:211]
    v_mfma_f32_16x16x32_bf16 v[244:247], v[100:103], v[72:75], v[244:247]
    s_waitcnt lgkmcnt(2)
    v_mfma_f32_16x16x32_bf16 v[140:143], v[104:107], v[60:63], v[140:143]
    v_mfma_f32_16x16x32_bf16 v[176:179], v[104:107], v[64:67], v[176:179]
    v_mfma_f32_16x16x32_bf16 v[212:215], v[104:107], v[68:71], v[212:215]
    v_mfma_f32_16x16x32_bf16 v[248:251], v[104:107], v[72:75], v[248:251]
    s_waitcnt lgkmcnt(0)
    v_mfma_f32_16x16x32_bf16 v[144:147], v[108:111], v[60:63], v[144:147]
    v_mfma_f32_16x16x32_bf16 v[180:183], v[108:111], v[64:67], v[180:183]
    v_mfma_f32_16x16x32_bf16 v[216:219], v[108:111], v[68:71], v[216:219]
    v_mfma_f32_16x16x32_bf16 v[252:255], v[108:111], v[72:75], v[252:255]
    s_nop 7
    s_nop 7
    s_barrier
    v_cvt_pk_bf16_f32 v112, v112, v113
    v_cvt_pk_bf16_f32 v113, v114, v115
    v_cvt_pk_bf16_f32 v116, v116, v117
    v_cvt_pk_bf16_f32 v117, v118, v119
    v_cvt_pk_bf16_f32 v120, v120, v121
    v_cvt_pk_bf16_f32 v121, v122, v123
    v_cvt_pk_bf16_f32 v124, v124, v125
    v_cvt_pk_bf16_f32 v125, v126, v127
    v_cvt_pk_bf16_f32 v128, v128, v129
    v_cvt_pk_bf16_f32 v129, v130, v131
    v_cvt_pk_bf16_f32 v132, v132, v133
    v_cvt_pk_bf16_f32 v133, v134, v135
    v_cvt_pk_bf16_f32 v136, v136, v137
    v_cvt_pk_bf16_f32 v137, v138, v139
    v_cvt_pk_bf16_f32 v140, v140, v141
    v_cvt_pk_bf16_f32 v141, v142, v143
    v_cvt_pk_bf16_f32 v144, v144, v145
    v_cvt_pk_bf16_f32 v145, v146, v147
    v_cvt_pk_bf16_f32 v148, v148, v149
    v_cvt_pk_bf16_f32 v149, v150, v151
    v_cvt_pk_bf16_f32 v152, v152, v153
    v_cvt_pk_bf16_f32 v153, v154, v155
    v_cvt_pk_bf16_f32 v156, v156, v157
    v_cvt_pk_bf16_f32 v157, v158, v159
    v_cvt_pk_bf16_f32 v160, v160, v161
    v_cvt_pk_bf16_f32 v161, v162, v163
    v_cvt_pk_bf16_f32 v164, v164, v165
    v_cvt_pk_bf16_f32 v165, v166, v167
    v_cvt_pk_bf16_f32 v168, v168, v169
    v_cvt_pk_bf16_f32 v169, v170, v171
    v_cvt_pk_bf16_f32 v172, v172, v173
    v_cvt_pk_bf16_f32 v173, v174, v175
    v_cvt_pk_bf16_f32 v176, v176, v177
    v_cvt_pk_bf16_f32 v177, v178, v179
    v_cvt_pk_bf16_f32 v180, v180, v181
    v_cvt_pk_bf16_f32 v181, v182, v183
    v_cvt_pk_bf16_f32 v184, v184, v185
    v_cvt_pk_bf16_f32 v185, v186, v187
    v_cvt_pk_bf16_f32 v188, v188, v189
    v_cvt_pk_bf16_f32 v189, v190, v191
    v_cvt_pk_bf16_f32 v192, v192, v193
    v_cvt_pk_bf16_f32 v193, v194, v195
    v_cvt_pk_bf16_f32 v196, v196, v197
    v_cvt_pk_bf16_f32 v197, v198, v199
    v_cvt_pk_bf16_f32 v200, v200, v201
    v_cvt_pk_bf16_f32 v201, v202, v203
    v_cvt_pk_bf16_f32 v204, v204, v205
    v_cvt_pk_bf16_f32 v205, v206, v207
    v_cvt_pk_bf16_f32 v208, v208, v209
    v_cvt_pk_bf16_f32 v209, v210, v211
    v_cvt_pk_bf16_f32 v212, v212, v213
    v_cvt_pk_bf16_f32 v213, v214, v215
    v_cvt_pk_bf16_f32 v216, v216, v217
    v_cvt_pk_bf16_f32 v217, v218, v219
    v_cvt_pk_bf16_f32 v220, v220, v221
    v_cvt_pk_bf16_f32 v221, v222, v223
    v_cvt_pk_bf16_f32 v224, v224, v225
    v_cvt_pk_bf16_f32 v225, v226, v227
    v_cvt_pk_bf16_f32 v228, v228, v229
    v_cvt_pk_bf16_f32 v229, v230, v231
    v_cvt_pk_bf16_f32 v232, v232, v233
    v_cvt_pk_bf16_f32 v233, v234, v235
    v_cvt_pk_bf16_f32 v236, v236, v237
    v_cvt_pk_bf16_f32 v237, v238, v239
    v_cvt_pk_bf16_f32 v240, v240, v241
    v_cvt_pk_bf16_f32 v241, v242, v243
    v_cvt_pk_bf16_f32 v244, v244, v245
    v_cvt_pk_bf16_f32 v245, v246, v247
    v_cvt_pk_bf16_f32 v248, v248, v249
    v_cvt_pk_bf16_f32 v249, v250, v251
    v_cvt_pk_bf16_f32 v252, v252, v253
    v_cvt_pk_bf16_f32 v253, v254, v255
    s_and_b32 s36, s28, 1
    s_lshl_b32 s36, s36, 1
    s_add_u32 s36, s36, s26
    s_cmp_eq_u32 s36, 1
    s_cbranch_scc1 g1_ep1
    s_cmp_eq_u32 s36, 2
    s_cbranch_scc1 g1_ep2
    s_cmp_eq_u32 s36, 3
    s_cbranch_scc1 g1_ep3
    ds_write_b64 v17, v[184:185] offset:0
    ds_write_b64 v17, v[188:189] offset:512
    ds_write_b64 v17, v[192:193] offset:1024
    ds_write_b64 v17, v[196:197] offset:1536
    ds_write_b64 v17, v[200:201] offset:2048
    ds_write_b64 v17, v[204:205] offset:2560
    ds_write_b64 v17, v[208:209] offset:3072
    ds_write_b64 v17, v[212:213] offset:3584
    ds_write_b64 v17, v[216:217] offset:4096
    ds_write_b64 v17, v[220:221] offset:4608
    ds_write_b64 v17, v[224:225] offset:5120
    ds_write_b64 v17, v[228:229] offset:5632
    ds_write_b64 v17, v[232:233] offset:6144
    ds_write_b64 v17, v[236:237] offset:6656
    ds_write_b64 v17, v[240:241] offset:7168
    ds_write_b64 v17, v[244:245] offset:7680
    ds_write_b64 v17, v[248:249] offset:8192
    ds_write_b64 v17, v[252:253] offset:8704
    s_waitcnt lgkmcnt(0)
    s_barrier
    ds_read_b64 v[114:115], v18 offset:0
    ds_read_b64 v[118:119], v18 offset:512
    ds_read_b64 v[122:123], v18 offset:1024
    ds_read_b64 v[126:127], v18 offset:1536
    ds_read_b64 v[130:131], v18 offset:2048
    ds_read_b64 v[134:135], v18 offset:2560
    ds_read_b64 v[138:139], v18 offset:3072
    ds_read_b64 v[142:143], v18 offset:3584
    ds_read_b64 v[146:147], v18 offset:4096
    ds_read_b64 v[150:151], v18 offset:4608
    ds_read_b64 v[154:155], v18 offset:5120
    ds_read_b64 v[158:159], v18 offset:5632
    ds_read_b64 v[162:163], v18 offset:6144
    ds_read_b64 v[166:167], v18 offset:6656
    ds_read_b64 v[170:171], v18 offset:7168
    ds_read_b64 v[174:175], v18 offset:7680
    ds_read_b64 v[178:179], v18 offset:8192
    ds_read_b64 v[182:183], v18 offset:8704
    s_waitcnt lgkmcnt(15)
    v_lshlrev_b32 v20, 16, v112
    v_and_b32 v21, 0xffff0000, v112
    v_lshlrev_b32 v22, 16, v113
    v_and_b32 v23, 0xffff0000, v113
    v_lshlrev_b32 v24, 16, v114
    v_and_b32 v25, 0xffff0000, v114
    v_lshlrev_b32 v26, 16, v115
    v_and_b32 v27, 0xffff0000, v115
    v_mul_f32 v20, v20, v24
    v_mul_f32 v21, v21, v25
    v_mul_f32 v22, v22, v26
    v_mul_f32 v23, v23, v27
    v_cvt_pk_bf16_f32 v112, v20, v21
    v_cvt_pk_bf16_f32 v113, v22, v23

    v_lshlrev_b32 v20, 16, v116
    v_and_b32 v21, 0xffff0000, v116
    v_lshlrev_b32 v22, 16, v117
    v_and_b32 v23, 0xffff0000, v117
    v_lshlrev_b32 v24, 16, v118
    v_and_b32 v25, 0xffff0000, v118
    v_lshlrev_b32 v26, 16, v119
    v_and_b32 v27, 0xffff0000, v119
    v_mul_f32 v20, v20, v24
    v_mul_f32 v21, v21, v25
    v_mul_f32 v22, v22, v26
    v_mul_f32 v23, v23, v27
    v_cvt_pk_bf16_f32 v114, v20, v21
    v_cvt_pk_bf16_f32 v115, v22, v23

    s_mov_b32 s36, 0
    buffer_store_dwordx4 v[112:115], v16, s[20:23], s36 offen sc1
    s_waitcnt lgkmcnt(14)
    v_lshlrev_b32 v20, 16, v120
    v_and_b32 v21, 0xffff0000, v120
    v_lshlrev_b32 v22, 16, v121
    v_and_b32 v23, 0xffff0000, v121
    v_lshlrev_b32 v24, 16, v122
    v_and_b32 v25, 0xffff0000, v122
    v_lshlrev_b32 v26, 16, v123
    v_and_b32 v27, 0xffff0000, v123
    v_mul_f32 v20, v20, v24
    v_mul_f32 v21, v21, v25
    v_mul_f32 v22, v22, v26
    v_mul_f32 v23, v23, v27
    v_cvt_pk_bf16_f32 v120, v20, v21
    v_cvt_pk_bf16_f32 v121, v22, v23

    v_lshlrev_b32 v20, 16, v124
    v_and_b32 v21, 0xffff0000, v124
    v_lshlrev_b32 v22, 16, v125
    v_and_b32 v23, 0xffff0000, v125
    v_lshlrev_b32 v24, 16, v126
    v_and_b32 v25, 0xffff0000, v126
    v_lshlrev_b32 v26, 16, v127
    v_and_b32 v27, 0xffff0000, v127
    v_mul_f32 v20, v20, v24
    v_mul_f32 v21, v21, v25
    v_mul_f32 v22, v22, v26
    v_mul_f32 v23, v23, v27
    v_cvt_pk_bf16_f32 v122, v20, v21
    v_cvt_pk_bf16_f32 v123, v22, v23

    s_mov_b32 s36, 1024
    buffer_store_dwordx4 v[120:123], v16, s[20:23], s36 offen sc1
    s_waitcnt lgkmcnt(12)
    v_lshlrev_b32 v20, 16, v128
    v_and_b32 v21, 0xffff0000, v128
    v_lshlrev_b32 v22, 16, v129
    v_and_b32 v23, 0xffff0000, v129
    v_lshlrev_b32 v24, 16, v130
    v_and_b32 v25, 0xffff0000, v130
    v_lshlrev_b32 v26, 16, v131
    v_and_b32 v27, 0xffff0000, v131
    v_mul_f32 v20, v20, v24
    v_mul_f32 v21, v21, v25
    v_mul_f32 v22, v22, v26
    v_mul_f32 v23, v23, v27
    v_cvt_pk_bf16_f32 v128, v20, v21
    v_cvt_pk_bf16_f32 v129, v22, v23

    v_lshlrev_b32 v20, 16, v132
    v_and_b32 v21, 0xffff0000, v132
    v_lshlrev_b32 v22, 16, v133
    v_and_b32 v23, 0xffff0000, v133
    v_lshlrev_b32 v24, 16, v134
    v_and_b32 v25, 0xffff0000, v134
    v_lshlrev_b32 v26, 16, v135
    v_and_b32 v27, 0xffff0000, v135
    v_mul_f32 v20, v20, v24
    v_mul_f32 v21, v21, v25
    v_mul_f32 v22, v22, v26
    v_mul_f32 v23, v23, v27
    v_cvt_pk_bf16_f32 v130, v20, v21
    v_cvt_pk_bf16_f32 v131, v22, v23

    s_mov_b32 s36, 2048
    buffer_store_dwordx4 v[128:131], v16, s[20:23], s36 offen sc1
    s_waitcnt lgkmcnt(10)
    v_lshlrev_b32 v20, 16, v136
    v_and_b32 v21, 0xffff0000, v136
    v_lshlrev_b32 v22, 16, v137
    v_and_b32 v23, 0xffff0000, v137
    v_lshlrev_b32 v24, 16, v138
    v_and_b32 v25, 0xffff0000, v138
    v_lshlrev_b32 v26, 16, v139
    v_and_b32 v27, 0xffff0000, v139
    v_mul_f32 v20, v20, v24
    v_mul_f32 v21, v21, v25
    v_mul_f32 v22, v22, v26
    v_mul_f32 v23, v23, v27
    v_cvt_pk_bf16_f32 v136, v20, v21
    v_cvt_pk_bf16_f32 v137, v22, v23

    v_lshlrev_b32 v20, 16, v140
    v_and_b32 v21, 0xffff0000, v140
    v_lshlrev_b32 v22, 16, v141
    v_and_b32 v23, 0xffff0000, v141
    v_lshlrev_b32 v24, 16, v142
    v_and_b32 v25, 0xffff0000, v142
    v_lshlrev_b32 v26, 16, v143
    v_and_b32 v27, 0xffff0000, v143
    v_mul_f32 v20, v20, v24
    v_mul_f32 v21, v21, v25
    v_mul_f32 v22, v22, v26
    v_mul_f32 v23, v23, v27
    v_cvt_pk_bf16_f32 v138, v20, v21
    v_cvt_pk_bf16_f32 v139, v22, v23

    s_mov_b32 s36, 3072
    buffer_store_dwordx4 v[136:139], v16, s[20:23], s36 offen sc1
    s_waitcnt lgkmcnt(9)
    v_lshlrev_b32 v20, 16, v144
    v_and_b32 v21, 0xffff0000, v144
    v_lshlrev_b32 v22, 16, v145
    v_and_b32 v23, 0xffff0000, v145
    v_lshlrev_b32 v24, 16, v146
    v_and_b32 v25, 0xffff0000, v146
    v_lshlrev_b32 v26, 16, v147
    v_and_b32 v27, 0xffff0000, v147
    v_mul_f32 v20, v20, v24
    v_mul_f32 v21, v21, v25
    v_mul_f32 v22, v22, v26
    v_mul_f32 v23, v23, v27
    v_cvt_pk_bf16_f32 v144, v20, v21
    v_cvt_pk_bf16_f32 v145, v22, v23

    s_mov_b32 s36, 4096
    buffer_store_dwordx2 v[144:145], v16, s[20:23], s36 offen sc1
    s_waitcnt lgkmcnt(7)
    v_lshlrev_b32 v20, 16, v148
    v_and_b32 v21, 0xffff0000, v148
    v_lshlrev_b32 v22, 16, v149
    v_and_b32 v23, 0xffff0000, v149
    v_lshlrev_b32 v24, 16, v150
    v_and_b32 v25, 0xffff0000, v150
    v_lshlrev_b32 v26, 16, v151
    v_and_b32 v27, 0xffff0000, v151
    v_mul_f32 v20, v20, v24
    v_mul_f32 v21, v21, v25
    v_mul_f32 v22, v22, v26
    v_mul_f32 v23, v23, v27
    v_cvt_pk_bf16_f32 v148, v20, v21
    v_cvt_pk_bf16_f32 v149, v22, v23

    v_lshlrev_b32 v20, 16, v152
    v_and_b32 v21, 0xffff0000, v152
    v_lshlrev_b32 v22, 16, v153
    v_and_b32 v23, 0xffff0000, v153
    v_lshlrev_b32 v24, 16, v154
    v_and_b32 v25, 0xffff0000, v154
    v_lshlrev_b32 v26, 16, v155
    v_and_b32 v27, 0xffff0000, v155
    v_mul_f32 v20, v20, v24
    v_mul_f32 v21, v21, v25
    v_mul_f32 v22, v22, v26
    v_mul_f32 v23, v23, v27
    v_cvt_pk_bf16_f32 v150, v20, v21
    v_cvt_pk_bf16_f32 v151, v22, v23

    s_mov_b32 s36, 147456
    buffer_store_dwordx4 v[148:151], v16, s[20:23], s36 offen sc1
    s_waitcnt lgkmcnt(5)
    v_lshlrev_b32 v20, 16, v156
    v_and_b32 v21, 0xffff0000, v156
    v_lshlrev_b32 v22, 16, v157
    v_and_b32 v23, 0xffff0000, v157
    v_lshlrev_b32 v24, 16, v158
    v_and_b32 v25, 0xffff0000, v158
    v_lshlrev_b32 v26, 16, v159
    v_and_b32 v27, 0xffff0000, v159
    v_mul_f32 v20, v20, v24
    v_mul_f32 v21, v21, v25
    v_mul_f32 v22, v22, v26
    v_mul_f32 v23, v23, v27
    v_cvt_pk_bf16_f32 v156, v20, v21
    v_cvt_pk_bf16_f32 v157, v22, v23

    v_lshlrev_b32 v20, 16, v160
    v_and_b32 v21, 0xffff0000, v160
    v_lshlrev_b32 v22, 16, v161
    v_and_b32 v23, 0xffff0000, v161
    v_lshlrev_b32 v24, 16, v162
    v_and_b32 v25, 0xffff0000, v162
    v_lshlrev_b32 v26, 16, v163
    v_and_b32 v27, 0xffff0000, v163
    v_mul_f32 v20, v20, v24
    v_mul_f32 v21, v21, v25
    v_mul_f32 v22, v22, v26
    v_mul_f32 v23, v23, v27
    v_cvt_pk_bf16_f32 v158, v20, v21
    v_cvt_pk_bf16_f32 v159, v22, v23

    s_mov_b32 s36, 148480
    buffer_store_dwordx4 v[156:159], v16, s[20:23], s36 offen sc1
    s_waitcnt lgkmcnt(3)
    v_lshlrev_b32 v20, 16, v164
    v_and_b32 v21, 0xffff0000, v164
    v_lshlrev_b32 v22, 16, v165
    v_and_b32 v23, 0xffff0000, v165
    v_lshlrev_b32 v24, 16, v166
    v_and_b32 v25, 0xffff0000, v166
    v_lshlrev_b32 v26, 16, v167
    v_and_b32 v27, 0xffff0000, v167
    v_mul_f32 v20, v20, v24
    v_mul_f32 v21, v21, v25
    v_mul_f32 v22, v22, v26
    v_mul_f32 v23, v23, v27
    v_cvt_pk_bf16_f32 v164, v20, v21
    v_cvt_pk_bf16_f32 v165, v22, v23

    v_lshlrev_b32 v20, 16, v168
    v_and_b32 v21, 0xffff0000, v168
    v_lshlrev_b32 v22, 16, v169
    v_and_b32 v23, 0xffff0000, v169
    v_lshlrev_b32 v24, 16, v170
    v_and_b32 v25, 0xffff0000, v170
    v_lshlrev_b32 v26, 16, v171
    v_and_b32 v27, 0xffff0000, v171
    v_mul_f32 v20, v20, v24
    v_mul_f32 v21, v21, v25
    v_mul_f32 v22, v22, v26
    v_mul_f32 v23, v23, v27
    v_cvt_pk_bf16_f32 v166, v20, v21
    v_cvt_pk_bf16_f32 v167, v22, v23

    s_mov_b32 s36, 149504
    buffer_store_dwordx4 v[164:167], v16, s[20:23], s36 offen sc1
    s_waitcnt lgkmcnt(1)
    v_lshlrev_b32 v20, 16, v172
    v_and_b32 v21, 0xffff0000, v172
    v_lshlrev_b32 v22, 16, v173
    v_and_b32 v23, 0xffff0000, v173
    v_lshlrev_b32 v24, 16, v174
    v_and_b32 v25, 0xffff0000, v174
    v_lshlrev_b32 v26, 16, v175
    v_and_b32 v27, 0xffff0000, v175
    v_mul_f32 v20, v20, v24
    v_mul_f32 v21, v21, v25
    v_mul_f32 v22, v22, v26
    v_mul_f32 v23, v23, v27
    v_cvt_pk_bf16_f32 v172, v20, v21
    v_cvt_pk_bf16_f32 v173, v22, v23

    v_lshlrev_b32 v20, 16, v176
    v_and_b32 v21, 0xffff0000, v176
    v_lshlrev_b32 v22, 16, v177
    v_and_b32 v23, 0xffff0000, v177
    v_lshlrev_b32 v24, 16, v178
    v_and_b32 v25, 0xffff0000, v178
    v_lshlrev_b32 v26, 16, v179
    v_and_b32 v27, 0xffff0000, v179
    v_mul_f32 v20, v20, v24
    v_mul_f32 v21, v21, v25
    v_mul_f32 v22, v22, v26
    v_mul_f32 v23, v23, v27
    v_cvt_pk_bf16_f32 v174, v20, v21
    v_cvt_pk_bf16_f32 v175, v22, v23

    s_mov_b32 s36, 150528
    buffer_store_dwordx4 v[172:175], v16, s[20:23], s36 offen sc1
    s_waitcnt lgkmcnt(0)
    v_lshlrev_b32 v20, 16, v180
    v_and_b32 v21, 0xffff0000, v180
    v_lshlrev_b32 v22, 16, v181
    v_and_b32 v23, 0xffff0000, v181
    v_lshlrev_b32 v24, 16, v182
    v_and_b32 v25, 0xffff0000, v182
    v_lshlrev_b32 v26, 16, v183
    v_and_b32 v27, 0xffff0000, v183
    v_mul_f32 v20, v20, v24
    v_mul_f32 v21, v21, v25
    v_mul_f32 v22, v22, v26
    v_mul_f32 v23, v23, v27
    v_cvt_pk_bf16_f32 v180, v20, v21
    v_cvt_pk_bf16_f32 v181, v22, v23

    s_mov_b32 s36, 151552
    buffer_store_dwordx2 v[180:181], v16, s[20:23], s36 offen sc1
    s_endpgm
g1_ep1:
    ds_write_b64 v17, v[112:113] offset:0
    ds_write_b64 v17, v[116:117] offset:512
    ds_write_b64 v17, v[120:121] offset:1024
    ds_write_b64 v17, v[124:125] offset:1536
    ds_write_b64 v17, v[128:129] offset:2048
    ds_write_b64 v17, v[132:133] offset:2560
    ds_write_b64 v17, v[136:137] offset:3072
    ds_write_b64 v17, v[140:141] offset:3584
    ds_write_b64 v17, v[144:145] offset:4096
    ds_write_b64 v17, v[148:149] offset:4608
    ds_write_b64 v17, v[152:153] offset:5120
    ds_write_b64 v17, v[156:157] offset:5632
    ds_write_b64 v17, v[160:161] offset:6144
    ds_write_b64 v17, v[164:165] offset:6656
    ds_write_b64 v17, v[168:169] offset:7168
    ds_write_b64 v17, v[172:173] offset:7680
    ds_write_b64 v17, v[176:177] offset:8192
    ds_write_b64 v17, v[180:181] offset:8704
    s_waitcnt lgkmcnt(0)
    s_barrier
    ds_read_b64 v[186:187], v18 offset:0
    ds_read_b64 v[190:191], v18 offset:512
    ds_read_b64 v[194:195], v18 offset:1024
    ds_read_b64 v[198:199], v18 offset:1536
    ds_read_b64 v[202:203], v18 offset:2048
    ds_read_b64 v[206:207], v18 offset:2560
    ds_read_b64 v[210:211], v18 offset:3072
    ds_read_b64 v[214:215], v18 offset:3584
    ds_read_b64 v[218:219], v18 offset:4096
    ds_read_b64 v[222:223], v18 offset:4608
    ds_read_b64 v[226:227], v18 offset:5120
    ds_read_b64 v[230:231], v18 offset:5632
    ds_read_b64 v[234:235], v18 offset:6144
    ds_read_b64 v[238:239], v18 offset:6656
    ds_read_b64 v[242:243], v18 offset:7168
    ds_read_b64 v[246:247], v18 offset:7680
    ds_read_b64 v[250:251], v18 offset:8192
    ds_read_b64 v[254:255], v18 offset:8704
    s_waitcnt lgkmcnt(15)
    v_lshlrev_b32 v20, 16, v184
    v_and_b32 v21, 0xffff0000, v184
    v_lshlrev_b32 v22, 16, v185
    v_and_b32 v23, 0xffff0000, v185
    v_lshlrev_b32 v24, 16, v186
    v_and_b32 v25, 0xffff0000, v186
    v_lshlrev_b32 v26, 16, v187
    v_and_b32 v27, 0xffff0000, v187
    v_mul_f32 v20, v20, v24
    v_mul_f32 v21, v21, v25
    v_mul_f32 v22, v22, v26
    v_mul_f32 v23, v23, v27
    v_cvt_pk_bf16_f32 v184, v20, v21
    v_cvt_pk_bf16_f32 v185, v22, v23

    v_lshlrev_b32 v20, 16, v188
    v_and_b32 v21, 0xffff0000, v188
    v_lshlrev_b32 v22, 16, v189
    v_and_b32 v23, 0xffff0000, v189
    v_lshlrev_b32 v24, 16, v190
    v_and_b32 v25, 0xffff0000, v190
    v_lshlrev_b32 v26, 16, v191
    v_and_b32 v27, 0xffff0000, v191
    v_mul_f32 v20, v20, v24
    v_mul_f32 v21, v21, v25
    v_mul_f32 v22, v22, v26
    v_mul_f32 v23, v23, v27
    v_cvt_pk_bf16_f32 v186, v20, v21
    v_cvt_pk_bf16_f32 v187, v22, v23

    s_mov_b32 s36, 294912
    buffer_store_dwordx4 v[184:187], v16, s[20:23], s36 offen sc1
    s_waitcnt lgkmcnt(14)
    v_lshlrev_b32 v20, 16, v192
    v_and_b32 v21, 0xffff0000, v192
    v_lshlrev_b32 v22, 16, v193
    v_and_b32 v23, 0xffff0000, v193
    v_lshlrev_b32 v24, 16, v194
    v_and_b32 v25, 0xffff0000, v194
    v_lshlrev_b32 v26, 16, v195
    v_and_b32 v27, 0xffff0000, v195
    v_mul_f32 v20, v20, v24
    v_mul_f32 v21, v21, v25
    v_mul_f32 v22, v22, v26
    v_mul_f32 v23, v23, v27
    v_cvt_pk_bf16_f32 v192, v20, v21
    v_cvt_pk_bf16_f32 v193, v22, v23

    v_lshlrev_b32 v20, 16, v196
    v_and_b32 v21, 0xffff0000, v196
    v_lshlrev_b32 v22, 16, v197
    v_and_b32 v23, 0xffff0000, v197
    v_lshlrev_b32 v24, 16, v198
    v_and_b32 v25, 0xffff0000, v198
    v_lshlrev_b32 v26, 16, v199
    v_and_b32 v27, 0xffff0000, v199
    v_mul_f32 v20, v20, v24
    v_mul_f32 v21, v21, v25
    v_mul_f32 v22, v22, v26
    v_mul_f32 v23, v23, v27
    v_cvt_pk_bf16_f32 v194, v20, v21
    v_cvt_pk_bf16_f32 v195, v22, v23

    s_mov_b32 s36, 295936
    buffer_store_dwordx4 v[192:195], v16, s[20:23], s36 offen sc1
    s_waitcnt lgkmcnt(12)
    v_lshlrev_b32 v20, 16, v200
    v_and_b32 v21, 0xffff0000, v200
    v_lshlrev_b32 v22, 16, v201
    v_and_b32 v23, 0xffff0000, v201
    v_lshlrev_b32 v24, 16, v202
    v_and_b32 v25, 0xffff0000, v202
    v_lshlrev_b32 v26, 16, v203
    v_and_b32 v27, 0xffff0000, v203
    v_mul_f32 v20, v20, v24
    v_mul_f32 v21, v21, v25
    v_mul_f32 v22, v22, v26
    v_mul_f32 v23, v23, v27
    v_cvt_pk_bf16_f32 v200, v20, v21
    v_cvt_pk_bf16_f32 v201, v22, v23

    v_lshlrev_b32 v20, 16, v204
    v_and_b32 v21, 0xffff0000, v204
    v_lshlrev_b32 v22, 16, v205
    v_and_b32 v23, 0xffff0000, v205
    v_lshlrev_b32 v24, 16, v206
    v_and_b32 v25, 0xffff0000, v206
    v_lshlrev_b32 v26, 16, v207
    v_and_b32 v27, 0xffff0000, v207
    v_mul_f32 v20, v20, v24
    v_mul_f32 v21, v21, v25
    v_mul_f32 v22, v22, v26
    v_mul_f32 v23, v23, v27
    v_cvt_pk_bf16_f32 v202, v20, v21
    v_cvt_pk_bf16_f32 v203, v22, v23

    s_mov_b32 s36, 296960
    buffer_store_dwordx4 v[200:203], v16, s[20:23], s36 offen sc1
    s_waitcnt lgkmcnt(10)
    v_lshlrev_b32 v20, 16, v208
    v_and_b32 v21, 0xffff0000, v208
    v_lshlrev_b32 v22, 16, v209
    v_and_b32 v23, 0xffff0000, v209
    v_lshlrev_b32 v24, 16, v210
    v_and_b32 v25, 0xffff0000, v210
    v_lshlrev_b32 v26, 16, v211
    v_and_b32 v27, 0xffff0000, v211
    v_mul_f32 v20, v20, v24
    v_mul_f32 v21, v21, v25
    v_mul_f32 v22, v22, v26
    v_mul_f32 v23, v23, v27
    v_cvt_pk_bf16_f32 v208, v20, v21
    v_cvt_pk_bf16_f32 v209, v22, v23

    v_lshlrev_b32 v20, 16, v212
    v_and_b32 v21, 0xffff0000, v212
    v_lshlrev_b32 v22, 16, v213
    v_and_b32 v23, 0xffff0000, v213
    v_lshlrev_b32 v24, 16, v214
    v_and_b32 v25, 0xffff0000, v214
    v_lshlrev_b32 v26, 16, v215
    v_and_b32 v27, 0xffff0000, v215
    v_mul_f32 v20, v20, v24
    v_mul_f32 v21, v21, v25
    v_mul_f32 v22, v22, v26
    v_mul_f32 v23, v23, v27
    v_cvt_pk_bf16_f32 v210, v20, v21
    v_cvt_pk_bf16_f32 v211, v22, v23

    s_mov_b32 s36, 297984
    buffer_store_dwordx4 v[208:211], v16, s[20:23], s36 offen sc1
    s_waitcnt lgkmcnt(9)
    v_lshlrev_b32 v20, 16, v216
    v_and_b32 v21, 0xffff0000, v216
    v_lshlrev_b32 v22, 16, v217
    v_and_b32 v23, 0xffff0000, v217
    v_lshlrev_b32 v24, 16, v218
    v_and_b32 v25, 0xffff0000, v218
    v_lshlrev_b32 v26, 16, v219
    v_and_b32 v27, 0xffff0000, v219
    v_mul_f32 v20, v20, v24
    v_mul_f32 v21, v21, v25
    v_mul_f32 v22, v22, v26
    v_mul_f32 v23, v23, v27
    v_cvt_pk_bf16_f32 v216, v20, v21
    v_cvt_pk_bf16_f32 v217, v22, v23

    s_mov_b32 s36, 299008
    buffer_store_dwordx2 v[216:217], v16, s[20:23], s36 offen sc1
    s_waitcnt lgkmcnt(7)
    v_lshlrev_b32 v20, 16, v220
    v_and_b32 v21, 0xffff0000, v220
    v_lshlrev_b32 v22, 16, v221
    v_and_b32 v23, 0xffff0000, v221
    v_lshlrev_b32 v24, 16, v222
    v_and_b32 v25, 0xffff0000, v222
    v_lshlrev_b32 v26, 16, v223
    v_and_b32 v27, 0xffff0000, v223
    v_mul_f32 v20, v20, v24
    v_mul_f32 v21, v21, v25
    v_mul_f32 v22, v22, v26
    v_mul_f32 v23, v23, v27
    v_cvt_pk_bf16_f32 v220, v20, v21
    v_cvt_pk_bf16_f32 v221, v22, v23

    v_lshlrev_b32 v20, 16, v224
    v_and_b32 v21, 0xffff0000, v224
    v_lshlrev_b32 v22, 16, v225
    v_and_b32 v23, 0xffff0000, v225
    v_lshlrev_b32 v24, 16, v226
    v_and_b32 v25, 0xffff0000, v226
    v_lshlrev_b32 v26, 16, v227
    v_and_b32 v27, 0xffff0000, v227
    v_mul_f32 v20, v20, v24
    v_mul_f32 v21, v21, v25
    v_mul_f32 v22, v22, v26
    v_mul_f32 v23, v23, v27
    v_cvt_pk_bf16_f32 v222, v20, v21
    v_cvt_pk_bf16_f32 v223, v22, v23

    s_mov_b32 s36, 442368
    buffer_store_dwordx4 v[220:223], v16, s[20:23], s36 offen sc1
    s_waitcnt lgkmcnt(5)
    v_lshlrev_b32 v20, 16, v228
    v_and_b32 v21, 0xffff0000, v228
    v_lshlrev_b32 v22, 16, v229
    v_and_b32 v23, 0xffff0000, v229
    v_lshlrev_b32 v24, 16, v230
    v_and_b32 v25, 0xffff0000, v230
    v_lshlrev_b32 v26, 16, v231
    v_and_b32 v27, 0xffff0000, v231
    v_mul_f32 v20, v20, v24
    v_mul_f32 v21, v21, v25
    v_mul_f32 v22, v22, v26
    v_mul_f32 v23, v23, v27
    v_cvt_pk_bf16_f32 v228, v20, v21
    v_cvt_pk_bf16_f32 v229, v22, v23

    v_lshlrev_b32 v20, 16, v232
    v_and_b32 v21, 0xffff0000, v232
    v_lshlrev_b32 v22, 16, v233
    v_and_b32 v23, 0xffff0000, v233
    v_lshlrev_b32 v24, 16, v234
    v_and_b32 v25, 0xffff0000, v234
    v_lshlrev_b32 v26, 16, v235
    v_and_b32 v27, 0xffff0000, v235
    v_mul_f32 v20, v20, v24
    v_mul_f32 v21, v21, v25
    v_mul_f32 v22, v22, v26
    v_mul_f32 v23, v23, v27
    v_cvt_pk_bf16_f32 v230, v20, v21
    v_cvt_pk_bf16_f32 v231, v22, v23

    s_mov_b32 s36, 443392
    buffer_store_dwordx4 v[228:231], v16, s[20:23], s36 offen sc1
    s_waitcnt lgkmcnt(3)
    v_lshlrev_b32 v20, 16, v236
    v_and_b32 v21, 0xffff0000, v236
    v_lshlrev_b32 v22, 16, v237
    v_and_b32 v23, 0xffff0000, v237
    v_lshlrev_b32 v24, 16, v238
    v_and_b32 v25, 0xffff0000, v238
    v_lshlrev_b32 v26, 16, v239
    v_and_b32 v27, 0xffff0000, v239
    v_mul_f32 v20, v20, v24
    v_mul_f32 v21, v21, v25
    v_mul_f32 v22, v22, v26
    v_mul_f32 v23, v23, v27
    v_cvt_pk_bf16_f32 v236, v20, v21
    v_cvt_pk_bf16_f32 v237, v22, v23

    v_lshlrev_b32 v20, 16, v240
    v_and_b32 v21, 0xffff0000, v240
    v_lshlrev_b32 v22, 16, v241
    v_and_b32 v23, 0xffff0000, v241
    v_lshlrev_b32 v24, 16, v242
    v_and_b32 v25, 0xffff0000, v242
    v_lshlrev_b32 v26, 16, v243
    v_and_b32 v27, 0xffff0000, v243
    v_mul_f32 v20, v20, v24
    v_mul_f32 v21, v21, v25
    v_mul_f32 v22, v22, v26
    v_mul_f32 v23, v23, v27
    v_cvt_pk_bf16_f32 v238, v20, v21
    v_cvt_pk_bf16_f32 v239, v22, v23

    s_mov_b32 s36, 444416
    buffer_store_dwordx4 v[236:239], v16, s[20:23], s36 offen sc1
    s_waitcnt lgkmcnt(1)
    v_lshlrev_b32 v20, 16, v244
    v_and_b32 v21, 0xffff0000, v244
    v_lshlrev_b32 v22, 16, v245
    v_and_b32 v23, 0xffff0000, v245
    v_lshlrev_b32 v24, 16, v246
    v_and_b32 v25, 0xffff0000, v246
    v_lshlrev_b32 v26, 16, v247
    v_and_b32 v27, 0xffff0000, v247
    v_mul_f32 v20, v20, v24
    v_mul_f32 v21, v21, v25
    v_mul_f32 v22, v22, v26
    v_mul_f32 v23, v23, v27
    v_cvt_pk_bf16_f32 v244, v20, v21
    v_cvt_pk_bf16_f32 v245, v22, v23

    v_lshlrev_b32 v20, 16, v248
    v_and_b32 v21, 0xffff0000, v248
    v_lshlrev_b32 v22, 16, v249
    v_and_b32 v23, 0xffff0000, v249
    v_lshlrev_b32 v24, 16, v250
    v_and_b32 v25, 0xffff0000, v250
    v_lshlrev_b32 v26, 16, v251
    v_and_b32 v27, 0xffff0000, v251
    v_mul_f32 v20, v20, v24
    v_mul_f32 v21, v21, v25
    v_mul_f32 v22, v22, v26
    v_mul_f32 v23, v23, v27
    v_cvt_pk_bf16_f32 v246, v20, v21
    v_cvt_pk_bf16_f32 v247, v22, v23

    s_mov_b32 s36, 445440
    buffer_store_dwordx4 v[244:247], v16, s[20:23], s36 offen sc1
    s_waitcnt lgkmcnt(0)
    v_lshlrev_b32 v20, 16, v252
    v_and_b32 v21, 0xffff0000, v252
    v_lshlrev_b32 v22, 16, v253
    v_and_b32 v23, 0xffff0000, v253
    v_lshlrev_b32 v24, 16, v254
    v_and_b32 v25, 0xffff0000, v254
    v_lshlrev_b32 v26, 16, v255
    v_and_b32 v27, 0xffff0000, v255
    v_mul_f32 v20, v20, v24
    v_mul_f32 v21, v21, v25
    v_mul_f32 v22, v22, v26
    v_mul_f32 v23, v23, v27
    v_cvt_pk_bf16_f32 v252, v20, v21
    v_cvt_pk_bf16_f32 v253, v22, v23

    s_mov_b32 s36, 446464
    buffer_store_dwordx2 v[252:253], v16, s[20:23], s36 offen sc1
    s_endpgm
g1_ep2:
    ds_write_b64 v17, v[184:185] offset:0
    ds_write_b64 v17, v[188:189] offset:512
    ds_write_b64 v17, v[192:193] offset:1024
    ds_write_b64 v17, v[196:197] offset:1536
    ds_write_b64 v17, v[200:201] offset:2048
    ds_write_b64 v17, v[204:205] offset:2560
    ds_write_b64 v17, v[208:209] offset:3072
    ds_write_b64 v17, v[212:213] offset:3584
    ds_write_b64 v17, v[216:217] offset:4096
    ds_write_b64 v17, v[220:221] offset:4608
    ds_write_b64 v17, v[224:225] offset:5120
    ds_write_b64 v17, v[228:229] offset:5632
    ds_write_b64 v17, v[232:233] offset:6144
    ds_write_b64 v17, v[236:237] offset:6656
    ds_write_b64 v17, v[240:241] offset:7168
    ds_write_b64 v17, v[244:245] offset:7680
    ds_write_b64 v17, v[248:249] offset:8192
    ds_write_b64 v17, v[252:253] offset:8704
    s_waitcnt lgkmcnt(0)
    s_barrier
    ds_read_b64 v[114:115], v18 offset:0
    ds_read_b64 v[118:119], v18 offset:512
    ds_read_b64 v[122:123], v18 offset:1024
    ds_read_b64 v[126:127], v18 offset:1536
    ds_read_b64 v[130:131], v18 offset:2048
    ds_read_b64 v[134:135], v18 offset:2560
    ds_read_b64 v[138:139], v18 offset:3072
    ds_read_b64 v[142:143], v18 offset:3584
    ds_read_b64 v[146:147], v18 offset:4096
    ds_read_b64 v[150:151], v18 offset:4608
    ds_read_b64 v[154:155], v18 offset:5120
    ds_read_b64 v[158:159], v18 offset:5632
    ds_read_b64 v[162:163], v18 offset:6144
    ds_read_b64 v[166:167], v18 offset:6656
    ds_read_b64 v[170:171], v18 offset:7168
    ds_read_b64 v[174:175], v18 offset:7680
    ds_read_b64 v[178:179], v18 offset:8192
    ds_read_b64 v[182:183], v18 offset:8704
    s_waitcnt lgkmcnt(15)
    v_lshlrev_b32 v20, 16, v112
    v_and_b32 v21, 0xffff0000, v112
    v_lshlrev_b32 v22, 16, v113
    v_and_b32 v23, 0xffff0000, v113
    v_lshlrev_b32 v24, 16, v114
    v_and_b32 v25, 0xffff0000, v114
    v_lshlrev_b32 v26, 16, v115
    v_and_b32 v27, 0xffff0000, v115
    v_mul_f32 v20, v20, v24
    v_mul_f32 v21, v21, v25
    v_mul_f32 v22, v22, v26
    v_mul_f32 v23, v23, v27
    v_cvt_pk_bf16_f32 v112, v20, v21
    v_cvt_pk_bf16_f32 v113, v22, v23

    s_mov_b32 s36, 8
    buffer_store_dwordx2 v[112:113], v16, s[20:23], s36 offen sc1
    s_waitcnt lgkmcnt(15)
    v_lshlrev_b32 v20, 16, v116
    v_and_b32 v21, 0xffff0000, v116
    v_lshlrev_b32 v22, 16, v117
    v_and_b32 v23, 0xffff0000, v117
    v_lshlrev_b32 v24, 16, v118
    v_and_b32 v25, 0xffff0000, v118
    v_lshlrev_b32 v26, 16, v119
    v_and_b32 v27, 0xffff0000, v119
    v_mul_f32 v20, v20, v24
    v_mul_f32 v21, v21, v25
    v_mul_f32 v22, v22, v26
    v_mul_f32 v23, v23, v27
    v_cvt_pk_bf16_f32 v116, v20, v21
    v_cvt_pk_bf16_f32 v117, v22, v23

    v_lshlrev_b32 v20, 16, v120
    v_and_b32 v21, 0xffff0000, v120
    v_lshlrev_b32 v22, 16, v121
    v_and_b32 v23, 0xffff0000, v121
    v_lshlrev_b32 v24, 16, v122
    v_and_b32 v25, 0xffff0000, v122
    v_lshlrev_b32 v26, 16, v123
    v_and_b32 v27, 0xffff0000, v123
    v_mul_f32 v20, v20, v24
    v_mul_f32 v21, v21, v25
    v_mul_f32 v22, v22, v26
    v_mul_f32 v23, v23, v27
    v_cvt_pk_bf16_f32 v118, v20, v21
    v_cvt_pk_bf16_f32 v119, v22, v23

    s_mov_b32 s36, 1024
    buffer_store_dwordx4 v[116:119], v16, s[20:23], s36 offen sc1
    s_waitcnt lgkmcnt(13)
    v_lshlrev_b32 v20, 16, v124
    v_and_b32 v21, 0xffff0000, v124
    v_lshlrev_b32 v22, 16, v125
    v_and_b32 v23, 0xffff0000, v125
    v_lshlrev_b32 v24, 16, v126
    v_and_b32 v25, 0xffff0000, v126
    v_lshlrev_b32 v26, 16, v127
    v_and_b32 v27, 0xffff0000, v127
    v_mul_f32 v20, v20, v24
    v_mul_f32 v21, v21, v25
    v_mul_f32 v22, v22, v26
    v_mul_f32 v23, v23, v27
    v_cvt_pk_bf16_f32 v124, v20, v21
    v_cvt_pk_bf16_f32 v125, v22, v23

    v_lshlrev_b32 v20, 16, v128
    v_and_b32 v21, 0xffff0000, v128
    v_lshlrev_b32 v22, 16, v129
    v_and_b32 v23, 0xffff0000, v129
    v_lshlrev_b32 v24, 16, v130
    v_and_b32 v25, 0xffff0000, v130
    v_lshlrev_b32 v26, 16, v131
    v_and_b32 v27, 0xffff0000, v131
    v_mul_f32 v20, v20, v24
    v_mul_f32 v21, v21, v25
    v_mul_f32 v22, v22, v26
    v_mul_f32 v23, v23, v27
    v_cvt_pk_bf16_f32 v126, v20, v21
    v_cvt_pk_bf16_f32 v127, v22, v23

    s_mov_b32 s36, 2048
    buffer_store_dwordx4 v[124:127], v16, s[20:23], s36 offen sc1
    s_waitcnt lgkmcnt(11)
    v_lshlrev_b32 v20, 16, v132
    v_and_b32 v21, 0xffff0000, v132
    v_lshlrev_b32 v22, 16, v133
    v_and_b32 v23, 0xffff0000, v133
    v_lshlrev_b32 v24, 16, v134
    v_and_b32 v25, 0xffff0000, v134
    v_lshlrev_b32 v26, 16, v135
    v_and_b32 v27, 0xffff0000, v135
    v_mul_f32 v20, v20, v24
    v_mul_f32 v21, v21, v25
    v_mul_f32 v22, v22, v26
    v_mul_f32 v23, v23, v27
    v_cvt_pk_bf16_f32 v132, v20, v21
    v_cvt_pk_bf16_f32 v133, v22, v23

    v_lshlrev_b32 v20, 16, v136
    v_and_b32 v21, 0xffff0000, v136
    v_lshlrev_b32 v22, 16, v137
    v_and_b32 v23, 0xffff0000, v137
    v_lshlrev_b32 v24, 16, v138
    v_and_b32 v25, 0xffff0000, v138
    v_lshlrev_b32 v26, 16, v139
    v_and_b32 v27, 0xffff0000, v139
    v_mul_f32 v20, v20, v24
    v_mul_f32 v21, v21, v25
    v_mul_f32 v22, v22, v26
    v_mul_f32 v23, v23, v27
    v_cvt_pk_bf16_f32 v134, v20, v21
    v_cvt_pk_bf16_f32 v135, v22, v23

    s_mov_b32 s36, 3072
    buffer_store_dwordx4 v[132:135], v16, s[20:23], s36 offen sc1
    s_waitcnt lgkmcnt(9)
    v_lshlrev_b32 v20, 16, v140
    v_and_b32 v21, 0xffff0000, v140
    v_lshlrev_b32 v22, 16, v141
    v_and_b32 v23, 0xffff0000, v141
    v_lshlrev_b32 v24, 16, v142
    v_and_b32 v25, 0xffff0000, v142
    v_lshlrev_b32 v26, 16, v143
    v_and_b32 v27, 0xffff0000, v143
    v_mul_f32 v20, v20, v24
    v_mul_f32 v21, v21, v25
    v_mul_f32 v22, v22, v26
    v_mul_f32 v23, v23, v27
    v_cvt_pk_bf16_f32 v140, v20, v21
    v_cvt_pk_bf16_f32 v141, v22, v23

    v_lshlrev_b32 v20, 16, v144
    v_and_b32 v21, 0xffff0000, v144
    v_lshlrev_b32 v22, 16, v145
    v_and_b32 v23, 0xffff0000, v145
    v_lshlrev_b32 v24, 16, v146
    v_and_b32 v25, 0xffff0000, v146
    v_lshlrev_b32 v26, 16, v147
    v_and_b32 v27, 0xffff0000, v147
    v_mul_f32 v20, v20, v24
    v_mul_f32 v21, v21, v25
    v_mul_f32 v22, v22, v26
    v_mul_f32 v23, v23, v27
    v_cvt_pk_bf16_f32 v142, v20, v21
    v_cvt_pk_bf16_f32 v143, v22, v23

    s_mov_b32 s36, 4096
    buffer_store_dwordx4 v[140:143], v16, s[20:23], s36 offen sc1
    s_waitcnt lgkmcnt(8)
    v_lshlrev_b32 v20, 16, v148
    v_and_b32 v21, 0xffff0000, v148
    v_lshlrev_b32 v22, 16, v149
    v_and_b32 v23, 0xffff0000, v149
    v_lshlrev_b32 v24, 16, v150
    v_and_b32 v25, 0xffff0000, v150
    v_lshlrev_b32 v26, 16, v151
    v_and_b32 v27, 0xffff0000, v151
    v_mul_f32 v20, v20, v24
    v_mul_f32 v21, v21, v25
    v_mul_f32 v22, v22, v26
    v_mul_f32 v23, v23, v27
    v_cvt_pk_bf16_f32 v148, v20, v21
    v_cvt_pk_bf16_f32 v149, v22, v23

    s_mov_b32 s36, 147464
    buffer_store_dwordx2 v[148:149], v16, s[20:23], s36 offen sc1
    s_waitcnt lgkmcnt(6)
    v_lshlrev_b32 v20, 16, v152
    v_and_b32 v21, 0xffff0000, v152
    v_lshlrev_b32 v22, 16, v153
    v_and_b32 v23, 0xffff0000, v153
    v_lshlrev_b32 v24, 16, v154
    v_and_b32 v25, 0xffff0000, v154
    v_lshlrev_b32 v26, 16, v155
    v_and_b32 v27, 0xffff0000, v155
    v_mul_f32 v20, v20, v24
    v_mul_f32 v21, v21, v25
    v_mul_f32 v22, v22, v26
    v_mul_f32 v23, v23, v27
    v_cvt_pk_bf16_f32 v152, v20, v21
    v_cvt_pk_bf16_f32 v153, v22, v23

    v_lshlrev_b32 v20, 16, v156
    v_and_b32 v21, 0xffff0000, v156
    v_lshlrev_b32 v22, 16, v157
    v_and_b32 v23, 0xffff0000, v157
    v_lshlrev_b32 v24, 16, v158
    v_and_b32 v25, 0xffff0000, v158
    v_lshlrev_b32 v26, 16, v159
    v_and_b32 v27, 0xffff0000, v159
    v_mul_f32 v20, v20, v24
    v_mul_f32 v21, v21, v25
    v_mul_f32 v22, v22, v26
    v_mul_f32 v23, v23, v27
    v_cvt_pk_bf16_f32 v154, v20, v21
    v_cvt_pk_bf16_f32 v155, v22, v23

    s_mov_b32 s36, 148480
    buffer_store_dwordx4 v[152:155], v16, s[20:23], s36 offen sc1
    s_waitcnt lgkmcnt(4)
    v_lshlrev_b32 v20, 16, v160
    v_and_b32 v21, 0xffff0000, v160
    v_lshlrev_b32 v22, 16, v161
    v_and_b32 v23, 0xffff0000, v161
    v_lshlrev_b32 v24, 16, v162
    v_and_b32 v25, 0xffff0000, v162
    v_lshlrev_b32 v26, 16, v163
    v_and_b32 v27, 0xffff0000, v163
    v_mul_f32 v20, v20, v24
    v_mul_f32 v21, v21, v25
    v_mul_f32 v22, v22, v26
    v_mul_f32 v23, v23, v27
    v_cvt_pk_bf16_f32 v160, v20, v21
    v_cvt_pk_bf16_f32 v161, v22, v23

    v_lshlrev_b32 v20, 16, v164
    v_and_b32 v21, 0xffff0000, v164
    v_lshlrev_b32 v22, 16, v165
    v_and_b32 v23, 0xffff0000, v165
    v_lshlrev_b32 v24, 16, v166
    v_and_b32 v25, 0xffff0000, v166
    v_lshlrev_b32 v26, 16, v167
    v_and_b32 v27, 0xffff0000, v167
    v_mul_f32 v20, v20, v24
    v_mul_f32 v21, v21, v25
    v_mul_f32 v22, v22, v26
    v_mul_f32 v23, v23, v27
    v_cvt_pk_bf16_f32 v162, v20, v21
    v_cvt_pk_bf16_f32 v163, v22, v23

    s_mov_b32 s36, 149504
    buffer_store_dwordx4 v[160:163], v16, s[20:23], s36 offen sc1
    s_waitcnt lgkmcnt(2)
    v_lshlrev_b32 v20, 16, v168
    v_and_b32 v21, 0xffff0000, v168
    v_lshlrev_b32 v22, 16, v169
    v_and_b32 v23, 0xffff0000, v169
    v_lshlrev_b32 v24, 16, v170
    v_and_b32 v25, 0xffff0000, v170
    v_lshlrev_b32 v26, 16, v171
    v_and_b32 v27, 0xffff0000, v171
    v_mul_f32 v20, v20, v24
    v_mul_f32 v21, v21, v25
    v_mul_f32 v22, v22, v26
    v_mul_f32 v23, v23, v27
    v_cvt_pk_bf16_f32 v168, v20, v21
    v_cvt_pk_bf16_f32 v169, v22, v23

    v_lshlrev_b32 v20, 16, v172
    v_and_b32 v21, 0xffff0000, v172
    v_lshlrev_b32 v22, 16, v173
    v_and_b32 v23, 0xffff0000, v173
    v_lshlrev_b32 v24, 16, v174
    v_and_b32 v25, 0xffff0000, v174
    v_lshlrev_b32 v26, 16, v175
    v_and_b32 v27, 0xffff0000, v175
    v_mul_f32 v20, v20, v24
    v_mul_f32 v21, v21, v25
    v_mul_f32 v22, v22, v26
    v_mul_f32 v23, v23, v27
    v_cvt_pk_bf16_f32 v170, v20, v21
    v_cvt_pk_bf16_f32 v171, v22, v23

    s_mov_b32 s36, 150528
    buffer_store_dwordx4 v[168:171], v16, s[20:23], s36 offen sc1
    s_waitcnt lgkmcnt(0)
    v_lshlrev_b32 v20, 16, v176
    v_and_b32 v21, 0xffff0000, v176
    v_lshlrev_b32 v22, 16, v177
    v_and_b32 v23, 0xffff0000, v177
    v_lshlrev_b32 v24, 16, v178
    v_and_b32 v25, 0xffff0000, v178
    v_lshlrev_b32 v26, 16, v179
    v_and_b32 v27, 0xffff0000, v179
    v_mul_f32 v20, v20, v24
    v_mul_f32 v21, v21, v25
    v_mul_f32 v22, v22, v26
    v_mul_f32 v23, v23, v27
    v_cvt_pk_bf16_f32 v176, v20, v21
    v_cvt_pk_bf16_f32 v177, v22, v23

    v_lshlrev_b32 v20, 16, v180
    v_and_b32 v21, 0xffff0000, v180
    v_lshlrev_b32 v22, 16, v181
    v_and_b32 v23, 0xffff0000, v181
    v_lshlrev_b32 v24, 16, v182
    v_and_b32 v25, 0xffff0000, v182
    v_lshlrev_b32 v26, 16, v183
    v_and_b32 v27, 0xffff0000, v183
    v_mul_f32 v20, v20, v24
    v_mul_f32 v21, v21, v25
    v_mul_f32 v22, v22, v26
    v_mul_f32 v23, v23, v27
    v_cvt_pk_bf16_f32 v178, v20, v21
    v_cvt_pk_bf16_f32 v179, v22, v23

    s_mov_b32 s36, 151552
    buffer_store_dwordx4 v[176:179], v16, s[20:23], s36 offen sc1
    s_endpgm
g1_ep3:
    ds_write_b64 v17, v[112:113] offset:0
    ds_write_b64 v17, v[116:117] offset:512
    ds_write_b64 v17, v[120:121] offset:1024
    ds_write_b64 v17, v[124:125] offset:1536
    ds_write_b64 v17, v[128:129] offset:2048
    ds_write_b64 v17, v[132:133] offset:2560
    ds_write_b64 v17, v[136:137] offset:3072
    ds_write_b64 v17, v[140:141] offset:3584
    ds_write_b64 v17, v[144:145] offset:4096
    ds_write_b64 v17, v[148:149] offset:4608
    ds_write_b64 v17, v[152:153] offset:5120
    ds_write_b64 v17, v[156:157] offset:5632
    ds_write_b64 v17, v[160:161] offset:6144
    ds_write_b64 v17, v[164:165] offset:6656
    ds_write_b64 v17, v[168:169] offset:7168
    ds_write_b64 v17, v[172:173] offset:7680
    ds_write_b64 v17, v[176:177] offset:8192
    ds_write_b64 v17, v[180:181] offset:8704
    s_waitcnt lgkmcnt(0)
    s_barrier
    ds_read_b64 v[186:187], v18 offset:0
    ds_read_b64 v[190:191], v18 offset:512
    ds_read_b64 v[194:195], v18 offset:1024
    ds_read_b64 v[198:199], v18 offset:1536
    ds_read_b64 v[202:203], v18 offset:2048
    ds_read_b64 v[206:207], v18 offset:2560
    ds_read_b64 v[210:211], v18 offset:3072
    ds_read_b64 v[214:215], v18 offset:3584
    ds_read_b64 v[218:219], v18 offset:4096
    ds_read_b64 v[222:223], v18 offset:4608
    ds_read_b64 v[226:227], v18 offset:5120
    ds_read_b64 v[230:231], v18 offset:5632
    ds_read_b64 v[234:235], v18 offset:6144
    ds_read_b64 v[238:239], v18 offset:6656
    ds_read_b64 v[242:243], v18 offset:7168
    ds_read_b64 v[246:247], v18 offset:7680
    ds_read_b64 v[250:251], v18 offset:8192
    ds_read_b64 v[254:255], v18 offset:8704
    s_waitcnt lgkmcnt(15)
    v_lshlrev_b32 v20, 16, v184
    v_and_b32 v21, 0xffff0000, v184
    v_lshlrev_b32 v22, 16, v185
    v_and_b32 v23, 0xffff0000, v185
    v_lshlrev_b32 v24, 16, v186
    v_and_b32 v25, 0xffff0000, v186
    v_lshlrev_b32 v26, 16, v187
    v_and_b32 v27, 0xffff0000, v187
    v_mul_f32 v20, v20, v24
    v_mul_f32 v21, v21, v25
    v_mul_f32 v22, v22, v26
    v_mul_f32 v23, v23, v27
    v_cvt_pk_bf16_f32 v184, v20, v21
    v_cvt_pk_bf16_f32 v185, v22, v23

    s_mov_b32 s36, 294920
    buffer_store_dwordx2 v[184:185], v16, s[20:23], s36 offen sc1
    s_waitcnt lgkmcnt(15)
    v_lshlrev_b32 v20, 16, v188
    v_and_b32 v21, 0xffff0000, v188
    v_lshlrev_b32 v22, 16, v189
    v_and_b32 v23, 0xffff0000, v189
    v_lshlrev_b32 v24, 16, v190
    v_and_b32 v25, 0xffff0000, v190
    v_lshlrev_b32 v26, 16, v191
    v_and_b32 v27, 0xffff0000, v191
    v_mul_f32 v20, v20, v24
    v_mul_f32 v21, v21, v25
    v_mul_f32 v22, v22, v26
    v_mul_f32 v23, v23, v27
    v_cvt_pk_bf16_f32 v188, v20, v21
    v_cvt_pk_bf16_f32 v189, v22, v23

    v_lshlrev_b32 v20, 16, v192
    v_and_b32 v21, 0xffff0000, v192
    v_lshlrev_b32 v22, 16, v193
    v_and_b32 v23, 0xffff0000, v193
    v_lshlrev_b32 v24, 16, v194
    v_and_b32 v25, 0xffff0000, v194
    v_lshlrev_b32 v26, 16, v195
    v_and_b32 v27, 0xffff0000, v195
    v_mul_f32 v20, v20, v24
    v_mul_f32 v21, v21, v25
    v_mul_f32 v22, v22, v26
    v_mul_f32 v23, v23, v27
    v_cvt_pk_bf16_f32 v190, v20, v21
    v_cvt_pk_bf16_f32 v191, v22, v23

    s_mov_b32 s36, 295936
    buffer_store_dwordx4 v[188:191], v16, s[20:23], s36 offen sc1
    s_waitcnt lgkmcnt(13)
    v_lshlrev_b32 v20, 16, v196
    v_and_b32 v21, 0xffff0000, v196
    v_lshlrev_b32 v22, 16, v197
    v_and_b32 v23, 0xffff0000, v197
    v_lshlrev_b32 v24, 16, v198
    v_and_b32 v25, 0xffff0000, v198
    v_lshlrev_b32 v26, 16, v199
    v_and_b32 v27, 0xffff0000, v199
    v_mul_f32 v20, v20, v24
    v_mul_f32 v21, v21, v25
    v_mul_f32 v22, v22, v26
    v_mul_f32 v23, v23, v27
    v_cvt_pk_bf16_f32 v196, v20, v21
    v_cvt_pk_bf16_f32 v197, v22, v23

    v_lshlrev_b32 v20, 16, v200
    v_and_b32 v21, 0xffff0000, v200
    v_lshlrev_b32 v22, 16, v201
    v_and_b32 v23, 0xffff0000, v201
    v_lshlrev_b32 v24, 16, v202
    v_and_b32 v25, 0xffff0000, v202
    v_lshlrev_b32 v26, 16, v203
    v_and_b32 v27, 0xffff0000, v203
    v_mul_f32 v20, v20, v24
    v_mul_f32 v21, v21, v25
    v_mul_f32 v22, v22, v26
    v_mul_f32 v23, v23, v27
    v_cvt_pk_bf16_f32 v198, v20, v21
    v_cvt_pk_bf16_f32 v199, v22, v23

    s_mov_b32 s36, 296960
    buffer_store_dwordx4 v[196:199], v16, s[20:23], s36 offen sc1
    s_waitcnt lgkmcnt(11)
    v_lshlrev_b32 v20, 16, v204
    v_and_b32 v21, 0xffff0000, v204
    v_lshlrev_b32 v22, 16, v205
    v_and_b32 v23, 0xffff0000, v205
    v_lshlrev_b32 v24, 16, v206
    v_and_b32 v25, 0xffff0000, v206
    v_lshlrev_b32 v26, 16, v207
    v_and_b32 v27, 0xffff0000, v207
    v_mul_f32 v20, v20, v24
    v_mul_f32 v21, v21, v25
    v_mul_f32 v22, v22, v26
    v_mul_f32 v23, v23, v27
    v_cvt_pk_bf16_f32 v204, v20, v21
    v_cvt_pk_bf16_f32 v205, v22, v23

    v_lshlrev_b32 v20, 16, v208
    v_and_b32 v21, 0xffff0000, v208
    v_lshlrev_b32 v22, 16, v209
    v_and_b32 v23, 0xffff0000, v209
    v_lshlrev_b32 v24, 16, v210
    v_and_b32 v25, 0xffff0000, v210
    v_lshlrev_b32 v26, 16, v211
    v_and_b32 v27, 0xffff0000, v211
    v_mul_f32 v20, v20, v24
    v_mul_f32 v21, v21, v25
    v_mul_f32 v22, v22, v26
    v_mul_f32 v23, v23, v27
    v_cvt_pk_bf16_f32 v206, v20, v21
    v_cvt_pk_bf16_f32 v207, v22, v23

    s_mov_b32 s36, 297984
    buffer_store_dwordx4 v[204:207], v16, s[20:23], s36 offen sc1
    s_waitcnt lgkmcnt(9)
    v_lshlrev_b32 v20, 16, v212
    v_and_b32 v21, 0xffff0000, v212
    v_lshlrev_b32 v22, 16, v213
    v_and_b32 v23, 0xffff0000, v213
    v_lshlrev_b32 v24, 16, v214
    v_and_b32 v25, 0xffff0000, v214
    v_lshlrev_b32 v26, 16, v215
    v_and_b32 v27, 0xffff0000, v215
    v_mul_f32 v20, v20, v24
    v_mul_f32 v21, v21, v25
    v_mul_f32 v22, v22, v26
    v_mul_f32 v23, v23, v27
    v_cvt_pk_bf16_f32 v212, v20, v21
    v_cvt_pk_bf16_f32 v213, v22, v23

    v_lshlrev_b32 v20, 16, v216
    v_and_b32 v21, 0xffff0000, v216
    v_lshlrev_b32 v22, 16, v217
    v_and_b32 v23, 0xffff0000, v217
    v_lshlrev_b32 v24, 16, v218
    v_and_b32 v25, 0xffff0000, v218
    v_lshlrev_b32 v26, 16, v219
    v_and_b32 v27, 0xffff0000, v219
    v_mul_f32 v20, v20, v24
    v_mul_f32 v21, v21, v25
    v_mul_f32 v22, v22, v26
    v_mul_f32 v23, v23, v27
    v_cvt_pk_bf16_f32 v214, v20, v21
    v_cvt_pk_bf16_f32 v215, v22, v23

    s_mov_b32 s36, 299008
    buffer_store_dwordx4 v[212:215], v16, s[20:23], s36 offen sc1
    s_waitcnt lgkmcnt(8)
    v_lshlrev_b32 v20, 16, v220
    v_and_b32 v21, 0xffff0000, v220
    v_lshlrev_b32 v22, 16, v221
    v_and_b32 v23, 0xffff0000, v221
    v_lshlrev_b32 v24, 16, v222
    v_and_b32 v25, 0xffff0000, v222
    v_lshlrev_b32 v26, 16, v223
    v_and_b32 v27, 0xffff0000, v223
    v_mul_f32 v20, v20, v24
    v_mul_f32 v21, v21, v25
    v_mul_f32 v22, v22, v26
    v_mul_f32 v23, v23, v27
    v_cvt_pk_bf16_f32 v220, v20, v21
    v_cvt_pk_bf16_f32 v221, v22, v23

    s_mov_b32 s36, 442376
    buffer_store_dwordx2 v[220:221], v16, s[20:23], s36 offen sc1
    s_waitcnt lgkmcnt(6)
    v_lshlrev_b32 v20, 16, v224
    v_and_b32 v21, 0xffff0000, v224
    v_lshlrev_b32 v22, 16, v225
    v_and_b32 v23, 0xffff0000, v225
    v_lshlrev_b32 v24, 16, v226
    v_and_b32 v25, 0xffff0000, v226
    v_lshlrev_b32 v26, 16, v227
    v_and_b32 v27, 0xffff0000, v227
    v_mul_f32 v20, v20, v24
    v_mul_f32 v21, v21, v25
    v_mul_f32 v22, v22, v26
    v_mul_f32 v23, v23, v27
    v_cvt_pk_bf16_f32 v224, v20, v21
    v_cvt_pk_bf16_f32 v225, v22, v23

    v_lshlrev_b32 v20, 16, v228
    v_and_b32 v21, 0xffff0000, v228
    v_lshlrev_b32 v22, 16, v229
    v_and_b32 v23, 0xffff0000, v229
    v_lshlrev_b32 v24, 16, v230
    v_and_b32 v25, 0xffff0000, v230
    v_lshlrev_b32 v26, 16, v231
    v_and_b32 v27, 0xffff0000, v231
    v_mul_f32 v20, v20, v24
    v_mul_f32 v21, v21, v25
    v_mul_f32 v22, v22, v26
    v_mul_f32 v23, v23, v27
    v_cvt_pk_bf16_f32 v226, v20, v21
    v_cvt_pk_bf16_f32 v227, v22, v23

    s_mov_b32 s36, 443392
    buffer_store_dwordx4 v[224:227], v16, s[20:23], s36 offen sc1
    s_waitcnt lgkmcnt(4)
    v_lshlrev_b32 v20, 16, v232
    v_and_b32 v21, 0xffff0000, v232
    v_lshlrev_b32 v22, 16, v233
    v_and_b32 v23, 0xffff0000, v233
    v_lshlrev_b32 v24, 16, v234
    v_and_b32 v25, 0xffff0000, v234
    v_lshlrev_b32 v26, 16, v235
    v_and_b32 v27, 0xffff0000, v235
    v_mul_f32 v20, v20, v24
    v_mul_f32 v21, v21, v25
    v_mul_f32 v22, v22, v26
    v_mul_f32 v23, v23, v27
    v_cvt_pk_bf16_f32 v232, v20, v21
    v_cvt_pk_bf16_f32 v233, v22, v23

    v_lshlrev_b32 v20, 16, v236
    v_and_b32 v21, 0xffff0000, v236
    v_lshlrev_b32 v22, 16, v237
    v_and_b32 v23, 0xffff0000, v237
    v_lshlrev_b32 v24, 16, v238
    v_and_b32 v25, 0xffff0000, v238
    v_lshlrev_b32 v26, 16, v239
    v_and_b32 v27, 0xffff0000, v239
    v_mul_f32 v20, v20, v24
    v_mul_f32 v21, v21, v25
    v_mul_f32 v22, v22, v26
    v_mul_f32 v23, v23, v27
    v_cvt_pk_bf16_f32 v234, v20, v21
    v_cvt_pk_bf16_f32 v235, v22, v23

    s_mov_b32 s36, 444416
    buffer_store_dwordx4 v[232:235], v16, s[20:23], s36 offen sc1
    s_waitcnt lgkmcnt(2)
    v_lshlrev_b32 v20, 16, v240
    v_and_b32 v21, 0xffff0000, v240
    v_lshlrev_b32 v22, 16, v241
    v_and_b32 v23, 0xffff0000, v241
    v_lshlrev_b32 v24, 16, v242
    v_and_b32 v25, 0xffff0000, v242
    v_lshlrev_b32 v26, 16, v243
    v_and_b32 v27, 0xffff0000, v243
    v_mul_f32 v20, v20, v24
    v_mul_f32 v21, v21, v25
    v_mul_f32 v22, v22, v26
    v_mul_f32 v23, v23, v27
    v_cvt_pk_bf16_f32 v240, v20, v21
    v_cvt_pk_bf16_f32 v241, v22, v23

    v_lshlrev_b32 v20, 16, v244
    v_and_b32 v21, 0xffff0000, v244
    v_lshlrev_b32 v22, 16, v245
    v_and_b32 v23, 0xffff0000, v245
    v_lshlrev_b32 v24, 16, v246
    v_and_b32 v25, 0xffff0000, v246
    v_lshlrev_b32 v26, 16, v247
    v_and_b32 v27, 0xffff0000, v247
    v_mul_f32 v20, v20, v24
    v_mul_f32 v21, v21, v25
    v_mul_f32 v22, v22, v26
    v_mul_f32 v23, v23, v27
    v_cvt_pk_bf16_f32 v242, v20, v21
    v_cvt_pk_bf16_f32 v243, v22, v23

    s_mov_b32 s36, 445440
    buffer_store_dwordx4 v[240:243], v16, s[20:23], s36 offen sc1
    s_waitcnt lgkmcnt(0)
    v_lshlrev_b32 v20, 16, v248
    v_and_b32 v21, 0xffff0000, v248
    v_lshlrev_b32 v22, 16, v249
    v_and_b32 v23, 0xffff0000, v249
    v_lshlrev_b32 v24, 16, v250
    v_and_b32 v25, 0xffff0000, v250
    v_lshlrev_b32 v26, 16, v251
    v_and_b32 v27, 0xffff0000, v251
    v_mul_f32 v20, v20, v24
    v_mul_f32 v21, v21, v25
    v_mul_f32 v22, v22, v26
    v_mul_f32 v23, v23, v27
    v_cvt_pk_bf16_f32 v248, v20, v21
    v_cvt_pk_bf16_f32 v249, v22, v23

    v_lshlrev_b32 v20, 16, v252
    v_and_b32 v21, 0xffff0000, v252
    v_lshlrev_b32 v22, 16, v253
    v_and_b32 v23, 0xffff0000, v253
    v_lshlrev_b32 v24, 16, v254
    v_and_b32 v25, 0xffff0000, v254
    v_lshlrev_b32 v26, 16, v255
    v_and_b32 v27, 0xffff0000, v255
    v_mul_f32 v20, v20, v24
    v_mul_f32 v21, v21, v25
    v_mul_f32 v22, v22, v26
    v_mul_f32 v23, v23, v27
    v_cvt_pk_bf16_f32 v250, v20, v21
    v_cvt_pk_bf16_f32 v251, v22, v23

    s_mov_b32 s36, 446464
    buffer_store_dwordx4 v[248:251], v16, s[20:23], s36 offen sc1
    s_endpgm
g1_done:
    s_endpgm
.globl gemm2_kernel
.p2align 8
.type gemm2_kernel,@function
gemm2_kernel:
    s_load_dwordx2 s[4:5], s[0:1], 96
    s_load_dwordx2 s[6:7], s[0:1], 72
    s_load_dwordx2 s[8:9], s[0:1], 32
    s_load_dwordx2 s[10:11], s[0:1], 40
    s_load_dwordx2 s[60:61], s[0:1], 0
    s_load_dwordx2 s[62:63], s[0:1], 80
    s_load_dwordx2 s[64:65], s[0:1], 88
    s_cmp_ge_u32 s2, 448
    s_cbranch_scc1 g2_done
    s_nop 0
    v_lshrrev_b32 v1, 6, v0
    s_nop 0
    v_readfirstlane_b32 s24, v1
    v_and_b32 v1, 63, v0
    s_waitcnt lgkmcnt(0)
    s_cmp_ge_u32 s2, 256
    s_cbranch_scc1 conv_start
    s_and_b32 s25, s24, 3
    s_lshr_b32 s26, s24, 2
    s_and_b32 s29, s2, 7
    s_and_b32 s38, s29, 3
    s_lshr_b32 s29, s29, 2
    s_lshr_b32 s27, s2, 3
    s_and_b32 s28, s27, 3
    s_lshr_b32 s27, s27, 2
    s_lshl_b32 s29, s29, 3
    s_add_u32 s27, s27, s29

    s_add_u32 s12, s4, 4718592
    s_addc_u32 s13, s5, 0
    s_mov_b32 s14, 18874368
    s_mov_b32 s15, 0x00020000
    s_mov_b32 s16, s6
    s_mov_b32 s17, s7
    s_mov_b32 s18, 5308416
    s_mov_b32 s19, 0x00020000
    s_add_u32 s20, s4, 25952256
    s_addc_u32 s21, s5, 0
    s_mov_b32 s22, 18874368
    s_mov_b32 s23, 0x00020000
    s_lshl_b32 s32, s27, 3
    s_lshl_b32 s33, s25, 1
    s_add_u32 s32, s32, s33
    s_mul_i32 s33, s32, 147456
    s_mul_i32 s34, s38, 36864
    s_add_u32 s33, s33, s34
    s_lshl_b32 s34, s26, 10
    s_add_u32 s33, s33, s34
    v_lshlrev_b32 v2, 4, v1
    v_add_u32 v2, s33, v2
    v_add_u32 v3, 147456, v2
    s_mul_i32 s33, s38, 1152
    s_lshl_b32 s34, s24, 3
    s_add_u32 s33, s33, s34
    s_mul_i32 s33, s33, 1152
    s_mul_i32 s34, s28, 288
    s_add_u32 s33, s33, s34

    v_add_u32 v20, 0, v1
    v_mul_u32_u24 v21, 3641, v20
    v_lshrrev_b32 v21, 16, v21
    v_mul_u32_u24 v22, 18, v21
    v_sub_u32 v22, v20, v22
    v_mul_u32_u24 v21, 1152, v21
    v_lshl_add_u32 v21, v22, 4, v21
    v_add_u32 v4, s33, v21

    v_add_u32 v20, 64, v1
    v_mul_u32_u24 v21, 3641, v20
    v_lshrrev_b32 v21, 16, v21
    v_mul_u32_u24 v22, 18, v21
    v_sub_u32 v22, v20, v22
    v_mul_u32_u24 v21, 1152, v21
    v_lshl_add_u32 v21, v22, 4, v21
    v_add_u32 v5, s33, v21

    v_add_u32 v20, 128, v1
    v_mul_u32_u24 v21, 3641, v20
    v_lshrrev_b32 v21, 16, v21
    v_mul_u32_u24 v22, 18, v21
    v_sub_u32 v22, v20, v22
    v_mul_u32_u24 v21, 1152, v21
    v_lshl_add_u32 v21, v22, 4, v21
    v_add_u32 v6, s33, v21

    s_mul_i32 s31, s24, 2304
    v_lshrrev_b32 v8, 2, v1
    v_mul_u32_u24 v8, 288, v8
    v_and_b32 v9, 3, v1
    v_lshl_add_u32 v8, v9, 3, v8
    s_mul_i32 s34, s26, 9216
    v_add_u32 v8, s34, v8

    v_add_u32 v9, 18432, v8
    v_add_u32 v10, 36864, v8
    v_add_u32 v11, 55296, v8

    s_mov_b32 s36, 0
    buffer_load_dwordx4 v[12:15], v2, s[12:15], s36 offen
    buffer_load_dwordx4 v[16:19], v3, s[12:15], s36 offen
    s_mov_b32 s37, 0
    s_add_u32 m0, s31, 0
    s_nop 0
    buffer_load_dwordx4 v4, s[16:19], s37 offen lds
    s_add_u32 m0, s31, 1024
    s_nop 0
    buffer_load_dwordx4 v5, s[16:19], s37 offen lds
    s_add_u32 m0, s31, 2048
    s_mov_b64 exec, 0xffff
    buffer_load_dwordx4 v6, s[16:19], s37 offen lds
    s_mov_b64 exec, -1
    s_mov_b32 s36, 2048
    buffer_load_dwordx4 v[20:23], v2, s[12:15], s36 offen
    buffer_load_dwordx4 v[24:27], v3, s[12:15], s36 offen
    s_mov_b32 s37, 73728
    s_add_u32 m0, s31, 18432
    s_nop 0
    buffer_load_dwordx4 v4, s[16:19], s37 offen lds
    s_add_u32 m0, s31, 19456
    s_nop 0
    buffer_load_dwordx4 v5, s[16:19], s37 offen lds
    s_add_u32 m0, s31, 20480
    s_mov_b64 exec, 0xffff
    buffer_load_dwordx4 v6, s[16:19], s37 offen lds
    s_mov_b64 exec, -1
    s_mov_b32 s36, 4096
    buffer_load_dwordx4 v[28:31], v2, s[12:15], s36 offen
    buffer_load_dwordx4 v[32:35], v3, s[12:15], s36 offen
    s_mov_b32 s37, 147456
    s_add_u32 m0, s31, 36864
    s_nop 0
    buffer_load_dwordx4 v4, s[16:19], s37 offen lds
    s_add_u32 m0, s31, 37888
    s_nop 0
    buffer_load_dwordx4 v5, s[16:19], s37 offen lds
    s_add_u32 m0, s31, 38912
    s_mov_b64 exec, 0xffff
    buffer_load_dwordx4 v6, s[16:19], s37 offen lds
    s_mov_b64 exec, -1
    s_waitcnt vmcnt(10)
    s_barrier
    ds_read_b64_tr_b16 v[44:45], v8 offset:0
    ds_read_b64_tr_b16 v[46:47], v8 offset:4608
    ds_read_b64_tr_b16 v[48:49], v8 offset:32
    ds_read_b64_tr_b16 v[50:51], v8 offset:4640
    ds_read_b64_tr_b16 v[52:53], v8 offset:64
    ds_read_b64_tr_b16 v[54:55], v8 offset:4672
    s_waitcnt vmcnt(13)
    s_waitcnt lgkmcnt(4)
    v_mfma_f32_16x16x32_bf16 v[56:59], v[44:47], v[12:15], 0
    v_mfma_f32_16x16x32_bf16 v[92:95], v[44:47], v[16:19], 0
    ds_read_b64_tr_b16 v[44:45], v8 offset:96
    ds_read_b64_tr_b16 v[46:47], v8 offset:4704
    s_waitcnt lgkmcnt(4)
    v_mfma_f32_16x16x32_bf16 v[60:63], v[48:51], v[12:15], 0
    v_mfma_f32_16x16x32_bf16 v[96:99], v[48:51], v[16:19], 0
    s_waitcnt vmcnt(5)
    s_barrier
    ds_read_b64_tr_b16 v[48:49], v8 offset:128
    ds_read_b64_tr_b16 v[50:51], v8 offset:4736
    s_waitcnt lgkmcnt(4)
    v_mfma_f32_16x16x32_bf16 v[64:67], v[52:55], v[12:15], 0
    v_mfma_f32_16x16x32_bf16 v[100:103], v[52:55], v[16:19], 0
    ds_read_b64_tr_b16 v[52:53], v8 offset:160
    ds_read_b64_tr_b16 v[54:55], v8 offset:4768
    s_mov_b32 s37, 221184
    s_add_u32 m0, s31, 55296
    s_nop 0
    buffer_load_dwordx4 v4, s[16:19], s37 offen lds
    s_waitcnt lgkmcnt(4)
    v_mfma_f32_16x16x32_bf16 v[68:71], v[44:47], v[12:15], 0
    v_mfma_f32_16x16x32_bf16 v[104:107], v[44:47], v[16:19], 0
    ds_read_b64_tr_b16 v[44:45], v8 offset:192
    ds_read_b64_tr_b16 v[46:47], v8 offset:4800
    s_add_u32 m0, s31, 56320
    s_nop 0
    buffer_load_dwordx4 v5, s[16:19], s37 offen lds
    s_waitcnt lgkmcnt(4)
    v_mfma_f32_16x16x32_bf16 v[72:75], v[48:51], v[12:15], 0
    v_mfma_f32_16x16x32_bf16 v[108:111], v[48:51], v[16:19], 0
    ds_read_b64_tr_b16 v[48:49], v8 offset:224
    ds_read_b64_tr_b16 v[50:51], v8 offset:4832
    s_add_u32 m0, s31, 57344
    s_mov_b64 exec, 0xffff
    buffer_load_dwordx4 v6, s[16:19], s37 offen lds
    s_mov_b64 exec, -1
    s_waitcnt lgkmcnt(4)
    v_mfma_f32_16x16x32_bf16 v[76:79], v[52:55], v[12:15], 0
    v_mfma_f32_16x16x32_bf16 v[112:115], v[52:55], v[16:19], 0
    ds_read_b64_tr_b16 v[52:53], v8 offset:256
    ds_read_b64_tr_b16 v[54:55], v8 offset:4864
    s_mov_b32 s36, 6144
    buffer_load_dwordx4 v[36:39], v2, s[12:15], s36 offen
    s_waitcnt lgkmcnt(4)
    v_mfma_f32_16x16x32_bf16 v[80:83], v[44:47], v[12:15], 0
    v_mfma_f32_16x16x32_bf16 v[116:119], v[44:47], v[16:19], 0
    ds_read_b64_tr_b16 v[44:45], v9 offset:0
    ds_read_b64_tr_b16 v[46:47], v9 offset:4608
    buffer_load_dwordx4 v[40:43], v3, s[12:15], s36 offen
    s_waitcnt lgkmcnt(4)
    v_mfma_f32_16x16x32_bf16 v[84:87], v[48:51], v[12:15], 0
    v_mfma_f32_16x16x32_bf16 v[120:123], v[48:51], v[16:19], 0
    ds_read_b64_tr_b16 v[48:49], v9 offset:32
    ds_read_b64_tr_b16 v[50:51], v9 offset:4640
    s_waitcnt lgkmcnt(4)
    v_mfma_f32_16x16x32_bf16 v[88:91], v[52:55], v[12:15], 0
    v_mfma_f32_16x16x32_bf16 v[124:127], v[52:55], v[16:19], 0
    ds_read_b64_tr_b16 v[52:53], v9 offset:64
    ds_read_b64_tr_b16 v[54:55], v9 offset:4672
    s_waitcnt vmcnt(13)
    s_waitcnt lgkmcnt(4)
    v_mfma_f32_16x16x32_bf16 v[56:59], v[44:47], v[20:23], v[56:59]
    v_mfma_f32_16x16x32_bf16 v[92:95], v[44:47], v[24:27], v[92:95]
    ds_read_b64_tr_b16 v[44:45], v9 offset:96
    ds_read_b64_tr_b16 v[46:47], v9 offset:4704
    s_waitcnt lgkmcnt(4)
    v_mfma_f32_16x16x32_bf16 v[60:63], v[48:51], v[20:23], v[60:63]
    v_mfma_f32_16x16x32_bf16 v[96:99], v[48:51], v[24:27], v[96:99]
    s_waitcnt vmcnt(5)
    s_barrier
    ds_read_b64_tr_b16 v[48:49], v9 offset:128
    ds_read_b64_tr_b16 v[50:51], v9 offset:4736
    s_waitcnt lgkmcnt(4)
    v_mfma_f32_16x16x32_bf16 v[64:67], v[52:55], v[20:23], v[64:67]
    v_mfma_f32_16x16x32_bf16 v[100:103], v[52:55], v[24:27], v[100:103]
    ds_read_b64_tr_b16 v[52:53], v9 offset:160
    ds_read_b64_tr_b16 v[54:55], v9 offset:4768
    s_mov_b32 s37, 294912
    s_add_u32 m0, s31, 0
    s_nop 0
    buffer_load_dwordx4 v4, s[16:19], s37 offen lds
    s_waitcnt lgkmcnt(4)
    v_mfma_f32_16x16x32_bf16 v[68:71], v[44:47], v[20:23], v[68:71]
    v_mfma_f32_16x16x32_bf16 v[104:107], v[44:47], v[24:27], v[104:107]
    ds_read_b64_tr_b16 v[44:45], v9 offset:192
    ds_read_b64_tr_b16 v[46:47], v9 offset:4800
    s_add_u32 m0, s31, 1024
    s_nop 0
    buffer_load_dwordx4 v5, s[16:19], s37 offen lds
    s_waitcnt lgkmcnt(4)
    v_mfma_f32_16x16x32_bf16 v[72:75], v[48:51], v[20:23], v[72:75]
    v_mfma_f32_16x16x32_bf16 v[108:111], v[48:51], v[24:27], v[108:111]
    ds_read_b64_tr_b16 v[48:49], v9 offset:224
    ds_read_b64_tr_b16 v[50:51], v9 offset:4832
    s_add_u32 m0, s31, 2048
    s_mov_b64 exec, 0xffff
    buffer_load_dwordx4 v6, s[16:19], s37 offen lds
    s_mov_b64 exec, -1
    s_waitcnt lgkmcnt(4)
    v_mfma_f32_16x16x32_bf16 v[76:79], v[52:55], v[20:23], v[76:79]
    v_mfma_f32_16x16x32_bf16 v[112:115], v[52:55], v[24:27], v[112:115]
    ds_read_b64_tr_b16 v[52:53], v9 offset:256
    ds_read_b64_tr_b16 v[54:55], v9 offset:4864
    s_mov_b32 s36, 8192
    buffer_load_dwordx4 v[12:15], v2, s[12:15], s36 offen
    s_waitcnt lgkmcnt(4)
    v_mfma_f32_16x16x32_bf16 v[80:83], v[44:47], v[20:23], v[80:83]
    v_mfma_f32_16x16x32_bf16 v[116:119], v[44:47], v[24:27], v[116:119]
    ds_read_b64_tr_b16 v[44:45], v10 offset:0
    ds_read_b64_tr_b16 v[46:47], v10 offset:4608
    buffer_load_dwordx4 v[16:19], v3, s[12:15], s36 offen
    s_waitcnt lgkmcnt(4)
    v_mfma_f32_16x16x32_bf16 v[84:87], v[48:51], v[20:23], v[84:87]
    v_mfma_f32_16x16x32_bf16 v[120:123], v[48:51], v[24:27], v[120:123]
    ds_read_b64_tr_b16 v[48:49], v10 offset:32
    ds_read_b64_tr_b16 v[50:51], v10 offset:4640
    s_waitcnt lgkmcnt(4)
    v_mfma_f32_16x16x32_bf16 v[88:91], v[52:55], v[20:23], v[88:91]
    v_mfma_f32_16x16x32_bf16 v[124:127], v[52:55], v[24:27], v[124:127]
    ds_read_b64_tr_b16 v[52:53], v10 offset:64
    ds_read_b64_tr_b16 v[54:55], v10 offset:4672
    s_waitcnt vmcnt(13)
    s_waitcnt lgkmcnt(4)
    v_mfma_f32_16x16x32_bf16 v[56:59], v[44:47], v[28:31], v[56:59]
    v_mfma_f32_16x16x32_bf16 v[92:95], v[44:47], v[32:35], v[92:95]
    ds_read_b64_tr_b16 v[44:45], v10 offset:96
    ds_read_b64_tr_b16 v[46:47], v10 offset:4704
    s_waitcnt lgkmcnt(4)
    v_mfma_f32_16x16x32_bf16 v[60:63], v[48:51], v[28:31], v[60:63]
    v_mfma_f32_16x16x32_bf16 v[96:99], v[48:51], v[32:35], v[96:99]
    s_waitcnt vmcnt(7)
    s_barrier
    ds_read_b64_tr_b16 v[48:49], v10 offset:128
    ds_read_b64_tr_b16 v[50:51], v10 offset:4736
    s_waitcnt lgkmcnt(4)
    v_mfma_f32_16x16x32_bf16 v[64:67], v[52:55], v[28:31], v[64:67]
    v_mfma_f32_16x16x32_bf16 v[100:103], v[52:55], v[32:35], v[100:103]
    ds_read_b64_tr_b16 v[52:53], v10 offset:160
    ds_read_b64_tr_b16 v[54:55], v10 offset:4768
    s_mov_b32 s37, 368640
    s_add_u32 m0, s31, 18432
    s_nop 0
    buffer_load_dwordx4 v4, s[16:19], s37 offen lds
    s_waitcnt lgkmcnt(4)
    v_mfma_f32_16x16x32_bf16 v[68:71], v[44:47], v[28:31], v[68:71]
    v_mfma_f32_16x16x32_bf16 v[104:107], v[44:47], v[32:35], v[104:107]
    ds_read_b64_tr_b16 v[44:45], v10 offset:192
    ds_read_b64_tr_b16 v[46:47], v10 offset:4800
    s_add_u32 m0, s31, 19456
    s_nop 0
    buffer_load_dwordx4 v5, s[16:19], s37 offen lds
    s_waitcnt lgkmcnt(4)
    v_mfma_f32_16x16x32_bf16 v[72:75], v[48:51], v[28:31], v[72:75]
    v_mfma_f32_16x16x32_bf16 v[108:111], v[48:51], v[32:35], v[108:111]
    ds_read_b64_tr_b16 v[48:49], v10 offset:224
    ds_read_b64_tr_b16 v[50:51], v10 offset:4832
    s_add_u32 m0, s31, 20480
    s_mov_b64 exec, 0xffff
    buffer_load_dwordx4 v6, s[16:19], s37 offen lds
    s_mov_b64 exec, -1
    s_waitcnt lgkmcnt(4)
    v_mfma_f32_16x16x32_bf16 v[76:79], v[52:55], v[28:31], v[76:79]
    v_mfma_f32_16x16x32_bf16 v[112:115], v[52:55], v[32:35], v[112:115]
    ds_read_b64_tr_b16 v[52:53], v10 offset:256
    ds_read_b64_tr_b16 v[54:55], v10 offset:4864
    s_mov_b32 s36, 10240
    buffer_load_dwordx4 v[20:23], v2, s[12:15], s36 offen
    s_waitcnt lgkmcnt(4)
    v_mfma_f32_16x16x32_bf16 v[80:83], v[44:47], v[28:31], v[80:83]
    v_mfma_f32_16x16x32_bf16 v[116:119], v[44:47], v[32:35], v[116:119]
    ds_read_b64_tr_b16 v[44:45], v11 offset:0
    ds_read_b64_tr_b16 v[46:47], v11 offset:4608
    buffer_load_dwordx4 v[24:27], v3, s[12:15], s36 offen
    s_waitcnt lgkmcnt(4)
    v_mfma_f32_16x16x32_bf16 v[84:87], v[48:51], v[28:31], v[84:87]
    v_mfma_f32_16x16x32_bf16 v[120:123], v[48:51], v[32:35], v[120:123]
    ds_read_b64_tr_b16 v[48:49], v11 offset:32
    ds_read_b64_tr_b16 v[50:51], v11 offset:4640
    s_waitcnt lgkmcnt(4)
    v_mfma_f32_16x16x32_bf16 v[88:91], v[52:55], v[28:31], v[88:91]
    v_mfma_f32_16x16x32_bf16 v[124:127], v[52:55], v[32:35], v[124:127]
    ds_read_b64_tr_b16 v[52:53], v11 offset:64
    ds_read_b64_tr_b16 v[54:55], v11 offset:4672
    s_waitcnt vmcnt(10)
    s_waitcnt lgkmcnt(4)
    v_mfma_f32_16x16x32_bf16 v[56:59], v[44:47], v[36:39], v[56:59]
    v_mfma_f32_16x16x32_bf16 v[92:95], v[44:47], v[40:43], v[92:95]
    ds_read_b64_tr_b16 v[44:45], v11 offset:96
    ds_read_b64_tr_b16 v[46:47], v11 offset:4704
    s_waitcnt lgkmcnt(4)
    v_mfma_f32_16x16x32_bf16 v[60:63], v[48:51], v[36:39], v[60:63]
    v_mfma_f32_16x16x32_bf16 v[96:99], v[48:51], v[40:43], v[96:99]
    s_waitcnt vmcnt(7)
    s_barrier
    ds_read_b64_tr_b16 v[48:49], v11 offset:128
    ds_read_b64_tr_b16 v[50:51], v11 offset:4736
    s_waitcnt lgkmcnt(4)
    v_mfma_f32_16x16x32_bf16 v[64:67], v[52:55], v[36:39], v[64:67]
    v_mfma_f32_16x16x32_bf16 v[100:103], v[52:55], v[40:43], v[100:103]
    ds_read_b64_tr_b16 v[52:53], v11 offset:160
    ds_read_b64_tr_b16 v[54:55], v11 offset:4768
    s_mov_b32 s37, 442368
    s_add_u32 m0, s31, 36864
    s_nop 0
    buffer_load_dwordx4 v4, s[16:19], s37 offen lds
    s_waitcnt lgkmcnt(4)
    v_mfma_f32_16x16x32_bf16 v[68:71], v[44:47], v[36:39], v[68:71]
    v_mfma_f32_16x16x32_bf16 v[104:107], v[44:47], v[40:43], v[104:107]
    ds_read_b64_tr_b16 v[44:45], v11 offset:192
    ds_read_b64_tr_b16 v[46:47], v11 offset:4800
    s_add_u32 m0, s31, 37888
    s_nop 0
    buffer_load_dwordx4 v5, s[16:19], s37 offen lds
    s_waitcnt lgkmcnt(4)
    v_mfma_f32_16x16x32_bf16 v[72:75], v[48:51], v[36:39], v[72:75]
    v_mfma_f32_16x16x32_bf16 v[108:111], v[48:51], v[40:43], v[108:111]
    ds_read_b64_tr_b16 v[48:49], v11 offset:224
    ds_read_b64_tr_b16 v[50:51], v11 offset:4832
    s_add_u32 m0, s31, 38912
    s_mov_b64 exec, 0xffff
    buffer_load_dwordx4 v6, s[16:19], s37 offen lds
    s_mov_b64 exec, -1
    s_waitcnt lgkmcnt(4)
    v_mfma_f32_16x16x32_bf16 v[76:79], v[52:55], v[36:39], v[76:79]
    v_mfma_f32_16x16x32_bf16 v[112:115], v[52:55], v[40:43], v[112:115]
    ds_read_b64_tr_b16 v[52:53], v11 offset:256
    ds_read_b64_tr_b16 v[54:55], v11 offset:4864
    s_mov_b32 s36, 12288
    buffer_load_dwordx4 v[28:31], v2, s[12:15], s36 offen
    s_waitcnt lgkmcnt(4)
    v_mfma_f32_16x16x32_bf16 v[80:83], v[44:47], v[36:39], v[80:83]
    v_mfma_f32_16x16x32_bf16 v[116:119], v[44:47], v[40:43], v[116:119]
    ds_read_b64_tr_b16 v[44:45], v8 offset:0
    ds_read_b64_tr_b16 v[46:47], v8 offset:4608
    buffer_load_dwordx4 v[32:35], v3, s[12:15], s36 offen
    s_waitcnt lgkmcnt(4)
    v_mfma_f32_16x16x32_bf16 v[84:87], v[48:51], v[36:39], v[84:87]
    v_mfma_f32_16x16x32_bf16 v[120:123], v[48:51], v[40:43], v[120:123]
    ds_read_b64_tr_b16 v[48:49], v8 offset:32
    ds_read_b64_tr_b16 v[50:51], v8 offset:4640
    s_waitcnt lgkmcnt(4)
    v_mfma_f32_16x16x32_bf16 v[88:91], v[52:55], v[36:39], v[88:91]
    v_mfma_f32_16x16x32_bf16 v[124:127], v[52:55], v[40:43], v[124:127]
    ds_read_b64_tr_b16 v[52:53], v8 offset:64
    ds_read_b64_tr_b16 v[54:55], v8 offset:4672
    s_waitcnt vmcnt(10)
    s_waitcnt lgkmcnt(4)
    v_mfma_f32_16x16x32_bf16 v[56:59], v[44:47], v[12:15], v[56:59]
    v_mfma_f32_16x16x32_bf16 v[92:95], v[44:47], v[16:19], v[92:95]
    ds_read_b64_tr_b16 v[44:45], v8 offset:96
    ds_read_b64_tr_b16 v[46:47], v8 offset:4704
    s_waitcnt lgkmcnt(4)
    v_mfma_f32_16x16x32_bf16 v[60:63], v[48:51], v[12:15], v[60:63]
    v_mfma_f32_16x16x32_bf16 v[96:99], v[48:51], v[16:19], v[96:99]
    s_waitcnt vmcnt(7)
    s_barrier
    ds_read_b64_tr_b16 v[48:49], v8 offset:128
    ds_read_b64_tr_b16 v[50:51], v8 offset:4736
    s_waitcnt lgkmcnt(4)
    v_mfma_f32_16x16x32_bf16 v[64:67], v[52:55], v[12:15], v[64:67]
    v_mfma_f32_16x16x32_bf16 v[100:103], v[52:55], v[16:19], v[100:103]
    ds_read_b64_tr_b16 v[52:53], v8 offset:160
    ds_read_b64_tr_b16 v[54:55], v8 offset:4768
    s_mov_b32 s37, 516096
    s_add_u32 m0, s31, 55296
    s_nop 0
    buffer_load_dwordx4 v4, s[16:19], s37 offen lds
    s_waitcnt lgkmcnt(4)
    v_mfma_f32_16x16x32_bf16 v[68:71], v[44:47], v[12:15], v[68:71]
    v_mfma_f32_16x16x32_bf16 v[104:107], v[44:47], v[16:19], v[104:107]
    ds_read_b64_tr_b16 v[44:45], v8 offset:192
    ds_read_b64_tr_b16 v[46:47], v8 offset:4800
    s_add_u32 m0, s31, 56320
    s_nop 0
    buffer_load_dwordx4 v5, s[16:19], s37 offen lds
    s_waitcnt lgkmcnt(4)
    v_mfma_f32_16x16x32_bf16 v[72:75], v[48:51], v[12:15], v[72:75]
    v_mfma_f32_16x16x32_bf16 v[108:111], v[48:51], v[16:19], v[108:111]
    ds_read_b64_tr_b16 v[48:49], v8 offset:224
    ds_read_b64_tr_b16 v[50:51], v8 offset:4832
    s_add_u32 m0, s31, 57344
    s_mov_b64 exec, 0xffff
    buffer_load_dwordx4 v6, s[16:19], s37 offen lds
    s_mov_b64 exec, -1
    s_waitcnt lgkmcnt(4)
    v_mfma_f32_16x16x32_bf16 v[76:79], v[52:55], v[12:15], v[76:79]
    v_mfma_f32_16x16x32_bf16 v[112:115], v[52:55], v[16:19], v[112:115]
    ds_read_b64_tr_b16 v[52:53], v8 offset:256
    ds_read_b64_tr_b16 v[54:55], v8 offset:4864
    s_mov_b32 s36, 14336
    buffer_load_dwordx4 v[36:39], v2, s[12:15], s36 offen
    s_waitcnt lgkmcnt(4)
    v_mfma_f32_16x16x32_bf16 v[80:83], v[44:47], v[12:15], v[80:83]
    v_mfma_f32_16x16x32_bf16 v[116:119], v[44:47], v[16:19], v[116:119]
    ds_read_b64_tr_b16 v[44:45], v9 offset:0
    ds_read_b64_tr_b16 v[46:47], v9 offset:4608
    buffer_load_dwordx4 v[40:43], v3, s[12:15], s36 offen
    s_waitcnt lgkmcnt(4)
    v_mfma_f32_16x16x32_bf16 v[84:87], v[48:51], v[12:15], v[84:87]
    v_mfma_f32_16x16x32_bf16 v[120:123], v[48:51], v[16:19], v[120:123]
    ds_read_b64_tr_b16 v[48:49], v9 offset:32
    ds_read_b64_tr_b16 v[50:51], v9 offset:4640
    s_waitcnt lgkmcnt(4)
    v_mfma_f32_16x16x32_bf16 v[88:91], v[52:55], v[12:15], v[88:91]
    v_mfma_f32_16x16x32_bf16 v[124:127], v[52:55], v[16:19], v[124:127]
    ds_read_b64_tr_b16 v[52:53], v9 offset:64
    ds_read_b64_tr_b16 v[54:55], v9 offset:4672
    s_waitcnt vmcnt(10)
    s_waitcnt lgkmcnt(4)
    v_mfma_f32_16x16x32_bf16 v[56:59], v[44:47], v[20:23], v[56:59]
    v_mfma_f32_16x16x32_bf16 v[92:95], v[44:47], v[24:27], v[92:95]
    ds_read_b64_tr_b16 v[44:45], v9 offset:96
    ds_read_b64_tr_b16 v[46:47], v9 offset:4704
    s_waitcnt lgkmcnt(4)
    v_mfma_f32_16x16x32_bf16 v[60:63], v[48:51], v[20:23], v[60:63]
    v_mfma_f32_16x16x32_bf16 v[96:99], v[48:51], v[24:27], v[96:99]
    s_waitcnt vmcnt(7)
    s_barrier
    ds_read_b64_tr_b16 v[48:49], v9 offset:128
    ds_read_b64_tr_b16 v[50:51], v9 offset:4736
    s_waitcnt lgkmcnt(4)
    v_mfma_f32_16x16x32_bf16 v[64:67], v[52:55], v[20:23], v[64:67]
    v_mfma_f32_16x16x32_bf16 v[100:103], v[52:55], v[24:27], v[100:103]
    ds_read_b64_tr_b16 v[52:53], v9 offset:160
    ds_read_b64_tr_b16 v[54:55], v9 offset:4768
    s_mov_b32 s37, 589824
    s_add_u32 m0, s31, 0
    s_nop 0
    buffer_load_dwordx4 v4, s[16:19], s37 offen lds
    s_waitcnt lgkmcnt(4)
    v_mfma_f32_16x16x32_bf16 v[68:71], v[44:47], v[20:23], v[68:71]
    v_mfma_f32_16x16x32_bf16 v[104:107], v[44:47], v[24:27], v[104:107]
    ds_read_b64_tr_b16 v[44:45], v9 offset:192
    ds_read_b64_tr_b16 v[46:47], v9 offset:4800
    s_add_u32 m0, s31, 1024
    s_nop 0
    buffer_load_dwordx4 v5, s[16:19], s37 offen lds
    s_waitcnt lgkmcnt(4)
    v_mfma_f32_16x16x32_bf16 v[72:75], v[48:51], v[20:23], v[72:75]
    v_mfma_f32_16x16x32_bf16 v[108:111], v[48:51], v[24:27], v[108:111]
    ds_read_b64_tr_b16 v[48:49], v9 offset:224
    ds_read_b64_tr_b16 v[50:51], v9 offset:4832
    s_add_u32 m0, s31, 2048
    s_mov_b64 exec, 0xffff
    buffer_load_dwordx4 v6, s[16:19], s37 offen lds
    s_mov_b64 exec, -1
    s_waitcnt lgkmcnt(4)
    v_mfma_f32_16x16x32_bf16 v[76:79], v[52:55], v[20:23], v[76:79]
    v_mfma_f32_16x16x32_bf16 v[112:115], v[52:55], v[24:27], v[112:115]
    ds_read_b64_tr_b16 v[52:53], v9 offset:256
    ds_read_b64_tr_b16 v[54:55], v9 offset:4864
    s_mov_b32 s36, 16384
    buffer_load_dwordx4 v[12:15], v2, s[12:15], s36 offen
    s_waitcnt lgkmcnt(4)
    v_mfma_f32_16x16x32_bf16 v[80:83], v[44:47], v[20:23], v[80:83]
    v_mfma_f32_16x16x32_bf16 v[116:119], v[44:47], v[24:27], v[116:119]
    ds_read_b64_tr_b16 v[44:45], v10 offset:0
    ds_read_b64_tr_b16 v[46:47], v10 offset:4608
    buffer_load_dwordx4 v[16:19], v3, s[12:15], s36 offen
    s_waitcnt lgkmcnt(4)
    v_mfma_f32_16x16x32_bf16 v[84:87], v[48:51], v[20:23], v[84:87]
    v_mfma_f32_16x16x32_bf16 v[120:123], v[48:51], v[24:27], v[120:123]
    ds_read_b64_tr_b16 v[48:49], v10 offset:32
    ds_read_b64_tr_b16 v[50:51], v10 offset:4640
    s_waitcnt lgkmcnt(4)
    v_mfma_f32_16x16x32_bf16 v[88:91], v[52:55], v[20:23], v[88:91]
    v_mfma_f32_16x16x32_bf16 v[124:127], v[52:55], v[24:27], v[124:127]
    ds_read_b64_tr_b16 v[52:53], v10 offset:64
    ds_read_b64_tr_b16 v[54:55], v10 offset:4672
    s_waitcnt vmcnt(10)
    s_waitcnt lgkmcnt(4)
    v_mfma_f32_16x16x32_bf16 v[56:59], v[44:47], v[28:31], v[56:59]
    v_mfma_f32_16x16x32_bf16 v[92:95], v[44:47], v[32:35], v[92:95]
    ds_read_b64_tr_b16 v[44:45], v10 offset:96
    ds_read_b64_tr_b16 v[46:47], v10 offset:4704
    s_waitcnt lgkmcnt(4)
    v_mfma_f32_16x16x32_bf16 v[60:63], v[48:51], v[28:31], v[60:63]
    v_mfma_f32_16x16x32_bf16 v[96:99], v[48:51], v[32:35], v[96:99]
    s_waitcnt vmcnt(7)
    s_barrier
    ds_read_b64_tr_b16 v[48:49], v10 offset:128
    ds_read_b64_tr_b16 v[50:51], v10 offset:4736
    s_waitcnt lgkmcnt(4)
    v_mfma_f32_16x16x32_bf16 v[64:67], v[52:55], v[28:31], v[64:67]
    v_mfma_f32_16x16x32_bf16 v[100:103], v[52:55], v[32:35], v[100:103]
    ds_read_b64_tr_b16 v[52:53], v10 offset:160
    ds_read_b64_tr_b16 v[54:55], v10 offset:4768
    s_mov_b32 s37, 663552
    s_add_u32 m0, s31, 18432
    s_nop 0
    buffer_load_dwordx4 v4, s[16:19], s37 offen lds
    s_waitcnt lgkmcnt(4)
    v_mfma_f32_16x16x32_bf16 v[68:71], v[44:47], v[28:31], v[68:71]
    v_mfma_f32_16x16x32_bf16 v[104:107], v[44:47], v[32:35], v[104:107]
    ds_read_b64_tr_b16 v[44:45], v10 offset:192
    ds_read_b64_tr_b16 v[46:47], v10 offset:4800
    s_add_u32 m0, s31, 19456
    s_nop 0
    buffer_load_dwordx4 v5, s[16:19], s37 offen lds
    s_waitcnt lgkmcnt(4)
    v_mfma_f32_16x16x32_bf16 v[72:75], v[48:51], v[28:31], v[72:75]
    v_mfma_f32_16x16x32_bf16 v[108:111], v[48:51], v[32:35], v[108:111]
    ds_read_b64_tr_b16 v[48:49], v10 offset:224
    ds_read_b64_tr_b16 v[50:51], v10 offset:4832
    s_add_u32 m0, s31, 20480
    s_mov_b64 exec, 0xffff
    buffer_load_dwordx4 v6, s[16:19], s37 offen lds
    s_mov_b64 exec, -1
    s_waitcnt lgkmcnt(4)
    v_mfma_f32_16x16x32_bf16 v[76:79], v[52:55], v[28:31], v[76:79]
    v_mfma_f32_16x16x32_bf16 v[112:115], v[52:55], v[32:35], v[112:115]
    ds_read_b64_tr_b16 v[52:53], v10 offset:256
    ds_read_b64_tr_b16 v[54:55], v10 offset:4864
    s_mov_b32 s36, 18432
    buffer_load_dwordx4 v[20:23], v2, s[12:15], s36 offen
    s_waitcnt lgkmcnt(4)
    v_mfma_f32_16x16x32_bf16 v[80:83], v[44:47], v[28:31], v[80:83]
    v_mfma_f32_16x16x32_bf16 v[116:119], v[44:47], v[32:35], v[116:119]
    ds_read_b64_tr_b16 v[44:45], v11 offset:0
    ds_read_b64_tr_b16 v[46:47], v11 offset:4608
    buffer_load_dwordx4 v[24:27], v3, s[12:15], s36 offen
    s_waitcnt lgkmcnt(4)
    v_mfma_f32_16x16x32_bf16 v[84:87], v[48:51], v[28:31], v[84:87]
    v_mfma_f32_16x16x32_bf16 v[120:123], v[48:51], v[32:35], v[120:123]
    ds_read_b64_tr_b16 v[48:49], v11 offset:32
    ds_read_b64_tr_b16 v[50:51], v11 offset:4640
    s_waitcnt lgkmcnt(4)
    v_mfma_f32_16x16x32_bf16 v[88:91], v[52:55], v[28:31], v[88:91]
    v_mfma_f32_16x16x32_bf16 v[124:127], v[52:55], v[32:35], v[124:127]
    ds_read_b64_tr_b16 v[52:53], v11 offset:64
    ds_read_b64_tr_b16 v[54:55], v11 offset:4672
    s_waitcnt vmcnt(10)
    s_waitcnt lgkmcnt(4)
    v_mfma_f32_16x16x32_bf16 v[56:59], v[44:47], v[36:39], v[56:59]
    v_mfma_f32_16x16x32_bf16 v[92:95], v[44:47], v[40:43], v[92:95]
    ds_read_b64_tr_b16 v[44:45], v11 offset:96
    ds_read_b64_tr_b16 v[46:47], v11 offset:4704
    s_waitcnt lgkmcnt(4)
    v_mfma_f32_16x16x32_bf16 v[60:63], v[48:51], v[36:39], v[60:63]
    v_mfma_f32_16x16x32_bf16 v[96:99], v[48:51], v[40:43], v[96:99]
    s_waitcnt vmcnt(7)
    s_barrier
    ds_read_b64_tr_b16 v[48:49], v11 offset:128
    ds_read_b64_tr_b16 v[50:51], v11 offset:4736
    s_waitcnt lgkmcnt(4)
    v_mfma_f32_16x16x32_bf16 v[64:67], v[52:55], v[36:39], v[64:67]
    v_mfma_f32_16x16x32_bf16 v[100:103], v[52:55], v[40:43], v[100:103]
    ds_read_b64_tr_b16 v[52:53], v11 offset:160
    ds_read_b64_tr_b16 v[54:55], v11 offset:4768
    s_mov_b32 s37, 737280
    s_add_u32 m0, s31, 36864
    s_nop 0
    buffer_load_dwordx4 v4, s[16:19], s37 offen lds
    s_waitcnt lgkmcnt(4)
    v_mfma_f32_16x16x32_bf16 v[68:71], v[44:47], v[36:39], v[68:71]
    v_mfma_f32_16x16x32_bf16 v[104:107], v[44:47], v[40:43], v[104:107]
    ds_read_b64_tr_b16 v[44:45], v11 offset:192
    ds_read_b64_tr_b16 v[46:47], v11 offset:4800
    s_add_u32 m0, s31, 37888
    s_nop 0
    buffer_load_dwordx4 v5, s[16:19], s37 offen lds
    s_waitcnt lgkmcnt(4)
    v_mfma_f32_16x16x32_bf16 v[72:75], v[48:51], v[36:39], v[72:75]
    v_mfma_f32_16x16x32_bf16 v[108:111], v[48:51], v[40:43], v[108:111]
    ds_read_b64_tr_b16 v[48:49], v11 offset:224
    ds_read_b64_tr_b16 v[50:51], v11 offset:4832
    s_add_u32 m0, s31, 38912
    s_mov_b64 exec, 0xffff
    buffer_load_dwordx4 v6, s[16:19], s37 offen lds
    s_mov_b64 exec, -1
    s_waitcnt lgkmcnt(4)
    v_mfma_f32_16x16x32_bf16 v[76:79], v[52:55], v[36:39], v[76:79]
    v_mfma_f32_16x16x32_bf16 v[112:115], v[52:55], v[40:43], v[112:115]
    ds_read_b64_tr_b16 v[52:53], v11 offset:256
    ds_read_b64_tr_b16 v[54:55], v11 offset:4864
    s_mov_b32 s36, 20480
    buffer_load_dwordx4 v[28:31], v2, s[12:15], s36 offen
    s_waitcnt lgkmcnt(4)
    v_mfma_f32_16x16x32_bf16 v[80:83], v[44:47], v[36:39], v[80:83]
    v_mfma_f32_16x16x32_bf16 v[116:119], v[44:47], v[40:43], v[116:119]
    ds_read_b64_tr_b16 v[44:45], v8 offset:0
    ds_read_b64_tr_b16 v[46:47], v8 offset:4608
    buffer_load_dwordx4 v[32:35], v3, s[12:15], s36 offen
    s_waitcnt lgkmcnt(4)
    v_mfma_f32_16x16x32_bf16 v[84:87], v[48:51], v[36:39], v[84:87]
    v_mfma_f32_16x16x32_bf16 v[120:123], v[48:51], v[40:43], v[120:123]
    ds_read_b64_tr_b16 v[48:49], v8 offset:32
    ds_read_b64_tr_b16 v[50:51], v8 offset:4640
    s_waitcnt lgkmcnt(4)
    v_mfma_f32_16x16x32_bf16 v[88:91], v[52:55], v[36:39], v[88:91]
    v_mfma_f32_16x16x32_bf16 v[124:127], v[52:55], v[40:43], v[124:127]
    ds_read_b64_tr_b16 v[52:53], v8 offset:64
    ds_read_b64_tr_b16 v[54:55], v8 offset:4672
    s_waitcnt vmcnt(10)
    s_waitcnt lgkmcnt(4)
    v_mfma_f32_16x16x32_bf16 v[56:59], v[44:47], v[12:15], v[56:59]
    v_mfma_f32_16x16x32_bf16 v[92:95], v[44:47], v[16:19], v[92:95]
    ds_read_b64_tr_b16 v[44:45], v8 offset:96
    ds_read_b64_tr_b16 v[46:47], v8 offset:4704
    s_waitcnt lgkmcnt(4)
    v_mfma_f32_16x16x32_bf16 v[60:63], v[48:51], v[12:15], v[60:63]
    v_mfma_f32_16x16x32_bf16 v[96:99], v[48:51], v[16:19], v[96:99]
    s_waitcnt vmcnt(7)
    s_barrier
    ds_read_b64_tr_b16 v[48:49], v8 offset:128
    ds_read_b64_tr_b16 v[50:51], v8 offset:4736
    s_waitcnt lgkmcnt(4)
    v_mfma_f32_16x16x32_bf16 v[64:67], v[52:55], v[12:15], v[64:67]
    v_mfma_f32_16x16x32_bf16 v[100:103], v[52:55], v[16:19], v[100:103]
    ds_read_b64_tr_b16 v[52:53], v8 offset:160
    ds_read_b64_tr_b16 v[54:55], v8 offset:4768
    s_mov_b32 s37, 811008
    s_add_u32 m0, s31, 55296
    s_nop 0
    buffer_load_dwordx4 v4, s[16:19], s37 offen lds
    s_waitcnt lgkmcnt(4)
    v_mfma_f32_16x16x32_bf16 v[68:71], v[44:47], v[12:15], v[68:71]
    v_mfma_f32_16x16x32_bf16 v[104:107], v[44:47], v[16:19], v[104:107]
    ds_read_b64_tr_b16 v[44:45], v8 offset:192
    ds_read_b64_tr_b16 v[46:47], v8 offset:4800
    s_add_u32 m0, s31, 56320
    s_nop 0
    buffer_load_dwordx4 v5, s[16:19], s37 offen lds
    s_waitcnt lgkmcnt(4)
    v_mfma_f32_16x16x32_bf16 v[72:75], v[48:51], v[12:15], v[72:75]
    v_mfma_f32_16x16x32_bf16 v[108:111], v[48:51], v[16:19], v[108:111]
    ds_read_b64_tr_b16 v[48:49], v8 offset:224
    ds_read_b64_tr_b16 v[50:51], v8 offset:4832
    s_add_u32 m0, s31, 57344
    s_mov_b64 exec, 0xffff
    buffer_load_dwordx4 v6, s[16:19], s37 offen lds
    s_mov_b64 exec, -1
    s_waitcnt lgkmcnt(4)
    v_mfma_f32_16x16x32_bf16 v[76:79], v[52:55], v[12:15], v[76:79]
    v_mfma_f32_16x16x32_bf16 v[112:115], v[52:55], v[16:19], v[112:115]
    ds_read_b64_tr_b16 v[52:53], v8 offset:256
    ds_read_b64_tr_b16 v[54:55], v8 offset:4864
    s_mov_b32 s36, 22528
    buffer_load_dwordx4 v[36:39], v2, s[12:15], s36 offen
    s_waitcnt lgkmcnt(4)
    v_mfma_f32_16x16x32_bf16 v[80:83], v[44:47], v[12:15], v[80:83]
    v_mfma_f32_16x16x32_bf16 v[116:119], v[44:47], v[16:19], v[116:119]
    ds_read_b64_tr_b16 v[44:45], v9 offset:0
    ds_read_b64_tr_b16 v[46:47], v9 offset:4608
    buffer_load_dwordx4 v[40:43], v3, s[12:15], s36 offen
    s_waitcnt lgkmcnt(4)
    v_mfma_f32_16x16x32_bf16 v[84:87], v[48:51], v[12:15], v[84:87]
    v_mfma_f32_16x16x32_bf16 v[120:123], v[48:51], v[16:19], v[120:123]
    ds_read_b64_tr_b16 v[48:49], v9 offset:32
    ds_read_b64_tr_b16 v[50:51], v9 offset:4640
    s_waitcnt lgkmcnt(4)
    v_mfma_f32_16x16x32_bf16 v[88:91], v[52:55], v[12:15], v[88:91]
    v_mfma_f32_16x16x32_bf16 v[124:127], v[52:55], v[16:19], v[124:127]
    ds_read_b64_tr_b16 v[52:53], v9 offset:64
    ds_read_b64_tr_b16 v[54:55], v9 offset:4672
    s_waitcnt vmcnt(10)
    s_waitcnt lgkmcnt(4)
    v_mfma_f32_16x16x32_bf16 v[56:59], v[44:47], v[20:23], v[56:59]
    v_mfma_f32_16x16x32_bf16 v[92:95], v[44:47], v[24:27], v[92:95]
    ds_read_b64_tr_b16 v[44:45], v9 offset:96
    ds_read_b64_tr_b16 v[46:47], v9 offset:4704
    s_waitcnt lgkmcnt(4)
    v_mfma_f32_16x16x32_bf16 v[60:63], v[48:51], v[20:23], v[60:63]
    v_mfma_f32_16x16x32_bf16 v[96:99], v[48:51], v[24:27], v[96:99]
    s_waitcnt vmcnt(7)
    s_barrier
    ds_read_b64_tr_b16 v[48:49], v9 offset:128
    ds_read_b64_tr_b16 v[50:51], v9 offset:4736
    s_waitcnt lgkmcnt(4)
    v_mfma_f32_16x16x32_bf16 v[64:67], v[52:55], v[20:23], v[64:67]
    v_mfma_f32_16x16x32_bf16 v[100:103], v[52:55], v[24:27], v[100:103]
    ds_read_b64_tr_b16 v[52:53], v9 offset:160
    ds_read_b64_tr_b16 v[54:55], v9 offset:4768
    s_mov_b32 s37, 884736
    s_add_u32 m0, s31, 0
    s_nop 0
    buffer_load_dwordx4 v4, s[16:19], s37 offen lds
    s_waitcnt lgkmcnt(4)
    v_mfma_f32_16x16x32_bf16 v[68:71], v[44:47], v[20:23], v[68:71]
    v_mfma_f32_16x16x32_bf16 v[104:107], v[44:47], v[24:27], v[104:107]
    ds_read_b64_tr_b16 v[44:45], v9 offset:192
    ds_read_b64_tr_b16 v[46:47], v9 offset:4800
    s_add_u32 m0, s31, 1024
    s_nop 0
    buffer_load_dwordx4 v5, s[16:19], s37 offen lds
    s_waitcnt lgkmcnt(4)
    v_mfma_f32_16x16x32_bf16 v[72:75], v[48:51], v[20:23], v[72:75]
    v_mfma_f32_16x16x32_bf16 v[108:111], v[48:51], v[24:27], v[108:111]
    ds_read_b64_tr_b16 v[48:49], v9 offset:224
    ds_read_b64_tr_b16 v[50:51], v9 offset:4832
    s_add_u32 m0, s31, 2048
    s_mov_b64 exec, 0xffff
    buffer_load_dwordx4 v6, s[16:19], s37 offen lds
    s_mov_b64 exec, -1
    s_waitcnt lgkmcnt(4)
    v_mfma_f32_16x16x32_bf16 v[76:79], v[52:55], v[20:23], v[76:79]
    v_mfma_f32_16x16x32_bf16 v[112:115], v[52:55], v[24:27], v[112:115]
    ds_read_b64_tr_b16 v[52:53], v9 offset:256
    ds_read_b64_tr_b16 v[54:55], v9 offset:4864
    s_mov_b32 s36, 24576
    buffer_load_dwordx4 v[12:15], v2, s[12:15], s36 offen
    s_waitcnt lgkmcnt(4)
    v_mfma_f32_16x16x32_bf16 v[80:83], v[44:47], v[20:23], v[80:83]
    v_mfma_f32_16x16x32_bf16 v[116:119], v[44:47], v[24:27], v[116:119]
    ds_read_b64_tr_b16 v[44:45], v10 offset:0
    ds_read_b64_tr_b16 v[46:47], v10 offset:4608
    buffer_load_dwordx4 v[16:19], v3, s[12:15], s36 offen
    s_waitcnt lgkmcnt(4)
    v_mfma_f32_16x16x32_bf16 v[84:87], v[48:51], v[20:23], v[84:87]
    v_mfma_f32_16x16x32_bf16 v[120:123], v[48:51], v[24:27], v[120:123]
    ds_read_b64_tr_b16 v[48:49], v10 offset:32
    ds_read_b64_tr_b16 v[50:51], v10 offset:4640
    s_waitcnt lgkmcnt(4)
    v_mfma_f32_16x16x32_bf16 v[88:91], v[52:55], v[20:23], v[88:91]
    v_mfma_f32_16x16x32_bf16 v[124:127], v[52:55], v[24:27], v[124:127]
    ds_read_b64_tr_b16 v[52:53], v10 offset:64
    ds_read_b64_tr_b16 v[54:55], v10 offset:4672
    s_waitcnt vmcnt(10)
    s_waitcnt lgkmcnt(4)
    v_mfma_f32_16x16x32_bf16 v[56:59], v[44:47], v[28:31], v[56:59]
    v_mfma_f32_16x16x32_bf16 v[92:95], v[44:47], v[32:35], v[92:95]
    ds_read_b64_tr_b16 v[44:45], v10 offset:96
    ds_read_b64_tr_b16 v[46:47], v10 offset:4704
    s_waitcnt lgkmcnt(4)
    v_mfma_f32_16x16x32_bf16 v[60:63], v[48:51], v[28:31], v[60:63]
    v_mfma_f32_16x16x32_bf16 v[96:99], v[48:51], v[32:35], v[96:99]
    s_waitcnt vmcnt(7)
    s_barrier
    ds_read_b64_tr_b16 v[48:49], v10 offset:128
    ds_read_b64_tr_b16 v[50:51], v10 offset:4736
    s_waitcnt lgkmcnt(4)
    v_mfma_f32_16x16x32_bf16 v[64:67], v[52:55], v[28:31], v[64:67]
    v_mfma_f32_16x16x32_bf16 v[100:103], v[52:55], v[32:35], v[100:103]
    ds_read_b64_tr_b16 v[52:53], v10 offset:160
    ds_read_b64_tr_b16 v[54:55], v10 offset:4768
    s_mov_b32 s37, 958464
    s_add_u32 m0, s31, 18432
    s_nop 0
    buffer_load_dwordx4 v4, s[16:19], s37 offen lds
    s_waitcnt lgkmcnt(4)
    v_mfma_f32_16x16x32_bf16 v[68:71], v[44:47], v[28:31], v[68:71]
    v_mfma_f32_16x16x32_bf16 v[104:107], v[44:47], v[32:35], v[104:107]
    ds_read_b64_tr_b16 v[44:45], v10 offset:192
    ds_read_b64_tr_b16 v[46:47], v10 offset:4800
    s_add_u32 m0, s31, 19456
    s_nop 0
    buffer_load_dwordx4 v5, s[16:19], s37 offen lds
    s_waitcnt lgkmcnt(4)
    v_mfma_f32_16x16x32_bf16 v[72:75], v[48:51], v[28:31], v[72:75]
    v_mfma_f32_16x16x32_bf16 v[108:111], v[48:51], v[32:35], v[108:111]
    ds_read_b64_tr_b16 v[48:49], v10 offset:224
    ds_read_b64_tr_b16 v[50:51], v10 offset:4832
    s_add_u32 m0, s31, 20480
    s_mov_b64 exec, 0xffff
    buffer_load_dwordx4 v6, s[16:19], s37 offen lds
    s_mov_b64 exec, -1
    s_waitcnt lgkmcnt(4)
    v_mfma_f32_16x16x32_bf16 v[76:79], v[52:55], v[28:31], v[76:79]
    v_mfma_f32_16x16x32_bf16 v[112:115], v[52:55], v[32:35], v[112:115]
    ds_read_b64_tr_b16 v[52:53], v10 offset:256
    ds_read_b64_tr_b16 v[54:55], v10 offset:4864
    s_mov_b32 s36, 26624
    buffer_load_dwordx4 v[20:23], v2, s[12:15], s36 offen
    s_waitcnt lgkmcnt(4)
    v_mfma_f32_16x16x32_bf16 v[80:83], v[44:47], v[28:31], v[80:83]
    v_mfma_f32_16x16x32_bf16 v[116:119], v[44:47], v[32:35], v[116:119]
    ds_read_b64_tr_b16 v[44:45], v11 offset:0
    ds_read_b64_tr_b16 v[46:47], v11 offset:4608
    buffer_load_dwordx4 v[24:27], v3, s[12:15], s36 offen
    s_waitcnt lgkmcnt(4)
    v_mfma_f32_16x16x32_bf16 v[84:87], v[48:51], v[28:31], v[84:87]
    v_mfma_f32_16x16x32_bf16 v[120:123], v[48:51], v[32:35], v[120:123]
    ds_read_b64_tr_b16 v[48:49], v11 offset:32
    ds_read_b64_tr_b16 v[50:51], v11 offset:4640
    s_waitcnt lgkmcnt(4)
    v_mfma_f32_16x16x32_bf16 v[88:91], v[52:55], v[28:31], v[88:91]
    v_mfma_f32_16x16x32_bf16 v[124:127], v[52:55], v[32:35], v[124:127]
    ds_read_b64_tr_b16 v[52:53], v11 offset:64
    ds_read_b64_tr_b16 v[54:55], v11 offset:4672
    s_waitcnt vmcnt(10)
    s_waitcnt lgkmcnt(4)
    v_mfma_f32_16x16x32_bf16 v[56:59], v[44:47], v[36:39], v[56:59]
    v_mfma_f32_16x16x32_bf16 v[92:95], v[44:47], v[40:43], v[92:95]
    ds_read_b64_tr_b16 v[44:45], v11 offset:96
    ds_read_b64_tr_b16 v[46:47], v11 offset:4704
    s_waitcnt lgkmcnt(4)
    v_mfma_f32_16x16x32_bf16 v[60:63], v[48:51], v[36:39], v[60:63]
    v_mfma_f32_16x16x32_bf16 v[96:99], v[48:51], v[40:43], v[96:99]
    s_waitcnt vmcnt(7)
    s_barrier
    ds_read_b64_tr_b16 v[48:49], v11 offset:128
    ds_read_b64_tr_b16 v[50:51], v11 offset:4736
    s_waitcnt lgkmcnt(4)
    v_mfma_f32_16x16x32_bf16 v[64:67], v[52:55], v[36:39], v[64:67]
    v_mfma_f32_16x16x32_bf16 v[100:103], v[52:55], v[40:43], v[100:103]
    ds_read_b64_tr_b16 v[52:53], v11 offset:160
    ds_read_b64_tr_b16 v[54:55], v11 offset:4768
    s_mov_b32 s37, 1032192
    s_add_u32 m0, s31, 36864
    s_nop 0
    buffer_load_dwordx4 v4, s[16:19], s37 offen lds
    s_waitcnt lgkmcnt(4)
    v_mfma_f32_16x16x32_bf16 v[68:71], v[44:47], v[36:39], v[68:71]
    v_mfma_f32_16x16x32_bf16 v[104:107], v[44:47], v[40:43], v[104:107]
    ds_read_b64_tr_b16 v[44:45], v11 offset:192
    ds_read_b64_tr_b16 v[46:47], v11 offset:4800
    s_add_u32 m0, s31, 37888
    s_nop 0
    buffer_load_dwordx4 v5, s[16:19], s37 offen lds
    s_waitcnt lgkmcnt(4)
    v_mfma_f32_16x16x32_bf16 v[72:75], v[48:51], v[36:39], v[72:75]
    v_mfma_f32_16x16x32_bf16 v[108:111], v[48:51], v[40:43], v[108:111]
    ds_read_b64_tr_b16 v[48:49], v11 offset:224
    ds_read_b64_tr_b16 v[50:51], v11 offset:4832
    s_add_u32 m0, s31, 38912
    s_mov_b64 exec, 0xffff
    buffer_load_dwordx4 v6, s[16:19], s37 offen lds
    s_mov_b64 exec, -1
    s_waitcnt lgkmcnt(4)
    v_mfma_f32_16x16x32_bf16 v[76:79], v[52:55], v[36:39], v[76:79]
    v_mfma_f32_16x16x32_bf16 v[112:115], v[52:55], v[40:43], v[112:115]
    ds_read_b64_tr_b16 v[52:53], v11 offset:256
    ds_read_b64_tr_b16 v[54:55], v11 offset:4864
    s_mov_b32 s36, 28672
    buffer_load_dwordx4 v[28:31], v2, s[12:15], s36 offen
    s_waitcnt lgkmcnt(4)
    v_mfma_f32_16x16x32_bf16 v[80:83], v[44:47], v[36:39], v[80:83]
    v_mfma_f32_16x16x32_bf16 v[116:119], v[44:47], v[40:43], v[116:119]
    ds_read_b64_tr_b16 v[44:45], v8 offset:0
    ds_read_b64_tr_b16 v[46:47], v8 offset:4608
    buffer_load_dwordx4 v[32:35], v3, s[12:15], s36 offen
    s_waitcnt lgkmcnt(4)
    v_mfma_f32_16x16x32_bf16 v[84:87], v[48:51], v[36:39], v[84:87]
    v_mfma_f32_16x16x32_bf16 v[120:123], v[48:51], v[40:43], v[120:123]
    ds_read_b64_tr_b16 v[48:49], v8 offset:32
    ds_read_b64_tr_b16 v[50:51], v8 offset:4640
    s_waitcnt lgkmcnt(4)
    v_mfma_f32_16x16x32_bf16 v[88:91], v[52:55], v[36:39], v[88:91]
    v_mfma_f32_16x16x32_bf16 v[124:127], v[52:55], v[40:43], v[124:127]
    ds_read_b64_tr_b16 v[52:53], v8 offset:64
    ds_read_b64_tr_b16 v[54:55], v8 offset:4672
    s_waitcnt vmcnt(10)
    s_waitcnt lgkmcnt(4)
    v_mfma_f32_16x16x32_bf16 v[56:59], v[44:47], v[12:15], v[56:59]
    v_mfma_f32_16x16x32_bf16 v[92:95], v[44:47], v[16:19], v[92:95]
    ds_read_b64_tr_b16 v[44:45], v8 offset:96
    ds_read_b64_tr_b16 v[46:47], v8 offset:4704
    s_waitcnt lgkmcnt(4)
    v_mfma_f32_16x16x32_bf16 v[60:63], v[48:51], v[12:15], v[60:63]
    v_mfma_f32_16x16x32_bf16 v[96:99], v[48:51], v[16:19], v[96:99]
    s_waitcnt vmcnt(7)
    s_barrier
    ds_read_b64_tr_b16 v[48:49], v8 offset:128
    ds_read_b64_tr_b16 v[50:51], v8 offset:4736
    s_waitcnt lgkmcnt(4)
    v_mfma_f32_16x16x32_bf16 v[64:67], v[52:55], v[12:15], v[64:67]
    v_mfma_f32_16x16x32_bf16 v[100:103], v[52:55], v[16:19], v[100:103]
    ds_read_b64_tr_b16 v[52:53], v8 offset:160
    ds_read_b64_tr_b16 v[54:55], v8 offset:4768
    s_mov_b32 s37, 1105920
    s_add_u32 m0, s31, 55296
    s_nop 0
    buffer_load_dwordx4 v4, s[16:19], s37 offen lds
    s_waitcnt lgkmcnt(4)
    v_mfma_f32_16x16x32_bf16 v[68:71], v[44:47], v[12:15], v[68:71]
    v_mfma_f32_16x16x32_bf16 v[104:107], v[44:47], v[16:19], v[104:107]
    ds_read_b64_tr_b16 v[44:45], v8 offset:192
    ds_read_b64_tr_b16 v[46:47], v8 offset:4800
    s_add_u32 m0, s31, 56320
    s_nop 0
    buffer_load_dwordx4 v5, s[16:19], s37 offen lds
    s_waitcnt lgkmcnt(4)
    v_mfma_f32_16x16x32_bf16 v[72:75], v[48:51], v[12:15], v[72:75]
    v_mfma_f32_16x16x32_bf16 v[108:111], v[48:51], v[16:19], v[108:111]
    ds_read_b64_tr_b16 v[48:49], v8 offset:224
    ds_read_b64_tr_b16 v[50:51], v8 offset:4832
    s_add_u32 m0, s31, 57344
    s_mov_b64 exec, 0xffff
    buffer_load_dwordx4 v6, s[16:19], s37 offen lds
    s_mov_b64 exec, -1
    s_waitcnt lgkmcnt(4)
    v_mfma_f32_16x16x32_bf16 v[76:79], v[52:55], v[12:15], v[76:79]
    v_mfma_f32_16x16x32_bf16 v[112:115], v[52:55], v[16:19], v[112:115]
    ds_read_b64_tr_b16 v[52:53], v8 offset:256
    ds_read_b64_tr_b16 v[54:55], v8 offset:4864
    s_mov_b32 s36, 30720
    buffer_load_dwordx4 v[36:39], v2, s[12:15], s36 offen
    s_waitcnt lgkmcnt(4)
    v_mfma_f32_16x16x32_bf16 v[80:83], v[44:47], v[12:15], v[80:83]
    v_mfma_f32_16x16x32_bf16 v[116:119], v[44:47], v[16:19], v[116:119]
    ds_read_b64_tr_b16 v[44:45], v9 offset:0
    ds_read_b64_tr_b16 v[46:47], v9 offset:4608
    buffer_load_dwordx4 v[40:43], v3, s[12:15], s36 offen
    s_waitcnt lgkmcnt(4)
    v_mfma_f32_16x16x32_bf16 v[84:87], v[48:51], v[12:15], v[84:87]
    v_mfma_f32_16x16x32_bf16 v[120:123], v[48:51], v[16:19], v[120:123]
    ds_read_b64_tr_b16 v[48:49], v9 offset:32
    ds_read_b64_tr_b16 v[50:51], v9 offset:4640
    s_waitcnt lgkmcnt(4)
    v_mfma_f32_16x16x32_bf16 v[88:91], v[52:55], v[12:15], v[88:91]
    v_mfma_f32_16x16x32_bf16 v[124:127], v[52:55], v[16:19], v[124:127]
    ds_read_b64_tr_b16 v[52:53], v9 offset:64
    ds_read_b64_tr_b16 v[54:55], v9 offset:4672
    s_waitcnt vmcnt(10)
    s_waitcnt lgkmcnt(4)
    v_mfma_f32_16x16x32_bf16 v[56:59], v[44:47], v[20:23], v[56:59]
    v_mfma_f32_16x16x32_bf16 v[92:95], v[44:47], v[24:27], v[92:95]
    ds_read_b64_tr_b16 v[44:45], v9 offset:96
    ds_read_b64_tr_b16 v[46:47], v9 offset:4704
    s_waitcnt lgkmcnt(4)
    v_mfma_f32_16x16x32_bf16 v[60:63], v[48:51], v[20:23], v[60:63]
    v_mfma_f32_16x16x32_bf16 v[96:99], v[48:51], v[24:27], v[96:99]
    s_waitcnt vmcnt(7)
    s_barrier
    ds_read_b64_tr_b16 v[48:49], v9 offset:128
    ds_read_b64_tr_b16 v[50:51], v9 offset:4736
    s_waitcnt lgkmcnt(4)
    v_mfma_f32_16x16x32_bf16 v[64:67], v[52:55], v[20:23], v[64:67]
    v_mfma_f32_16x16x32_bf16 v[100:103], v[52:55], v[24:27], v[100:103]
    ds_read_b64_tr_b16 v[52:53], v9 offset:160
    ds_read_b64_tr_b16 v[54:55], v9 offset:4768
    s_mov_b32 s37, 1179648
    s_add_u32 m0, s31, 0
    s_nop 0
    buffer_load_dwordx4 v4, s[16:19], s37 offen lds
    s_waitcnt lgkmcnt(4)
    v_mfma_f32_16x16x32_bf16 v[68:71], v[44:47], v[20:23], v[68:71]
    v_mfma_f32_16x16x32_bf16 v[104:107], v[44:47], v[24:27], v[104:107]
    ds_read_b64_tr_b16 v[44:45], v9 offset:192
    ds_read_b64_tr_b16 v[46:47], v9 offset:4800
    s_add_u32 m0, s31, 1024
    s_nop 0
    buffer_load_dwordx4 v5, s[16:19], s37 offen lds
    s_waitcnt lgkmcnt(4)
    v_mfma_f32_16x16x32_bf16 v[72:75], v[48:51], v[20:23], v[72:75]
    v_mfma_f32_16x16x32_bf16 v[108:111], v[48:51], v[24:27], v[108:111]
    ds_read_b64_tr_b16 v[48:49], v9 offset:224
    ds_read_b64_tr_b16 v[50:51], v9 offset:4832
    s_add_u32 m0, s31, 2048
    s_mov_b64 exec, 0xffff
    buffer_load_dwordx4 v6, s[16:19], s37 offen lds
    s_mov_b64 exec, -1
    s_waitcnt lgkmcnt(4)
    v_mfma_f32_16x16x32_bf16 v[76:79], v[52:55], v[20:23], v[76:79]
    v_mfma_f32_16x16x32_bf16 v[112:115], v[52:55], v[24:27], v[112:115]
    ds_read_b64_tr_b16 v[52:53], v9 offset:256
    ds_read_b64_tr_b16 v[54:55], v9 offset:4864
    s_mov_b32 s36, 32768
    buffer_load_dwordx4 v[12:15], v2, s[12:15], s36 offen
    s_waitcnt lgkmcnt(4)
    v_mfma_f32_16x16x32_bf16 v[80:83], v[44:47], v[20:23], v[80:83]
    v_mfma_f32_16x16x32_bf16 v[116:119], v[44:47], v[24:27], v[116:119]
    ds_read_b64_tr_b16 v[44:45], v10 offset:0
    ds_read_b64_tr_b16 v[46:47], v10 offset:4608
    buffer_load_dwordx4 v[16:19], v3, s[12:15], s36 offen
    s_waitcnt lgkmcnt(4)
    v_mfma_f32_16x16x32_bf16 v[84:87], v[48:51], v[20:23], v[84:87]
    v_mfma_f32_16x16x32_bf16 v[120:123], v[48:51], v[24:27], v[120:123]
    ds_read_b64_tr_b16 v[48:49], v10 offset:32
    ds_read_b64_tr_b16 v[50:51], v10 offset:4640
    s_waitcnt lgkmcnt(4)
    v_mfma_f32_16x16x32_bf16 v[88:91], v[52:55], v[20:23], v[88:91]
    v_mfma_f32_16x16x32_bf16 v[124:127], v[52:55], v[24:27], v[124:127]
    ds_read_b64_tr_b16 v[52:53], v10 offset:64
    ds_read_b64_tr_b16 v[54:55], v10 offset:4672
    s_waitcnt vmcnt(10)
    s_waitcnt lgkmcnt(4)
    v_mfma_f32_16x16x32_bf16 v[56:59], v[44:47], v[28:31], v[56:59]
    v_mfma_f32_16x16x32_bf16 v[92:95], v[44:47], v[32:35], v[92:95]
    ds_read_b64_tr_b16 v[44:45], v10 offset:96
    ds_read_b64_tr_b16 v[46:47], v10 offset:4704
    s_waitcnt lgkmcnt(4)
    v_mfma_f32_16x16x32_bf16 v[60:63], v[48:51], v[28:31], v[60:63]
    v_mfma_f32_16x16x32_bf16 v[96:99], v[48:51], v[32:35], v[96:99]
    s_waitcnt vmcnt(7)
    s_barrier
    ds_read_b64_tr_b16 v[48:49], v10 offset:128
    ds_read_b64_tr_b16 v[50:51], v10 offset:4736
    s_waitcnt lgkmcnt(4)
    v_mfma_f32_16x16x32_bf16 v[64:67], v[52:55], v[28:31], v[64:67]
    v_mfma_f32_16x16x32_bf16 v[100:103], v[52:55], v[32:35], v[100:103]
    ds_read_b64_tr_b16 v[52:53], v10 offset:160
    ds_read_b64_tr_b16 v[54:55], v10 offset:4768
    s_mov_b32 s37, 1253376
    s_add_u32 m0, s31, 18432
    s_nop 0
    buffer_load_dwordx4 v4, s[16:19], s37 offen lds
    s_waitcnt lgkmcnt(4)
    v_mfma_f32_16x16x32_bf16 v[68:71], v[44:47], v[28:31], v[68:71]
    v_mfma_f32_16x16x32_bf16 v[104:107], v[44:47], v[32:35], v[104:107]
    ds_read_b64_tr_b16 v[44:45], v10 offset:192
    ds_read_b64_tr_b16 v[46:47], v10 offset:4800
    s_add_u32 m0, s31, 19456
    s_nop 0
    buffer_load_dwordx4 v5, s[16:19], s37 offen lds
    s_waitcnt lgkmcnt(4)
    v_mfma_f32_16x16x32_bf16 v[72:75], v[48:51], v[28:31], v[72:75]
    v_mfma_f32_16x16x32_bf16 v[108:111], v[48:51], v[32:35], v[108:111]
    ds_read_b64_tr_b16 v[48:49], v10 offset:224
    ds_read_b64_tr_b16 v[50:51], v10 offset:4832
    s_add_u32 m0, s31, 20480
    s_mov_b64 exec, 0xffff
    buffer_load_dwordx4 v6, s[16:19], s37 offen lds
    s_mov_b64 exec, -1
    s_waitcnt lgkmcnt(4)
    v_mfma_f32_16x16x32_bf16 v[76:79], v[52:55], v[28:31], v[76:79]
    v_mfma_f32_16x16x32_bf16 v[112:115], v[52:55], v[32:35], v[112:115]
    ds_read_b64_tr_b16 v[52:53], v10 offset:256
    ds_read_b64_tr_b16 v[54:55], v10 offset:4864
    s_mov_b32 s36, 34816
    buffer_load_dwordx4 v[20:23], v2, s[12:15], s36 offen
    s_waitcnt lgkmcnt(4)
    v_mfma_f32_16x16x32_bf16 v[80:83], v[44:47], v[28:31], v[80:83]
    v_mfma_f32_16x16x32_bf16 v[116:119], v[44:47], v[32:35], v[116:119]
    ds_read_b64_tr_b16 v[44:45], v11 offset:0
    ds_read_b64_tr_b16 v[46:47], v11 offset:4608
    buffer_load_dwordx4 v[24:27], v3, s[12:15], s36 offen
    s_waitcnt lgkmcnt(4)
    v_mfma_f32_16x16x32_bf16 v[84:87], v[48:51], v[28:31], v[84:87]
    v_mfma_f32_16x16x32_bf16 v[120:123], v[48:51], v[32:35], v[120:123]
    ds_read_b64_tr_b16 v[48:49], v11 offset:32
    ds_read_b64_tr_b16 v[50:51], v11 offset:4640
    s_waitcnt lgkmcnt(4)
    v_mfma_f32_16x16x32_bf16 v[88:91], v[52:55], v[28:31], v[88:91]
    v_mfma_f32_16x16x32_bf16 v[124:127], v[52:55], v[32:35], v[124:127]
    ds_read_b64_tr_b16 v[52:53], v11 offset:64
    ds_read_b64_tr_b16 v[54:55], v11 offset:4672
    s_waitcnt vmcnt(10)
    s_waitcnt lgkmcnt(4)
    v_mfma_f32_16x16x32_bf16 v[56:59], v[44:47], v[36:39], v[56:59]
    v_mfma_f32_16x16x32_bf16 v[92:95], v[44:47], v[40:43], v[92:95]
    ds_read_b64_tr_b16 v[44:45], v11 offset:96
    ds_read_b64_tr_b16 v[46:47], v11 offset:4704
    s_waitcnt lgkmcnt(4)
    v_mfma_f32_16x16x32_bf16 v[60:63], v[48:51], v[36:39], v[60:63]
    v_mfma_f32_16x16x32_bf16 v[96:99], v[48:51], v[40:43], v[96:99]
    s_waitcnt vmcnt(7)
    s_barrier
    ds_read_b64_tr_b16 v[48:49], v11 offset:128
    ds_read_b64_tr_b16 v[50:51], v11 offset:4736
    s_waitcnt lgkmcnt(4)
    v_mfma_f32_16x16x32_bf16 v[64:67], v[52:55], v[36:39], v[64:67]
    v_mfma_f32_16x16x32_bf16 v[100:103], v[52:55], v[40:43], v[100:103]
    ds_read_b64_tr_b16 v[52:53], v11 offset:160
    ds_read_b64_tr_b16 v[54:55], v11 offset:4768
    s_waitcnt lgkmcnt(4)
    v_mfma_f32_16x16x32_bf16 v[68:71], v[44:47], v[36:39], v[68:71]
    v_mfma_f32_16x16x32_bf16 v[104:107], v[44:47], v[40:43], v[104:107]
    ds_read_b64_tr_b16 v[44:45], v11 offset:192
    ds_read_b64_tr_b16 v[46:47], v11 offset:4800
    s_waitcnt lgkmcnt(4)
    v_mfma_f32_16x16x32_bf16 v[72:75], v[48:51], v[36:39], v[72:75]
    v_mfma_f32_16x16x32_bf16 v[108:111], v[48:51], v[40:43], v[108:111]
    ds_read_b64_tr_b16 v[48:49], v11 offset:224
    ds_read_b64_tr_b16 v[50:51], v11 offset:4832
    s_waitcnt lgkmcnt(4)
    v_mfma_f32_16x16x32_bf16 v[76:79], v[52:55], v[36:39], v[76:79]
    v_mfma_f32_16x16x32_bf16 v[112:115], v[52:55], v[40:43], v[112:115]
    ds_read_b64_tr_b16 v[52:53], v11 offset:256
    ds_read_b64_tr_b16 v[54:55], v11 offset:4864
    s_waitcnt lgkmcnt(4)
    v_mfma_f32_16x16x32_bf16 v[80:83], v[44:47], v[36:39], v[80:83]
    v_mfma_f32_16x16x32_bf16 v[116:119], v[44:47], v[40:43], v[116:119]
    ds_read_b64_tr_b16 v[44:45], v8 offset:0
    ds_read_b64_tr_b16 v[46:47], v8 offset:4608
    s_waitcnt lgkmcnt(4)
    v_mfma_f32_16x16x32_bf16 v[84:87], v[48:51], v[36:39], v[84:87]
    v_mfma_f32_16x16x32_bf16 v[120:123], v[48:51], v[40:43], v[120:123]
    ds_read_b64_tr_b16 v[48:49], v8 offset:32
    ds_read_b64_tr_b16 v[50:51], v8 offset:4640
    s_waitcnt lgkmcnt(4)
    v_mfma_f32_16x16x32_bf16 v[88:91], v[52:55], v[36:39], v[88:91]
    v_mfma_f32_16x16x32_bf16 v[124:127], v[52:55], v[40:43], v[124:127]
    ds_read_b64_tr_b16 v[52:53], v8 offset:64
    ds_read_b64_tr_b16 v[54:55], v8 offset:4672
    s_waitcnt vmcnt(5)
    s_waitcnt lgkmcnt(4)
    v_mfma_f32_16x16x32_bf16 v[56:59], v[44:47], v[12:15], v[56:59]
    v_mfma_f32_16x16x32_bf16 v[92:95], v[44:47], v[16:19], v[92:95]
    ds_read_b64_tr_b16 v[44:45], v8 offset:96
    ds_read_b64_tr_b16 v[46:47], v8 offset:4704
    s_waitcnt lgkmcnt(4)
    v_mfma_f32_16x16x32_bf16 v[60:63], v[48:51], v[12:15], v[60:63]
    v_mfma_f32_16x16x32_bf16 v[96:99], v[48:51], v[16:19], v[96:99]
    s_waitcnt vmcnt(2)
    s_barrier
    ds_read_b64_tr_b16 v[48:49], v8 offset:128
    ds_read_b64_tr_b16 v[50:51], v8 offset:4736
    s_waitcnt lgkmcnt(4)
    v_mfma_f32_16x16x32_bf16 v[64:67], v[52:55], v[12:15], v[64:67]
    v_mfma_f32_16x16x32_bf16 v[100:103], v[52:55], v[16:19], v[100:103]
    ds_read_b64_tr_b16 v[52:53], v8 offset:160
    ds_read_b64_tr_b16 v[54:55], v8 offset:4768
    s_waitcnt lgkmcnt(4)
    v_mfma_f32_16x16x32_bf16 v[68:71], v[44:47], v[12:15], v[68:71]
    v_mfma_f32_16x16x32_bf16 v[104:107], v[44:47], v[16:19], v[104:107]
    ds_read_b64_tr_b16 v[44:45], v8 offset:192
    ds_read_b64_tr_b16 v[46:47], v8 offset:4800
    s_waitcnt lgkmcnt(4)
    v_mfma_f32_16x16x32_bf16 v[72:75], v[48:51], v[12:15], v[72:75]
    v_mfma_f32_16x16x32_bf16 v[108:111], v[48:51], v[16:19], v[108:111]
    ds_read_b64_tr_b16 v[48:49], v8 offset:224
    ds_read_b64_tr_b16 v[50:51], v8 offset:4832
    s_waitcnt lgkmcnt(4)
    v_mfma_f32_16x16x32_bf16 v[76:79], v[52:55], v[12:15], v[76:79]
    v_mfma_f32_16x16x32_bf16 v[112:115], v[52:55], v[16:19], v[112:115]
    ds_read_b64_tr_b16 v[52:53], v8 offset:256
    ds_read_b64_tr_b16 v[54:55], v8 offset:4864
    s_waitcnt lgkmcnt(4)
    v_mfma_f32_16x16x32_bf16 v[80:83], v[44:47], v[12:15], v[80:83]
    v_mfma_f32_16x16x32_bf16 v[116:119], v[44:47], v[16:19], v[116:119]
    ds_read_b64_tr_b16 v[44:45], v9 offset:0
    ds_read_b64_tr_b16 v[46:47], v9 offset:4608
    s_waitcnt lgkmcnt(4)
    v_mfma_f32_16x16x32_bf16 v[84:87], v[48:51], v[12:15], v[84:87]
    v_mfma_f32_16x16x32_bf16 v[120:123], v[48:51], v[16:19], v[120:123]
    ds_read_b64_tr_b16 v[48:49], v9 offset:32
    ds_read_b64_tr_b16 v[50:51], v9 offset:4640
    s_waitcnt lgkmcnt(4)
    v_mfma_f32_16x16x32_bf16 v[88:91], v[52:55], v[12:15], v[88:91]
    v_mfma_f32_16x16x32_bf16 v[124:127], v[52:55], v[16:19], v[124:127]
    ds_read_b64_tr_b16 v[52:53], v9 offset:64
    ds_read_b64_tr_b16 v[54:55], v9 offset:4672
    s_waitcnt vmcnt(0)
    s_waitcnt lgkmcnt(4)
    v_mfma_f32_16x16x32_bf16 v[56:59], v[44:47], v[20:23], v[56:59]
    v_mfma_f32_16x16x32_bf16 v[92:95], v[44:47], v[24:27], v[92:95]
    ds_read_b64_tr_b16 v[44:45], v9 offset:96
    ds_read_b64_tr_b16 v[46:47], v9 offset:4704
    s_waitcnt lgkmcnt(4)
    v_mfma_f32_16x16x32_bf16 v[60:63], v[48:51], v[20:23], v[60:63]
    v_mfma_f32_16x16x32_bf16 v[96:99], v[48:51], v[24:27], v[96:99]
    ds_read_b64_tr_b16 v[48:49], v9 offset:128
    ds_read_b64_tr_b16 v[50:51], v9 offset:4736
    s_waitcnt lgkmcnt(4)
    v_mfma_f32_16x16x32_bf16 v[64:67], v[52:55], v[20:23], v[64:67]
    v_mfma_f32_16x16x32_bf16 v[100:103], v[52:55], v[24:27], v[100:103]
    ds_read_b64_tr_b16 v[52:53], v9 offset:160
    ds_read_b64_tr_b16 v[54:55], v9 offset:4768
    s_waitcnt lgkmcnt(4)
    v_mfma_f32_16x16x32_bf16 v[68:71], v[44:47], v[20:23], v[68:71]
    v_mfma_f32_16x16x32_bf16 v[104:107], v[44:47], v[24:27], v[104:107]
    ds_read_b64_tr_b16 v[44:45], v9 offset:192
    ds_read_b64_tr_b16 v[46:47], v9 offset:4800
    s_waitcnt lgkmcnt(4)
    v_mfma_f32_16x16x32_bf16 v[72:75], v[48:51], v[20:23], v[72:75]
    v_mfma_f32_16x16x32_bf16 v[108:111], v[48:51], v[24:27], v[108:111]
    ds_read_b64_tr_b16 v[48:49], v9 offset:224
    ds_read_b64_tr_b16 v[50:51], v9 offset:4832
    s_waitcnt lgkmcnt(4)
    v_mfma_f32_16x16x32_bf16 v[76:79], v[52:55], v[20:23], v[76:79]
    v_mfma_f32_16x16x32_bf16 v[112:115], v[52:55], v[24:27], v[112:115]
    ds_read_b64_tr_b16 v[52:53], v9 offset:256
    ds_read_b64_tr_b16 v[54:55], v9 offset:4864
    s_waitcnt lgkmcnt(4)
    v_mfma_f32_16x16x32_bf16 v[80:83], v[44:47], v[20:23], v[80:83]
    v_mfma_f32_16x16x32_bf16 v[116:119], v[44:47], v[24:27], v[116:119]
    s_waitcnt lgkmcnt(2)
    v_mfma_f32_16x16x32_bf16 v[84:87], v[48:51], v[20:23], v[84:87]
    v_mfma_f32_16x16x32_bf16 v[120:123], v[48:51], v[24:27], v[120:123]
    s_waitcnt lgkmcnt(0)
    v_mfma_f32_16x16x32_bf16 v[88:91], v[52:55], v[20:23], v[88:91]
    v_mfma_f32_16x16x32_bf16 v[124:127], v[52:55], v[24:27], v[124:127]
    v_and_b32 v1, 63, v0
    s_lshl_b32 s34, s38, 7
    s_add_u32 s34, s34, s32
    s_add_u32 s34, s34, s26
    s_mul_i32 s34, s34, 36
    s_mul_i32 s35, s28, 9
    s_add_u32 s34, s34, s35
    s_lshl_b32 s34, s34, 10
    v_lshlrev_b32 v12, 4, v1
    v_add_u32 v12, s34, v12
    s_mul_i32 s34, s24, 9216
    v_lshlrev_b32 v13, 4, v1
    v_add_u32 v13, s34, v13
    s_xor_b32 s35, s24, 4
    s_mul_i32 s35, s35, 9216
    v_lshlrev_b32 v14, 4, v1
    v_add_u32 v14, s35, v14

    s_nop 7
    s_barrier
    s_cmp_eq_u32 s26, 0
    s_cbranch_scc0 g2_ep1
    ds_write_b128 v13, v[92:95] offset:0
    ds_write_b128 v13, v[96:99] offset:1024
    ds_write_b128 v13, v[100:103] offset:2048
    ds_write_b128 v13, v[104:107] offset:3072
    ds_write_b128 v13, v[108:111] offset:4096
    ds_write_b128 v13, v[112:115] offset:5120
    ds_write_b128 v13, v[116:119] offset:6144
    ds_write_b128 v13, v[120:123] offset:7168
    ds_write_b128 v13, v[124:127] offset:8192
    s_waitcnt lgkmcnt(0)
    s_barrier
    ds_read_b128 v[92:95], v14 offset:0
    ds_read_b128 v[96:99], v14 offset:1024
    ds_read_b128 v[100:103], v14 offset:2048
    ds_read_b128 v[104:107], v14 offset:3072
    ds_read_b128 v[108:111], v14 offset:4096
    ds_read_b128 v[112:115], v14 offset:5120
    ds_read_b128 v[116:119], v14 offset:6144
    ds_read_b128 v[120:123], v14 offset:7168
    ds_read_b128 v[124:127], v14 offset:8192
    s_waitcnt lgkmcnt(8)
    v_add_f32 v56, v56, v92
    v_add_f32 v57, v57, v93
    v_add_f32 v58, v58, v94
    v_add_f32 v59, v59, v95
    s_mov_b32 s36, 0
    buffer_store_dwordx4 v[56:59], v12, s[20:23], s36 offen sc1
    s_waitcnt lgkmcnt(7)
    v_add_f32 v60, v60, v96
    v_add_f32 v61, v61, v97
    v_add_f32 v62, v62, v98
    v_add_f32 v63, v63, v99
    s_mov_b32 s36, 1024
    buffer_store_dwordx4 v[60:63], v12, s[20:23], s36 offen sc1
    s_waitcnt lgkmcnt(6)
    v_add_f32 v64, v64, v100
    v_add_f32 v65, v65, v101
    v_add_f32 v66, v66, v102
    v_add_f32 v67, v67, v103
    s_mov_b32 s36, 2048
    buffer_store_dwordx4 v[64:67], v12, s[20:23], s36 offen sc1
    s_waitcnt lgkmcnt(5)
    v_add_f32 v68, v68, v104
    v_add_f32 v69, v69, v105
    v_add_f32 v70, v70, v106
    v_add_f32 v71, v71, v107
    s_mov_b32 s36, 3072
    buffer_store_dwordx4 v[68:71], v12, s[20:23], s36 offen sc1
    s_waitcnt lgkmcnt(4)
    v_add_f32 v72, v72, v108
    v_add_f32 v73, v73, v109
    v_add_f32 v74, v74, v110
    v_add_f32 v75, v75, v111
    s_mov_b32 s36, 4096
    buffer_store_dwordx4 v[72:75], v12, s[20:23], s36 offen sc1
    s_waitcnt lgkmcnt(3)
    v_add_f32 v76, v76, v112
    v_add_f32 v77, v77, v113
    v_add_f32 v78, v78, v114
    v_add_f32 v79, v79, v115
    s_mov_b32 s36, 5120
    buffer_store_dwordx4 v[76:79], v12, s[20:23], s36 offen sc1
    s_waitcnt lgkmcnt(2)
    v_add_f32 v80, v80, v116
    v_add_f32 v81, v81, v117
    v_add_f32 v82, v82, v118
    v_add_f32 v83, v83, v119
    s_mov_b32 s36, 6144
    buffer_store_dwordx4 v[80:83], v12, s[20:23], s36 offen sc1
    s_waitcnt lgkmcnt(1)
    v_add_f32 v84, v84, v120
    v_add_f32 v85, v85, v121
    v_add_f32 v86, v86, v122
    v_add_f32 v87, v87, v123
    s_mov_b32 s36, 7168
    buffer_store_dwordx4 v[84:87], v12, s[20:23], s36 offen sc1
    s_waitcnt lgkmcnt(0)
    v_add_f32 v88, v88, v124
    v_add_f32 v89, v89, v125
    v_add_f32 v90, v90, v126
    v_add_f32 v91, v91, v127
    s_mov_b32 s36, 8192
    buffer_store_dwordx4 v[88:91], v12, s[20:23], s36 offen sc1
    s_endpgm
g2_ep1:
    ds_write_b128 v13, v[56:59] offset:0
    ds_write_b128 v13, v[60:63] offset:1024
    ds_write_b128 v13, v[64:67] offset:2048
    ds_write_b128 v13, v[68:71] offset:3072
    ds_write_b128 v13, v[72:75] offset:4096
    ds_write_b128 v13, v[76:79] offset:5120
    ds_write_b128 v13, v[80:83] offset:6144
    ds_write_b128 v13, v[84:87] offset:7168
    ds_write_b128 v13, v[88:91] offset:8192
    s_waitcnt lgkmcnt(0)
    s_barrier
    ds_read_b128 v[56:59], v14 offset:0
    ds_read_b128 v[60:63], v14 offset:1024
    ds_read_b128 v[64:67], v14 offset:2048
    ds_read_b128 v[68:71], v14 offset:3072
    ds_read_b128 v[72:75], v14 offset:4096
    ds_read_b128 v[76:79], v14 offset:5120
    ds_read_b128 v[80:83], v14 offset:6144
    ds_read_b128 v[84:87], v14 offset:7168
    ds_read_b128 v[88:91], v14 offset:8192
    s_waitcnt lgkmcnt(8)
    v_add_f32 v92, v92, v56
    v_add_f32 v93, v93, v57
    v_add_f32 v94, v94, v58
    v_add_f32 v95, v95, v59
    s_mov_b32 s36, 0
    buffer_store_dwordx4 v[92:95], v12, s[20:23], s36 offen sc1
    s_waitcnt lgkmcnt(7)
    v_add_f32 v96, v96, v60
    v_add_f32 v97, v97, v61
    v_add_f32 v98, v98, v62
    v_add_f32 v99, v99, v63
    s_mov_b32 s36, 1024
    buffer_store_dwordx4 v[96:99], v12, s[20:23], s36 offen sc1
    s_waitcnt lgkmcnt(6)
    v_add_f32 v100, v100, v64
    v_add_f32 v101, v101, v65
    v_add_f32 v102, v102, v66
    v_add_f32 v103, v103, v67
    s_mov_b32 s36, 2048
    buffer_store_dwordx4 v[100:103], v12, s[20:23], s36 offen sc1
    s_waitcnt lgkmcnt(5)
    v_add_f32 v104, v104, v68
    v_add_f32 v105, v105, v69
    v_add_f32 v106, v106, v70
    v_add_f32 v107, v107, v71
    s_mov_b32 s36, 3072
    buffer_store_dwordx4 v[104:107], v12, s[20:23], s36 offen sc1
    s_waitcnt lgkmcnt(4)
    v_add_f32 v108, v108, v72
    v_add_f32 v109, v109, v73
    v_add_f32 v110, v110, v74
    v_add_f32 v111, v111, v75
    s_mov_b32 s36, 4096
    buffer_store_dwordx4 v[108:111], v12, s[20:23], s36 offen sc1
    s_waitcnt lgkmcnt(3)
    v_add_f32 v112, v112, v76
    v_add_f32 v113, v113, v77
    v_add_f32 v114, v114, v78
    v_add_f32 v115, v115, v79
    s_mov_b32 s36, 5120
    buffer_store_dwordx4 v[112:115], v12, s[20:23], s36 offen sc1
    s_waitcnt lgkmcnt(2)
    v_add_f32 v116, v116, v80
    v_add_f32 v117, v117, v81
    v_add_f32 v118, v118, v82
    v_add_f32 v119, v119, v83
    s_mov_b32 s36, 6144
    buffer_store_dwordx4 v[116:119], v12, s[20:23], s36 offen sc1
    s_waitcnt lgkmcnt(1)
    v_add_f32 v120, v120, v84
    v_add_f32 v121, v121, v85
    v_add_f32 v122, v122, v86
    v_add_f32 v123, v123, v87
    s_mov_b32 s36, 7168
    buffer_store_dwordx4 v[120:123], v12, s[20:23], s36 offen sc1
    s_waitcnt lgkmcnt(0)
    v_add_f32 v124, v124, v88
    v_add_f32 v125, v125, v89
    v_add_f32 v126, v126, v90
    v_add_f32 v127, v127, v91
    s_mov_b32 s36, 8192
    buffer_store_dwordx4 v[124:127], v12, s[20:23], s36 offen sc1
    s_endpgm
conv_start:
    s_cmp_ge_u32 s24, 6
    s_cbranch_scc1 g2_done
    s_add_u32 s12, s4, 2359296
    s_addc_u32 s13, s5, 0
    s_mov_b32 s14, 2359296
    s_mov_b32 s15, 0x00020000
    s_mov_b32 s16, s8
    s_mov_b32 s17, s9
    s_mov_b32 s18, 2359296
    s_mov_b32 s19, 0x00020000
    s_add_u32 s20, s4, 23592960
    s_addc_u32 s21, s5, 0
    s_mov_b32 s22, 2359296
    s_mov_b32 s23, 0x00020000
    s_mov_b32 s40, s10
    s_mov_b32 s41, s11
    s_mov_b32 s42, 1152
    s_mov_b32 s43, 0x00020000
    s_lshr_b32 s26, s24, 1
    s_and_b32 s27, s24, 1
    s_sub_u32 s25, s2, 256
    s_mul_i32 s25, s25, 3
    s_add_u32 s25, s25, s26
    s_mul_i32 s30, s26, 24512
    s_lshl_b32 s31, s25, 12
    s_lshl_b32 s28, s27, 11
    v_lshlrev_b32 v2, 4, v1
    v_add_u32 v3, s30, v2
    v_add_u32 v4, s28, v3
    s_lshl_b32 s32, s25, 1
    v_mov_b32 v8, s32
    buffer_load_ushort v9, v8, s[40:43], 0 offen
    s_add_u32 s34, s31, s28

    s_add_u32 s33, s34, 0
    buffer_load_dwordx4 v[32:35], v2, s[12:15], s33 offen
    buffer_load_dwordx4 v[48:51], v2, s[16:19], s33 offen
    buffer_load_dwordx2 v[52:53], v2, s[16:19], s33 offen offset:16
    s_add_u32 s33, s34, 1024
    buffer_load_dwordx4 v[36:39], v2, s[12:15], s33 offen
    buffer_load_dwordx4 v[54:57], v2, s[16:19], s33 offen
    buffer_load_dwordx2 v[58:59], v2, s[16:19], s33 offen offset:16
    v_mov_b32 v60, 0
    v_mov_b32 v61, 0
    v_mov_b32 v62, 0
    v_mov_b32 v63, 0
    s_cmp_lg_u32 s27, 0
    s_cbranch_scc1 conv_nozero
    ds_write_b128 v3, v[60:63] offset:16896
    ds_write_b128 v3, v[60:63] offset:17920
    ds_write_b128 v3, v[60:63] offset:18944
    s_mov_b64 exec, 0xf
    ds_write_b128 v3, v[60:63] offset:0
    ds_write_b128 v3, v[60:63] offset:4160
    ds_write_b128 v3, v[60:63] offset:8320
    ds_write_b64 v3, v[60:61] offset:12728
    ds_write_b64 v3, v[60:61] offset:12736
    s_mov_b64 exec, -1

conv_nozero:
    v_lshrrev_b32 v20, 2, v1
    v_mul_u32_u24 v20, 80, v20
    v_and_b32 v21, 3, v1
    v_lshl_add_u32 v20, v21, 4, v20
    v_add_u32 v20, s30, v20
    s_mul_i32 s33, s27, 2560
    v_add_u32 v20, s33, v20
    v_and_b32 v10, 31, v1
    v_lshrrev_b32 v11, 5, v1
    v_lshlrev_b32 v12, 3, v11
    v_sub_u32 v12, v10, v12
    v_add_u32 v12, 9, v12
    v_and_b32 v13, 3, v12
    v_sub_u32 v12, v12, v13
    v_lshlrev_b32 v12, 1, v12
    v_add_u32 v14, -1, v13
    v_mul_u32_u24 v15, 4160, v14
    v_cmp_eq_u32 vcc, 0, v13
    v_mov_b32 v16, 12728
    s_nop 1
    v_cndmask_b32 v15, v15, v16, vcc
    v_add_u32 v12, v12, v15
    v_add_u32 v12, s30, v12
    v_mul_u32_u24 v13, 80, v10
    v_lshl_add_u32 v13, v11, 4, v13
    v_add_u32 v13, 16896, v13
    v_add_u32 v13, s30, v13
    v_add_u32 v14, 2560, v13
    s_waitcnt vmcnt(0) lgkmcnt(0)
    v_lshlrev_b32 v9, 16, v9

    ds_write_b128 v20, v[32:35] offset:19376
    ds_write_b128 v20, v[36:39] offset:20656
    s_cmp_lg_u32 s27, 0
    s_cbranch_scc1 conv_nospec
    s_mov_b64 exec, 1
    v_lshlrev_b32 v22, 16, v48
    v_alignbit_b32 v23, v49, v48, 16
    ds_write_b32 v3, v22 offset:60
    ds_write_b32 v3, v48 offset:4220
    ds_write_b32 v3, v22 offset:8376
    ds_write_b32 v3, v23 offset:8380
    s_mov_b64 exec, -1

conv_nospec:
    v_alignbit_b32 v72, v49, v48, 16
    v_alignbit_b32 v73, v50, v49, 16
    v_alignbit_b32 v74, v51, v50, 16
    v_alignbit_b32 v75, v52, v51, 16
    v_mov_b32 v76, v73
    v_mov_b32 v77, v74
    v_mov_b32 v78, v75
    v_alignbit_b32 v79, v53, v52, 16
    v_mov_b32 v80, v49
    v_mov_b32 v81, v50
    v_mov_b32 v82, v51
    v_mov_b32 v83, v52
    ds_write_b64 v4, v[48:49] offset:12792
    ds_write_b64 v4, v[50:51] offset:12800
    ds_write_b128 v4, v[72:75] offset:64
    ds_write_b128 v4, v[80:83] offset:4224
    ds_write_b128 v4, v[76:79] offset:8384
    s_waitcnt lgkmcnt(0)

    v_alignbit_b32 v72, v55, v54, 16
    v_alignbit_b32 v73, v56, v55, 16
    v_alignbit_b32 v74, v57, v56, 16
    v_alignbit_b32 v75, v58, v57, 16
    v_mov_b32 v76, v73
    v_mov_b32 v77, v74
    v_mov_b32 v78, v75
    v_alignbit_b32 v79, v59, v58, 16
    v_mov_b32 v80, v55
    v_mov_b32 v81, v56
    v_mov_b32 v82, v57
    v_mov_b32 v83, v58
    ds_write_b64 v4, v[54:55] offset:13816
    ds_write_b64 v4, v[56:57] offset:13824
    ds_write_b128 v4, v[72:75] offset:1088
    ds_write_b128 v4, v[80:83] offset:5248
    ds_write_b128 v4, v[76:79] offset:9408
    s_waitcnt lgkmcnt(0)

    s_barrier
    s_cmp_lg_u32 s27, 0
    s_cbranch_scc1 conv_odd
    ds_read_b64 v[16:17], v12 offset:0
    ds_read_b64 v[18:19], v12 offset:8
    ds_read_b128 v[48:51], v14 offset:2512
    ds_read_b128 v[32:35], v13 offset:2512
    ds_read_b64 v[20:21], v12 offset:64
    ds_read_b64 v[22:23], v12 offset:72
    ds_read_b128 v[52:55], v14 offset:2432
    ds_read_b128 v[36:39], v13 offset:2432
    ds_read_b64 v[24:25], v12 offset:128
    ds_read_b64 v[26:27], v12 offset:136
    ds_read_b128 v[56:59], v14 offset:2352
    ds_read_b128 v[40:43], v13 offset:2352
    s_waitcnt lgkmcnt(8)
    v_mfma_f32_32x32x16_bf16 v[80:95], v[16:19], v[48:51], 0
    v_mfma_f32_32x32x16_bf16 v[64:79], v[16:19], v[32:35], 0
    ds_read_b64 v[16:17], v12 offset:192
    ds_read_b64 v[18:19], v12 offset:200
    ds_read_b128 v[48:51], v14 offset:2272
    ds_read_b128 v[32:35], v13 offset:2272
    s_waitcnt lgkmcnt(8)
    v_mfma_f32_32x32x16_bf16 v[80:95], v[20:23], v[52:55], v[80:95]
    v_mfma_f32_32x32x16_bf16 v[64:79], v[20:23], v[36:39], v[64:79]
    ds_read_b64 v[20:21], v12 offset:256
    ds_read_b64 v[22:23], v12 offset:264
    ds_read_b128 v[52:55], v14 offset:2192
    ds_read_b128 v[36:39], v13 offset:2192
    s_waitcnt lgkmcnt(8)
    v_mfma_f32_32x32x16_bf16 v[80:95], v[24:27], v[56:59], v[80:95]
    v_mfma_f32_32x32x16_bf16 v[64:79], v[24:27], v[40:43], v[64:79]
    ds_read_b64 v[24:25], v12 offset:320
    ds_read_b64 v[26:27], v12 offset:328
    ds_read_b128 v[56:59], v14 offset:2112
    ds_read_b128 v[40:43], v13 offset:2112
    s_waitcnt lgkmcnt(8)
    v_mfma_f32_32x32x16_bf16 v[80:95], v[16:19], v[48:51], v[80:95]
    v_mfma_f32_32x32x16_bf16 v[64:79], v[16:19], v[32:35], v[64:79]
    ds_read_b64 v[16:17], v12 offset:384
    ds_read_b64 v[18:19], v12 offset:392
    ds_read_b128 v[48:51], v14 offset:2032
    ds_read_b128 v[32:35], v13 offset:2032
    s_waitcnt lgkmcnt(8)
    v_mfma_f32_32x32x16_bf16 v[80:95], v[20:23], v[52:55], v[80:95]
    v_mfma_f32_32x32x16_bf16 v[64:79], v[20:23], v[36:39], v[64:79]
    ds_read_b64 v[20:21], v12 offset:448
    ds_read_b64 v[22:23], v12 offset:456
    ds_read_b128 v[52:55], v14 offset:1952
    ds_read_b128 v[36:39], v13 offset:1952
    s_waitcnt lgkmcnt(8)
    v_mfma_f32_32x32x16_bf16 v[80:95], v[24:27], v[56:59], v[80:95]
    v_mfma_f32_32x32x16_bf16 v[64:79], v[24:27], v[40:43], v[64:79]
    ds_read_b64 v[24:25], v12 offset:512
    ds_read_b64 v[26:27], v12 offset:520
    ds_read_b128 v[56:59], v14 offset:1872
    ds_read_b128 v[40:43], v13 offset:1872
    s_waitcnt lgkmcnt(8)
    v_mfma_f32_32x32x16_bf16 v[80:95], v[16:19], v[48:51], v[80:95]
    v_mfma_f32_32x32x16_bf16 v[64:79], v[16:19], v[32:35], v[64:79]
    ds_read_b64 v[16:17], v12 offset:576
    ds_read_b64 v[18:19], v12 offset:584
    ds_read_b128 v[48:51], v14 offset:1792
    ds_read_b128 v[32:35], v13 offset:1792
    s_waitcnt lgkmcnt(8)
    v_mfma_f32_32x32x16_bf16 v[80:95], v[20:23], v[52:55], v[80:95]
    v_mfma_f32_32x32x16_bf16 v[64:79], v[20:23], v[36:39], v[64:79]
    ds_read_b64 v[20:21], v12 offset:640
    ds_read_b64 v[22:23], v12 offset:648
    ds_read_b128 v[52:55], v14 offset:1712
    ds_read_b128 v[36:39], v13 offset:1712
    s_waitcnt lgkmcnt(8)
    v_mfma_f32_32x32x16_bf16 v[80:95], v[24:27], v[56:59], v[80:95]
    v_mfma_f32_32x32x16_bf16 v[64:79], v[24:27], v[40:43], v[64:79]
    ds_read_b64 v[24:25], v12 offset:704
    ds_read_b64 v[26:27], v12 offset:712
    ds_read_b128 v[56:59], v14 offset:1632
    ds_read_b128 v[40:43], v13 offset:1632
    s_waitcnt lgkmcnt(8)
    v_mfma_f32_32x32x16_bf16 v[80:95], v[16:19], v[48:51], v[80:95]
    v_mfma_f32_32x32x16_bf16 v[64:79], v[16:19], v[32:35], v[64:79]
    ds_read_b64 v[16:17], v12 offset:768
    ds_read_b64 v[18:19], v12 offset:776
    ds_read_b128 v[48:51], v14 offset:1552
    ds_read_b128 v[32:35], v13 offset:1552
    s_waitcnt lgkmcnt(8)
    v_mfma_f32_32x32x16_bf16 v[80:95], v[20:23], v[52:55], v[80:95]
    v_mfma_f32_32x32x16_bf16 v[64:79], v[20:23], v[36:39], v[64:79]
    ds_read_b64 v[20:21], v12 offset:832
    ds_read_b64 v[22:23], v12 offset:840
    ds_read_b128 v[52:55], v14 offset:1472
    ds_read_b128 v[36:39], v13 offset:1472
    s_waitcnt lgkmcnt(8)
    v_mfma_f32_32x32x16_bf16 v[80:95], v[24:27], v[56:59], v[80:95]
    v_mfma_f32_32x32x16_bf16 v[64:79], v[24:27], v[40:43], v[64:79]
    ds_read_b64 v[24:25], v12 offset:896
    ds_read_b64 v[26:27], v12 offset:904
    ds_read_b128 v[56:59], v14 offset:1392
    ds_read_b128 v[40:43], v13 offset:1392
    s_waitcnt lgkmcnt(8)
    v_mfma_f32_32x32x16_bf16 v[80:95], v[16:19], v[48:51], v[80:95]
    v_mfma_f32_32x32x16_bf16 v[64:79], v[16:19], v[32:35], v[64:79]
    ds_read_b64 v[16:17], v12 offset:960
    ds_read_b64 v[18:19], v12 offset:968
    ds_read_b128 v[48:51], v14 offset:1312
    ds_read_b128 v[32:35], v13 offset:1312
    s_waitcnt lgkmcnt(8)
    v_mfma_f32_32x32x16_bf16 v[80:95], v[20:23], v[52:55], v[80:95]
    v_mfma_f32_32x32x16_bf16 v[64:79], v[20:23], v[36:39], v[64:79]
    ds_read_b64 v[20:21], v12 offset:1024
    ds_read_b64 v[22:23], v12 offset:1032
    ds_read_b128 v[52:55], v14 offset:1232
    ds_read_b128 v[36:39], v13 offset:1232
    s_waitcnt lgkmcnt(8)
    v_mfma_f32_32x32x16_bf16 v[80:95], v[24:27], v[56:59], v[80:95]
    v_mfma_f32_32x32x16_bf16 v[64:79], v[24:27], v[40:43], v[64:79]
    ds_read_b64 v[24:25], v12 offset:1088
    ds_read_b64 v[26:27], v12 offset:1096
    ds_read_b128 v[56:59], v14 offset:1152
    ds_read_b128 v[40:43], v13 offset:1152
    s_waitcnt lgkmcnt(8)
    v_mfma_f32_32x32x16_bf16 v[80:95], v[16:19], v[48:51], v[80:95]
    v_mfma_f32_32x32x16_bf16 v[64:79], v[16:19], v[32:35], v[64:79]
    ds_read_b64 v[16:17], v12 offset:1152
    ds_read_b64 v[18:19], v12 offset:1160
    ds_read_b128 v[48:51], v14 offset:1072
    ds_read_b128 v[32:35], v13 offset:1072
    s_waitcnt lgkmcnt(8)
    v_mfma_f32_32x32x16_bf16 v[80:95], v[20:23], v[52:55], v[80:95]
    v_mfma_f32_32x32x16_bf16 v[64:79], v[20:23], v[36:39], v[64:79]
    ds_read_b64 v[20:21], v12 offset:1216
    ds_read_b64 v[22:23], v12 offset:1224
    ds_read_b128 v[52:55], v14 offset:992
    ds_read_b128 v[36:39], v13 offset:992
    s_waitcnt lgkmcnt(8)
    v_mfma_f32_32x32x16_bf16 v[80:95], v[24:27], v[56:59], v[80:95]
    v_mfma_f32_32x32x16_bf16 v[64:79], v[24:27], v[40:43], v[64:79]
    ds_read_b64 v[24:25], v12 offset:1280
    ds_read_b64 v[26:27], v12 offset:1288
    ds_read_b128 v[56:59], v14 offset:912
    ds_read_b128 v[40:43], v13 offset:912
    s_waitcnt lgkmcnt(8)
    v_mfma_f32_32x32x16_bf16 v[80:95], v[16:19], v[48:51], v[80:95]
    v_mfma_f32_32x32x16_bf16 v[64:79], v[16:19], v[32:35], v[64:79]
    ds_read_b64 v[16:17], v12 offset:1344
    ds_read_b64 v[18:19], v12 offset:1352
    ds_read_b128 v[48:51], v14 offset:832
    ds_read_b128 v[32:35], v13 offset:832
    s_waitcnt lgkmcnt(8)
    v_mfma_f32_32x32x16_bf16 v[80:95], v[20:23], v[52:55], v[80:95]
    v_mfma_f32_32x32x16_bf16 v[64:79], v[20:23], v[36:39], v[64:79]
    ds_read_b64 v[20:21], v12 offset:1408
    ds_read_b64 v[22:23], v12 offset:1416
    ds_read_b128 v[52:55], v14 offset:752
    ds_read_b128 v[36:39], v13 offset:752
    s_waitcnt lgkmcnt(8)
    v_mfma_f32_32x32x16_bf16 v[80:95], v[24:27], v[56:59], v[80:95]
    v_mfma_f32_32x32x16_bf16 v[64:79], v[24:27], v[40:43], v[64:79]
    ds_read_b64 v[24:25], v12 offset:1472
    ds_read_b64 v[26:27], v12 offset:1480
    ds_read_b128 v[56:59], v14 offset:672
    ds_read_b128 v[40:43], v13 offset:672
    s_waitcnt lgkmcnt(8)
    v_mfma_f32_32x32x16_bf16 v[80:95], v[16:19], v[48:51], v[80:95]
    v_mfma_f32_32x32x16_bf16 v[64:79], v[16:19], v[32:35], v[64:79]
    ds_read_b64 v[16:17], v12 offset:1536
    ds_read_b64 v[18:19], v12 offset:1544
    ds_read_b128 v[48:51], v14 offset:592
    ds_read_b128 v[32:35], v13 offset:592
    s_waitcnt lgkmcnt(8)
    v_mfma_f32_32x32x16_bf16 v[80:95], v[20:23], v[52:55], v[80:95]
    v_mfma_f32_32x32x16_bf16 v[64:79], v[20:23], v[36:39], v[64:79]
    ds_read_b64 v[20:21], v12 offset:1600
    ds_read_b64 v[22:23], v12 offset:1608
    ds_read_b128 v[52:55], v14 offset:512
    ds_read_b128 v[36:39], v13 offset:512
    s_waitcnt lgkmcnt(8)
    v_mfma_f32_32x32x16_bf16 v[80:95], v[24:27], v[56:59], v[80:95]
    v_mfma_f32_32x32x16_bf16 v[64:79], v[24:27], v[40:43], v[64:79]
    ds_read_b64 v[24:25], v12 offset:1664
    ds_read_b64 v[26:27], v12 offset:1672
    ds_read_b128 v[56:59], v14 offset:432
    ds_read_b128 v[40:43], v13 offset:432
    s_waitcnt lgkmcnt(8)
    v_mfma_f32_32x32x16_bf16 v[80:95], v[16:19], v[48:51], v[80:95]
    v_mfma_f32_32x32x16_bf16 v[64:79], v[16:19], v[32:35], v[64:79]
    ds_read_b64 v[16:17], v12 offset:1728
    ds_read_b64 v[18:19], v12 offset:1736
    ds_read_b128 v[48:51], v14 offset:352
    ds_read_b128 v[32:35], v13 offset:352
    s_waitcnt lgkmcnt(8)
    v_mfma_f32_32x32x16_bf16 v[80:95], v[20:23], v[52:55], v[80:95]
    v_mfma_f32_32x32x16_bf16 v[64:79], v[20:23], v[36:39], v[64:79]
    ds_read_b64 v[20:21], v12 offset:1792
    ds_read_b64 v[22:23], v12 offset:1800
    ds_read_b128 v[52:55], v14 offset:272
    ds_read_b128 v[36:39], v13 offset:272
    s_waitcnt lgkmcnt(8)
    v_mfma_f32_32x32x16_bf16 v[80:95], v[24:27], v[56:59], v[80:95]
    v_mfma_f32_32x32x16_bf16 v[64:79], v[24:27], v[40:43], v[64:79]
    ds_read_b64 v[24:25], v12 offset:1856
    ds_read_b64 v[26:27], v12 offset:1864
    ds_read_b128 v[56:59], v14 offset:192
    ds_read_b128 v[40:43], v13 offset:192
    s_waitcnt lgkmcnt(8)
    v_mfma_f32_32x32x16_bf16 v[80:95], v[16:19], v[48:51], v[80:95]
    v_mfma_f32_32x32x16_bf16 v[64:79], v[16:19], v[32:35], v[64:79]
    ds_read_b64 v[16:17], v12 offset:1920
    ds_read_b64 v[18:19], v12 offset:1928
    ds_read_b128 v[48:51], v14 offset:112
    ds_read_b128 v[32:35], v13 offset:112
    s_waitcnt lgkmcnt(8)
    v_mfma_f32_32x32x16_bf16 v[80:95], v[20:23], v[52:55], v[80:95]
    v_mfma_f32_32x32x16_bf16 v[64:79], v[20:23], v[36:39], v[64:79]
    ds_read_b64 v[20:21], v12 offset:1984
    ds_read_b64 v[22:23], v12 offset:1992
    ds_read_b128 v[52:55], v14 offset:32
    ds_read_b128 v[36:39], v13 offset:32
    s_waitcnt lgkmcnt(8)
    v_mfma_f32_32x32x16_bf16 v[80:95], v[24:27], v[56:59], v[80:95]
    v_mfma_f32_32x32x16_bf16 v[64:79], v[24:27], v[40:43], v[64:79]
    ds_read_b64 v[24:25], v12 offset:2048
    ds_read_b64 v[26:27], v12 offset:2056
    ds_read_b128 v[56:59], v13 offset:2512
    s_waitcnt lgkmcnt(7)
    v_mfma_f32_32x32x16_bf16 v[80:95], v[16:19], v[48:51], v[80:95]
    v_mfma_f32_32x32x16_bf16 v[64:79], v[16:19], v[32:35], v[64:79]
    ds_read_b64 v[16:17], v12 offset:2112
    ds_read_b64 v[18:19], v12 offset:2120
    ds_read_b128 v[48:51], v13 offset:2432
    s_waitcnt lgkmcnt(6)
    v_mfma_f32_32x32x16_bf16 v[80:95], v[20:23], v[52:55], v[80:95]
    v_mfma_f32_32x32x16_bf16 v[64:79], v[20:23], v[36:39], v[64:79]
    ds_read_b64 v[20:21], v12 offset:2176
    ds_read_b64 v[22:23], v12 offset:2184
    ds_read_b128 v[52:55], v13 offset:2352
    s_waitcnt lgkmcnt(6)
    v_mfma_f32_32x32x16_bf16 v[80:95], v[24:27], v[56:59], v[80:95]
    ds_read_b64 v[24:25], v12 offset:2240
    ds_read_b64 v[26:27], v12 offset:2248
    ds_read_b128 v[56:59], v13 offset:2272
    s_waitcnt lgkmcnt(6)
    v_mfma_f32_32x32x16_bf16 v[80:95], v[16:19], v[48:51], v[80:95]
    ds_read_b64 v[16:17], v12 offset:2304
    ds_read_b64 v[18:19], v12 offset:2312
    ds_read_b128 v[48:51], v13 offset:2192
    s_waitcnt lgkmcnt(6)
    v_mfma_f32_32x32x16_bf16 v[80:95], v[20:23], v[52:55], v[80:95]
    ds_read_b64 v[20:21], v12 offset:2368
    ds_read_b64 v[22:23], v12 offset:2376
    ds_read_b128 v[52:55], v13 offset:2112
    s_waitcnt lgkmcnt(6)
    v_mfma_f32_32x32x16_bf16 v[80:95], v[24:27], v[56:59], v[80:95]
    ds_read_b64 v[24:25], v12 offset:2432
    ds_read_b64 v[26:27], v12 offset:2440
    ds_read_b128 v[56:59], v13 offset:2032
    s_waitcnt lgkmcnt(6)
    v_mfma_f32_32x32x16_bf16 v[80:95], v[16:19], v[48:51], v[80:95]
    ds_read_b64 v[16:17], v12 offset:2496
    ds_read_b64 v[18:19], v12 offset:2504
    ds_read_b128 v[48:51], v13 offset:1952
    s_waitcnt lgkmcnt(6)
    v_mfma_f32_32x32x16_bf16 v[80:95], v[20:23], v[52:55], v[80:95]
    ds_read_b64 v[20:21], v12 offset:2560
    ds_read_b64 v[22:23], v12 offset:2568
    ds_read_b128 v[52:55], v13 offset:1872
    s_waitcnt lgkmcnt(6)
    v_mfma_f32_32x32x16_bf16 v[80:95], v[24:27], v[56:59], v[80:95]
    ds_read_b64 v[24:25], v12 offset:2624
    ds_read_b64 v[26:27], v12 offset:2632
    ds_read_b128 v[56:59], v13 offset:1792
    s_waitcnt lgkmcnt(6)
    v_mfma_f32_32x32x16_bf16 v[80:95], v[16:19], v[48:51], v[80:95]
    ds_read_b64 v[16:17], v12 offset:2688
    ds_read_b64 v[18:19], v12 offset:2696
    ds_read_b128 v[48:51], v13 offset:1712
    s_waitcnt lgkmcnt(6)
    v_mfma_f32_32x32x16_bf16 v[80:95], v[20:23], v[52:55], v[80:95]
    ds_read_b64 v[20:21], v12 offset:2752
    ds_read_b64 v[22:23], v12 offset:2760
    ds_read_b128 v[52:55], v13 offset:1632
    s_waitcnt lgkmcnt(6)
    v_mfma_f32_32x32x16_bf16 v[80:95], v[24:27], v[56:59], v[80:95]
    ds_read_b64 v[24:25], v12 offset:2816
    ds_read_b64 v[26:27], v12 offset:2824
    ds_read_b128 v[56:59], v13 offset:1552
    s_waitcnt lgkmcnt(6)
    v_mfma_f32_32x32x16_bf16 v[80:95], v[16:19], v[48:51], v[80:95]
    ds_read_b64 v[16:17], v12 offset:2880
    ds_read_b64 v[18:19], v12 offset:2888
    ds_read_b128 v[48:51], v13 offset:1472
    s_waitcnt lgkmcnt(6)
    v_mfma_f32_32x32x16_bf16 v[80:95], v[20:23], v[52:55], v[80:95]
    ds_read_b64 v[20:21], v12 offset:2944
    ds_read_b64 v[22:23], v12 offset:2952
    ds_read_b128 v[52:55], v13 offset:1392
    s_waitcnt lgkmcnt(6)
    v_mfma_f32_32x32x16_bf16 v[80:95], v[24:27], v[56:59], v[80:95]
    ds_read_b64 v[24:25], v12 offset:3008
    ds_read_b64 v[26:27], v12 offset:3016
    ds_read_b128 v[56:59], v13 offset:1312
    s_waitcnt lgkmcnt(6)
    v_mfma_f32_32x32x16_bf16 v[80:95], v[16:19], v[48:51], v[80:95]
    ds_read_b64 v[16:17], v12 offset:3072
    ds_read_b64 v[18:19], v12 offset:3080
    ds_read_b128 v[48:51], v13 offset:1232
    s_waitcnt lgkmcnt(6)
    v_mfma_f32_32x32x16_bf16 v[80:95], v[20:23], v[52:55], v[80:95]
    ds_read_b64 v[20:21], v12 offset:3136
    ds_read_b64 v[22:23], v12 offset:3144
    ds_read_b128 v[52:55], v13 offset:1152
    s_waitcnt lgkmcnt(6)
    v_mfma_f32_32x32x16_bf16 v[80:95], v[24:27], v[56:59], v[80:95]
    ds_read_b64 v[24:25], v12 offset:3200
    ds_read_b64 v[26:27], v12 offset:3208
    ds_read_b128 v[56:59], v13 offset:1072
    s_waitcnt lgkmcnt(6)
    v_mfma_f32_32x32x16_bf16 v[80:95], v[16:19], v[48:51], v[80:95]
    ds_read_b64 v[16:17], v12 offset:3264
    ds_read_b64 v[18:19], v12 offset:3272
    ds_read_b128 v[48:51], v13 offset:992
    s_waitcnt lgkmcnt(6)
    v_mfma_f32_32x32x16_bf16 v[80:95], v[20:23], v[52:55], v[80:95]
    ds_read_b64 v[20:21], v12 offset:3328
    ds_read_b64 v[22:23], v12 offset:3336
    ds_read_b128 v[52:55], v13 offset:912
    s_waitcnt lgkmcnt(6)
    v_mfma_f32_32x32x16_bf16 v[80:95], v[24:27], v[56:59], v[80:95]
    ds_read_b64 v[24:25], v12 offset:3392
    ds_read_b64 v[26:27], v12 offset:3400
    ds_read_b128 v[56:59], v13 offset:832
    s_waitcnt lgkmcnt(6)
    v_mfma_f32_32x32x16_bf16 v[80:95], v[16:19], v[48:51], v[80:95]
    ds_read_b64 v[16:17], v12 offset:3456
    ds_read_b64 v[18:19], v12 offset:3464
    ds_read_b128 v[48:51], v13 offset:752
    s_waitcnt lgkmcnt(6)
    v_mfma_f32_32x32x16_bf16 v[80:95], v[20:23], v[52:55], v[80:95]
    ds_read_b64 v[20:21], v12 offset:3520
    ds_read_b64 v[22:23], v12 offset:3528
    ds_read_b128 v[52:55], v13 offset:672
    s_waitcnt lgkmcnt(6)
    v_mfma_f32_32x32x16_bf16 v[80:95], v[24:27], v[56:59], v[80:95]
    ds_read_b64 v[24:25], v12 offset:3584
    ds_read_b64 v[26:27], v12 offset:3592
    ds_read_b128 v[56:59], v13 offset:592
    s_waitcnt lgkmcnt(6)
    v_mfma_f32_32x32x16_bf16 v[80:95], v[16:19], v[48:51], v[80:95]
    ds_read_b64 v[16:17], v12 offset:3648
    ds_read_b64 v[18:19], v12 offset:3656
    ds_read_b128 v[48:51], v13 offset:512
    s_waitcnt lgkmcnt(6)
    v_mfma_f32_32x32x16_bf16 v[80:95], v[20:23], v[52:55], v[80:95]
    ds_read_b64 v[20:21], v12 offset:3712
    ds_read_b64 v[22:23], v12 offset:3720
    ds_read_b128 v[52:55], v13 offset:432
    s_waitcnt lgkmcnt(6)
    v_mfma_f32_32x32x16_bf16 v[80:95], v[24:27], v[56:59], v[80:95]
    ds_read_b64 v[24:25], v12 offset:3776
    ds_read_b64 v[26:27], v12 offset:3784
    ds_read_b128 v[56:59], v13 offset:352
    s_waitcnt lgkmcnt(6)
    v_mfma_f32_32x32x16_bf16 v[80:95], v[16:19], v[48:51], v[80:95]
    ds_read_b64 v[16:17], v12 offset:3840
    ds_read_b64 v[18:19], v12 offset:3848
    ds_read_b128 v[48:51], v13 offset:272
    s_waitcnt lgkmcnt(6)
    v_mfma_f32_32x32x16_bf16 v[80:95], v[20:23], v[52:55], v[80:95]
    ds_read_b64 v[20:21], v12 offset:3904
    ds_read_b64 v[22:23], v12 offset:3912
    ds_read_b128 v[52:55], v13 offset:192
    s_waitcnt lgkmcnt(6)
    v_mfma_f32_32x32x16_bf16 v[80:95], v[24:27], v[56:59], v[80:95]
    ds_read_b64 v[24:25], v12 offset:3968
    ds_read_b64 v[26:27], v12 offset:3976
    ds_read_b128 v[56:59], v13 offset:112
    s_waitcnt lgkmcnt(6)
    v_mfma_f32_32x32x16_bf16 v[80:95], v[16:19], v[48:51], v[80:95]
    ds_read_b64 v[16:17], v12 offset:4032
    ds_read_b64 v[18:19], v12 offset:4040
    ds_read_b128 v[48:51], v13 offset:32
    s_waitcnt lgkmcnt(6)
    v_mfma_f32_32x32x16_bf16 v[80:95], v[20:23], v[52:55], v[80:95]
    s_waitcnt lgkmcnt(3)
    v_mfma_f32_32x32x16_bf16 v[80:95], v[24:27], v[56:59], v[80:95]
    s_waitcnt lgkmcnt(0)
    v_mfma_f32_32x32x16_bf16 v[80:95], v[16:19], v[48:51], v[80:95]
    s_nop 7
    s_nop 7
    s_barrier
    s_barrier
    ds_read_b128 v[16:19], v3 offset:0
    ds_read_b128 v[20:23], v3 offset:1024
    ds_read_b128 v[24:27], v3 offset:2048
    ds_read_b128 v[28:31], v3 offset:3072
    ds_read_b128 v[32:35], v3 offset:4096
    ds_read_b128 v[36:39], v3 offset:5120
    ds_read_b128 v[40:43], v3 offset:6144
    ds_read_b128 v[44:47], v3 offset:7168
    s_waitcnt lgkmcnt(7)
    v_add_f32 v64, v64, v16
    v_add_f32 v65, v65, v17
    v_add_f32 v66, v66, v18
    v_add_f32 v67, v67, v19
    s_waitcnt lgkmcnt(6)
    v_add_f32 v68, v68, v20
    v_add_f32 v69, v69, v21
    v_add_f32 v70, v70, v22
    v_add_f32 v71, v71, v23
    s_waitcnt lgkmcnt(5)
    v_add_f32 v72, v72, v24
    v_add_f32 v73, v73, v25
    v_add_f32 v74, v74, v26
    v_add_f32 v75, v75, v27
    s_waitcnt lgkmcnt(4)
    v_add_f32 v76, v76, v28
    v_add_f32 v77, v77, v29
    v_add_f32 v78, v78, v30
    v_add_f32 v79, v79, v31
    s_waitcnt lgkmcnt(3)
    v_add_f32 v80, v80, v32
    v_add_f32 v81, v81, v33
    v_add_f32 v82, v82, v34
    v_add_f32 v83, v83, v35
    s_waitcnt lgkmcnt(2)
    v_add_f32 v84, v84, v36
    v_add_f32 v85, v85, v37
    v_add_f32 v86, v86, v38
    v_add_f32 v87, v87, v39
    s_waitcnt lgkmcnt(1)
    v_add_f32 v88, v88, v40
    v_add_f32 v89, v89, v41
    v_add_f32 v90, v90, v42
    v_add_f32 v91, v91, v43
    s_waitcnt lgkmcnt(0)
    v_add_f32 v92, v92, v44
    v_add_f32 v93, v93, v45
    v_add_f32 v94, v94, v46
    v_add_f32 v95, v95, v47
    s_branch conv_epi
conv_odd:
    ds_read_b64 v[16:17], v12 offset:32
    ds_read_b64 v[18:19], v12 offset:40
    ds_read_b128 v[48:51], v14 offset:2480
    ds_read_b128 v[32:35], v13 offset:2480
    ds_read_b64 v[20:21], v12 offset:96
    ds_read_b64 v[22:23], v12 offset:104
    ds_read_b128 v[52:55], v14 offset:2400
    ds_read_b128 v[36:39], v13 offset:2400
    ds_read_b64 v[24:25], v12 offset:160
    ds_read_b64 v[26:27], v12 offset:168
    ds_read_b128 v[56:59], v14 offset:2320
    ds_read_b128 v[40:43], v13 offset:2320
    s_waitcnt lgkmcnt(8)
    v_mfma_f32_32x32x16_bf16 v[80:95], v[16:19], v[48:51], 0
    v_mfma_f32_32x32x16_bf16 v[64:79], v[16:19], v[32:35], 0
    ds_read_b64 v[16:17], v12 offset:224
    ds_read_b64 v[18:19], v12 offset:232
    ds_read_b128 v[48:51], v14 offset:2240
    ds_read_b128 v[32:35], v13 offset:2240
    s_waitcnt lgkmcnt(8)
    v_mfma_f32_32x32x16_bf16 v[80:95], v[20:23], v[52:55], v[80:95]
    v_mfma_f32_32x32x16_bf16 v[64:79], v[20:23], v[36:39], v[64:79]
    ds_read_b64 v[20:21], v12 offset:288
    ds_read_b64 v[22:23], v12 offset:296
    ds_read_b128 v[52:55], v14 offset:2160
    ds_read_b128 v[36:39], v13 offset:2160
    s_waitcnt lgkmcnt(8)
    v_mfma_f32_32x32x16_bf16 v[80:95], v[24:27], v[56:59], v[80:95]
    v_mfma_f32_32x32x16_bf16 v[64:79], v[24:27], v[40:43], v[64:79]
    ds_read_b64 v[24:25], v12 offset:352
    ds_read_b64 v[26:27], v12 offset:360
    ds_read_b128 v[56:59], v14 offset:2080
    ds_read_b128 v[40:43], v13 offset:2080
    s_waitcnt lgkmcnt(8)
    v_mfma_f32_32x32x16_bf16 v[80:95], v[16:19], v[48:51], v[80:95]
    v_mfma_f32_32x32x16_bf16 v[64:79], v[16:19], v[32:35], v[64:79]
    ds_read_b64 v[16:17], v12 offset:416
    ds_read_b64 v[18:19], v12 offset:424
    ds_read_b128 v[48:51], v14 offset:2000
    ds_read_b128 v[32:35], v13 offset:2000
    s_waitcnt lgkmcnt(8)
    v_mfma_f32_32x32x16_bf16 v[80:95], v[20:23], v[52:55], v[80:95]
    v_mfma_f32_32x32x16_bf16 v[64:79], v[20:23], v[36:39], v[64:79]
    ds_read_b64 v[20:21], v12 offset:480
    ds_read_b64 v[22:23], v12 offset:488
    ds_read_b128 v[52:55], v14 offset:1920
    ds_read_b128 v[36:39], v13 offset:1920
    s_waitcnt lgkmcnt(8)
    v_mfma_f32_32x32x16_bf16 v[80:95], v[24:27], v[56:59], v[80:95]
    v_mfma_f32_32x32x16_bf16 v[64:79], v[24:27], v[40:43], v[64:79]
    ds_read_b64 v[24:25], v12 offset:544
    ds_read_b64 v[26:27], v12 offset:552
    ds_read_b128 v[56:59], v14 offset:1840
    ds_read_b128 v[40:43], v13 offset:1840
    s_waitcnt lgkmcnt(8)
    v_mfma_f32_32x32x16_bf16 v[80:95], v[16:19], v[48:51], v[80:95]
    v_mfma_f32_32x32x16_bf16 v[64:79], v[16:19], v[32:35], v[64:79]
    ds_read_b64 v[16:17], v12 offset:608
    ds_read_b64 v[18:19], v12 offset:616
    ds_read_b128 v[48:51], v14 offset:1760
    ds_read_b128 v[32:35], v13 offset:1760
    s_waitcnt lgkmcnt(8)
    v_mfma_f32_32x32x16_bf16 v[80:95], v[20:23], v[52:55], v[80:95]
    v_mfma_f32_32x32x16_bf16 v[64:79], v[20:23], v[36:39], v[64:79]
    ds_read_b64 v[20:21], v12 offset:672
    ds_read_b64 v[22:23], v12 offset:680
    ds_read_b128 v[52:55], v14 offset:1680
    ds_read_b128 v[36:39], v13 offset:1680
    s_waitcnt lgkmcnt(8)
    v_mfma_f32_32x32x16_bf16 v[80:95], v[24:27], v[56:59], v[80:95]
    v_mfma_f32_32x32x16_bf16 v[64:79], v[24:27], v[40:43], v[64:79]
    ds_read_b64 v[24:25], v12 offset:736
    ds_read_b64 v[26:27], v12 offset:744
    ds_read_b128 v[56:59], v14 offset:1600
    ds_read_b128 v[40:43], v13 offset:1600
    s_waitcnt lgkmcnt(8)
    v_mfma_f32_32x32x16_bf16 v[80:95], v[16:19], v[48:51], v[80:95]
    v_mfma_f32_32x32x16_bf16 v[64:79], v[16:19], v[32:35], v[64:79]
    ds_read_b64 v[16:17], v12 offset:800
    ds_read_b64 v[18:19], v12 offset:808
    ds_read_b128 v[48:51], v14 offset:1520
    ds_read_b128 v[32:35], v13 offset:1520
    s_waitcnt lgkmcnt(8)
    v_mfma_f32_32x32x16_bf16 v[80:95], v[20:23], v[52:55], v[80:95]
    v_mfma_f32_32x32x16_bf16 v[64:79], v[20:23], v[36:39], v[64:79]
    ds_read_b64 v[20:21], v12 offset:864
    ds_read_b64 v[22:23], v12 offset:872
    ds_read_b128 v[52:55], v14 offset:1440
    ds_read_b128 v[36:39], v13 offset:1440
    s_waitcnt lgkmcnt(8)
    v_mfma_f32_32x32x16_bf16 v[80:95], v[24:27], v[56:59], v[80:95]
    v_mfma_f32_32x32x16_bf16 v[64:79], v[24:27], v[40:43], v[64:79]
    ds_read_b64 v[24:25], v12 offset:928
    ds_read_b64 v[26:27], v12 offset:936
    ds_read_b128 v[56:59], v14 offset:1360
    ds_read_b128 v[40:43], v13 offset:1360
    s_waitcnt lgkmcnt(8)
    v_mfma_f32_32x32x16_bf16 v[80:95], v[16:19], v[48:51], v[80:95]
    v_mfma_f32_32x32x16_bf16 v[64:79], v[16:19], v[32:35], v[64:79]
    ds_read_b64 v[16:17], v12 offset:992
    ds_read_b64 v[18:19], v12 offset:1000
    ds_read_b128 v[48:51], v14 offset:1280
    ds_read_b128 v[32:35], v13 offset:1280
    s_waitcnt lgkmcnt(8)
    v_mfma_f32_32x32x16_bf16 v[80:95], v[20:23], v[52:55], v[80:95]
    v_mfma_f32_32x32x16_bf16 v[64:79], v[20:23], v[36:39], v[64:79]
    ds_read_b64 v[20:21], v12 offset:1056
    ds_read_b64 v[22:23], v12 offset:1064
    ds_read_b128 v[52:55], v14 offset:1200
    ds_read_b128 v[36:39], v13 offset:1200
    s_waitcnt lgkmcnt(8)
    v_mfma_f32_32x32x16_bf16 v[80:95], v[24:27], v[56:59], v[80:95]
    v_mfma_f32_32x32x16_bf16 v[64:79], v[24:27], v[40:43], v[64:79]
    ds_read_b64 v[24:25], v12 offset:1120
    ds_read_b64 v[26:27], v12 offset:1128
    ds_read_b128 v[56:59], v14 offset:1120
    ds_read_b128 v[40:43], v13 offset:1120
    s_waitcnt lgkmcnt(8)
    v_mfma_f32_32x32x16_bf16 v[80:95], v[16:19], v[48:51], v[80:95]
    v_mfma_f32_32x32x16_bf16 v[64:79], v[16:19], v[32:35], v[64:79]
    ds_read_b64 v[16:17], v12 offset:1184
    ds_read_b64 v[18:19], v12 offset:1192
    ds_read_b128 v[48:51], v14 offset:1040
    ds_read_b128 v[32:35], v13 offset:1040
    s_waitcnt lgkmcnt(8)
    v_mfma_f32_32x32x16_bf16 v[80:95], v[20:23], v[52:55], v[80:95]
    v_mfma_f32_32x32x16_bf16 v[64:79], v[20:23], v[36:39], v[64:79]
    ds_read_b64 v[20:21], v12 offset:1248
    ds_read_b64 v[22:23], v12 offset:1256
    ds_read_b128 v[52:55], v14 offset:960
    ds_read_b128 v[36:39], v13 offset:960
    s_waitcnt lgkmcnt(8)
    v_mfma_f32_32x32x16_bf16 v[80:95], v[24:27], v[56:59], v[80:95]
    v_mfma_f32_32x32x16_bf16 v[64:79], v[24:27], v[40:43], v[64:79]
    ds_read_b64 v[24:25], v12 offset:1312
    ds_read_b64 v[26:27], v12 offset:1320
    ds_read_b128 v[56:59], v14 offset:880
    ds_read_b128 v[40:43], v13 offset:880
    s_waitcnt lgkmcnt(8)
    v_mfma_f32_32x32x16_bf16 v[80:95], v[16:19], v[48:51], v[80:95]
    v_mfma_f32_32x32x16_bf16 v[64:79], v[16:19], v[32:35], v[64:79]
    ds_read_b64 v[16:17], v12 offset:1376
    ds_read_b64 v[18:19], v12 offset:1384
    ds_read_b128 v[48:51], v14 offset:800
    ds_read_b128 v[32:35], v13 offset:800
    s_waitcnt lgkmcnt(8)
    v_mfma_f32_32x32x16_bf16 v[80:95], v[20:23], v[52:55], v[80:95]
    v_mfma_f32_32x32x16_bf16 v[64:79], v[20:23], v[36:39], v[64:79]
    ds_read_b64 v[20:21], v12 offset:1440
    ds_read_b64 v[22:23], v12 offset:1448
    ds_read_b128 v[52:55], v14 offset:720
    ds_read_b128 v[36:39], v13 offset:720
    s_waitcnt lgkmcnt(8)
    v_mfma_f32_32x32x16_bf16 v[80:95], v[24:27], v[56:59], v[80:95]
    v_mfma_f32_32x32x16_bf16 v[64:79], v[24:27], v[40:43], v[64:79]
    ds_read_b64 v[24:25], v12 offset:1504
    ds_read_b64 v[26:27], v12 offset:1512
    ds_read_b128 v[56:59], v14 offset:640
    ds_read_b128 v[40:43], v13 offset:640
    s_waitcnt lgkmcnt(8)
    v_mfma_f32_32x32x16_bf16 v[80:95], v[16:19], v[48:51], v[80:95]
    v_mfma_f32_32x32x16_bf16 v[64:79], v[16:19], v[32:35], v[64:79]
    ds_read_b64 v[16:17], v12 offset:1568
    ds_read_b64 v[18:19], v12 offset:1576
    ds_read_b128 v[48:51], v14 offset:560
    ds_read_b128 v[32:35], v13 offset:560
    s_waitcnt lgkmcnt(8)
    v_mfma_f32_32x32x16_bf16 v[80:95], v[20:23], v[52:55], v[80:95]
    v_mfma_f32_32x32x16_bf16 v[64:79], v[20:23], v[36:39], v[64:79]
    ds_read_b64 v[20:21], v12 offset:1632
    ds_read_b64 v[22:23], v12 offset:1640
    ds_read_b128 v[52:55], v14 offset:480
    ds_read_b128 v[36:39], v13 offset:480
    s_waitcnt lgkmcnt(8)
    v_mfma_f32_32x32x16_bf16 v[80:95], v[24:27], v[56:59], v[80:95]
    v_mfma_f32_32x32x16_bf16 v[64:79], v[24:27], v[40:43], v[64:79]
    ds_read_b64 v[24:25], v12 offset:1696
    ds_read_b64 v[26:27], v12 offset:1704
    ds_read_b128 v[56:59], v14 offset:400
    ds_read_b128 v[40:43], v13 offset:400
    s_waitcnt lgkmcnt(8)
    v_mfma_f32_32x32x16_bf16 v[80:95], v[16:19], v[48:51], v[80:95]
    v_mfma_f32_32x32x16_bf16 v[64:79], v[16:19], v[32:35], v[64:79]
    ds_read_b64 v[16:17], v12 offset:1760
    ds_read_b64 v[18:19], v12 offset:1768
    ds_read_b128 v[48:51], v14 offset:320
    ds_read_b128 v[32:35], v13 offset:320
    s_waitcnt lgkmcnt(8)
    v_mfma_f32_32x32x16_bf16 v[80:95], v[20:23], v[52:55], v[80:95]
    v_mfma_f32_32x32x16_bf16 v[64:79], v[20:23], v[36:39], v[64:79]
    ds_read_b64 v[20:21], v12 offset:1824
    ds_read_b64 v[22:23], v12 offset:1832
    ds_read_b128 v[52:55], v14 offset:240
    ds_read_b128 v[36:39], v13 offset:240
    s_waitcnt lgkmcnt(8)
    v_mfma_f32_32x32x16_bf16 v[80:95], v[24:27], v[56:59], v[80:95]
    v_mfma_f32_32x32x16_bf16 v[64:79], v[24:27], v[40:43], v[64:79]
    ds_read_b64 v[24:25], v12 offset:1888
    ds_read_b64 v[26:27], v12 offset:1896
    ds_read_b128 v[56:59], v14 offset:160
    ds_read_b128 v[40:43], v13 offset:160
    s_waitcnt lgkmcnt(8)
    v_mfma_f32_32x32x16_bf16 v[80:95], v[16:19], v[48:51], v[80:95]
    v_mfma_f32_32x32x16_bf16 v[64:79], v[16:19], v[32:35], v[64:79]
    ds_read_b64 v[16:17], v12 offset:1952
    ds_read_b64 v[18:19], v12 offset:1960
    ds_read_b128 v[48:51], v14 offset:80
    ds_read_b128 v[32:35], v13 offset:80
    s_waitcnt lgkmcnt(8)
    v_mfma_f32_32x32x16_bf16 v[80:95], v[20:23], v[52:55], v[80:95]
    v_mfma_f32_32x32x16_bf16 v[64:79], v[20:23], v[36:39], v[64:79]
    ds_read_b64 v[20:21], v12 offset:2016
    ds_read_b64 v[22:23], v12 offset:2024
    ds_read_b128 v[52:55], v14 offset:0
    ds_read_b128 v[36:39], v13 offset:0
    s_waitcnt lgkmcnt(8)
    v_mfma_f32_32x32x16_bf16 v[80:95], v[24:27], v[56:59], v[80:95]
    v_mfma_f32_32x32x16_bf16 v[64:79], v[24:27], v[40:43], v[64:79]
    ds_read_b64 v[24:25], v12 offset:2080
    ds_read_b64 v[26:27], v12 offset:2088
    ds_read_b128 v[56:59], v13 offset:2480
    s_waitcnt lgkmcnt(7)
    v_mfma_f32_32x32x16_bf16 v[80:95], v[16:19], v[48:51], v[80:95]
    v_mfma_f32_32x32x16_bf16 v[64:79], v[16:19], v[32:35], v[64:79]
    ds_read_b64 v[16:17], v12 offset:2144
    ds_read_b64 v[18:19], v12 offset:2152
    ds_read_b128 v[48:51], v13 offset:2400
    s_waitcnt lgkmcnt(6)
    v_mfma_f32_32x32x16_bf16 v[80:95], v[20:23], v[52:55], v[80:95]
    v_mfma_f32_32x32x16_bf16 v[64:79], v[20:23], v[36:39], v[64:79]
    ds_read_b64 v[20:21], v12 offset:2208
    ds_read_b64 v[22:23], v12 offset:2216
    ds_read_b128 v[52:55], v13 offset:2320
    s_waitcnt lgkmcnt(6)
    v_mfma_f32_32x32x16_bf16 v[80:95], v[24:27], v[56:59], v[80:95]
    ds_read_b64 v[24:25], v12 offset:2272
    ds_read_b64 v[26:27], v12 offset:2280
    ds_read_b128 v[56:59], v13 offset:2240
    s_waitcnt lgkmcnt(6)
    v_mfma_f32_32x32x16_bf16 v[80:95], v[16:19], v[48:51], v[80:95]
    ds_read_b64 v[16:17], v12 offset:2336
    ds_read_b64 v[18:19], v12 offset:2344
    ds_read_b128 v[48:51], v13 offset:2160
    s_waitcnt lgkmcnt(6)
    v_mfma_f32_32x32x16_bf16 v[80:95], v[20:23], v[52:55], v[80:95]
    ds_read_b64 v[20:21], v12 offset:2400
    ds_read_b64 v[22:23], v12 offset:2408
    ds_read_b128 v[52:55], v13 offset:2080
    s_waitcnt lgkmcnt(6)
    v_mfma_f32_32x32x16_bf16 v[80:95], v[24:27], v[56:59], v[80:95]
    ds_read_b64 v[24:25], v12 offset:2464
    ds_read_b64 v[26:27], v12 offset:2472
    ds_read_b128 v[56:59], v13 offset:2000
    s_waitcnt lgkmcnt(6)
    v_mfma_f32_32x32x16_bf16 v[80:95], v[16:19], v[48:51], v[80:95]
    ds_read_b64 v[16:17], v12 offset:2528
    ds_read_b64 v[18:19], v12 offset:2536
    ds_read_b128 v[48:51], v13 offset:1920
    s_waitcnt lgkmcnt(6)
    v_mfma_f32_32x32x16_bf16 v[80:95], v[20:23], v[52:55], v[80:95]
    ds_read_b64 v[20:21], v12 offset:2592
    ds_read_b64 v[22:23], v12 offset:2600
    ds_read_b128 v[52:55], v13 offset:1840
    s_waitcnt lgkmcnt(6)
    v_mfma_f32_32x32x16_bf16 v[80:95], v[24:27], v[56:59], v[80:95]
    ds_read_b64 v[24:25], v12 offset:2656
    ds_read_b64 v[26:27], v12 offset:2664
    ds_read_b128 v[56:59], v13 offset:1760
    s_waitcnt lgkmcnt(6)
    v_mfma_f32_32x32x16_bf16 v[80:95], v[16:19], v[48:51], v[80:95]
    ds_read_b64 v[16:17], v12 offset:2720
    ds_read_b64 v[18:19], v12 offset:2728
    ds_read_b128 v[48:51], v13 offset:1680
    s_waitcnt lgkmcnt(6)
    v_mfma_f32_32x32x16_bf16 v[80:95], v[20:23], v[52:55], v[80:95]
    ds_read_b64 v[20:21], v12 offset:2784
    ds_read_b64 v[22:23], v12 offset:2792
    ds_read_b128 v[52:55], v13 offset:1600
    s_waitcnt lgkmcnt(6)
    v_mfma_f32_32x32x16_bf16 v[80:95], v[24:27], v[56:59], v[80:95]
    ds_read_b64 v[24:25], v12 offset:2848
    ds_read_b64 v[26:27], v12 offset:2856
    ds_read_b128 v[56:59], v13 offset:1520
    s_waitcnt lgkmcnt(6)
    v_mfma_f32_32x32x16_bf16 v[80:95], v[16:19], v[48:51], v[80:95]
    ds_read_b64 v[16:17], v12 offset:2912
    ds_read_b64 v[18:19], v12 offset:2920
    ds_read_b128 v[48:51], v13 offset:1440
    s_waitcnt lgkmcnt(6)
    v_mfma_f32_32x32x16_bf16 v[80:95], v[20:23], v[52:55], v[80:95]
    ds_read_b64 v[20:21], v12 offset:2976
    ds_read_b64 v[22:23], v12 offset:2984
    ds_read_b128 v[52:55], v13 offset:1360
    s_waitcnt lgkmcnt(6)
    v_mfma_f32_32x32x16_bf16 v[80:95], v[24:27], v[56:59], v[80:95]
    ds_read_b64 v[24:25], v12 offset:3040
    ds_read_b64 v[26:27], v12 offset:3048
    ds_read_b128 v[56:59], v13 offset:1280
    s_waitcnt lgkmcnt(6)
    v_mfma_f32_32x32x16_bf16 v[80:95], v[16:19], v[48:51], v[80:95]
    ds_read_b64 v[16:17], v12 offset:3104
    ds_read_b64 v[18:19], v12 offset:3112
    ds_read_b128 v[48:51], v13 offset:1200
    s_waitcnt lgkmcnt(6)
    v_mfma_f32_32x32x16_bf16 v[80:95], v[20:23], v[52:55], v[80:95]
    ds_read_b64 v[20:21], v12 offset:3168
    ds_read_b64 v[22:23], v12 offset:3176
    ds_read_b128 v[52:55], v13 offset:1120
    s_waitcnt lgkmcnt(6)
    v_mfma_f32_32x32x16_bf16 v[80:95], v[24:27], v[56:59], v[80:95]
    ds_read_b64 v[24:25], v12 offset:3232
    ds_read_b64 v[26:27], v12 offset:3240
    ds_read_b128 v[56:59], v13 offset:1040
    s_waitcnt lgkmcnt(6)
    v_mfma_f32_32x32x16_bf16 v[80:95], v[16:19], v[48:51], v[80:95]
    ds_read_b64 v[16:17], v12 offset:3296
    ds_read_b64 v[18:19], v12 offset:3304
    ds_read_b128 v[48:51], v13 offset:960
    s_waitcnt lgkmcnt(6)
    v_mfma_f32_32x32x16_bf16 v[80:95], v[20:23], v[52:55], v[80:95]
    ds_read_b64 v[20:21], v12 offset:3360
    ds_read_b64 v[22:23], v12 offset:3368
    ds_read_b128 v[52:55], v13 offset:880
    s_waitcnt lgkmcnt(6)
    v_mfma_f32_32x32x16_bf16 v[80:95], v[24:27], v[56:59], v[80:95]
    ds_read_b64 v[24:25], v12 offset:3424
    ds_read_b64 v[26:27], v12 offset:3432
    ds_read_b128 v[56:59], v13 offset:800
    s_waitcnt lgkmcnt(6)
    v_mfma_f32_32x32x16_bf16 v[80:95], v[16:19], v[48:51], v[80:95]
    ds_read_b64 v[16:17], v12 offset:3488
    ds_read_b64 v[18:19], v12 offset:3496
    ds_read_b128 v[48:51], v13 offset:720
    s_waitcnt lgkmcnt(6)
    v_mfma_f32_32x32x16_bf16 v[80:95], v[20:23], v[52:55], v[80:95]
    ds_read_b64 v[20:21], v12 offset:3552
    ds_read_b64 v[22:23], v12 offset:3560
    ds_read_b128 v[52:55], v13 offset:640
    s_waitcnt lgkmcnt(6)
    v_mfma_f32_32x32x16_bf16 v[80:95], v[24:27], v[56:59], v[80:95]
    ds_read_b64 v[24:25], v12 offset:3616
    ds_read_b64 v[26:27], v12 offset:3624
    ds_read_b128 v[56:59], v13 offset:560
    s_waitcnt lgkmcnt(6)
    v_mfma_f32_32x32x16_bf16 v[80:95], v[16:19], v[48:51], v[80:95]
    ds_read_b64 v[16:17], v12 offset:3680
    ds_read_b64 v[18:19], v12 offset:3688
    ds_read_b128 v[48:51], v13 offset:480
    s_waitcnt lgkmcnt(6)
    v_mfma_f32_32x32x16_bf16 v[80:95], v[20:23], v[52:55], v[80:95]
    ds_read_b64 v[20:21], v12 offset:3744
    ds_read_b64 v[22:23], v12 offset:3752
    ds_read_b128 v[52:55], v13 offset:400
    s_waitcnt lgkmcnt(6)
    v_mfma_f32_32x32x16_bf16 v[80:95], v[24:27], v[56:59], v[80:95]
    ds_read_b64 v[24:25], v12 offset:3808
    ds_read_b64 v[26:27], v12 offset:3816
    ds_read_b128 v[56:59], v13 offset:320
    s_waitcnt lgkmcnt(6)
    v_mfma_f32_32x32x16_bf16 v[80:95], v[16:19], v[48:51], v[80:95]
    ds_read_b64 v[16:17], v12 offset:3872
    ds_read_b64 v[18:19], v12 offset:3880
    ds_read_b128 v[48:51], v13 offset:240
    s_waitcnt lgkmcnt(6)
    v_mfma_f32_32x32x16_bf16 v[80:95], v[20:23], v[52:55], v[80:95]
    ds_read_b64 v[20:21], v12 offset:3936
    ds_read_b64 v[22:23], v12 offset:3944
    ds_read_b128 v[52:55], v13 offset:160
    s_waitcnt lgkmcnt(6)
    v_mfma_f32_32x32x16_bf16 v[80:95], v[24:27], v[56:59], v[80:95]
    ds_read_b64 v[24:25], v12 offset:4000
    ds_read_b64 v[26:27], v12 offset:4008
    ds_read_b128 v[56:59], v13 offset:80
    s_waitcnt lgkmcnt(6)
    v_mfma_f32_32x32x16_bf16 v[80:95], v[16:19], v[48:51], v[80:95]
    ds_read_b64 v[16:17], v12 offset:4064
    ds_read_b64 v[18:19], v12 offset:4072
    ds_read_b128 v[48:51], v13 offset:0
    s_waitcnt lgkmcnt(6)
    v_mfma_f32_32x32x16_bf16 v[80:95], v[20:23], v[52:55], v[80:95]
    s_waitcnt lgkmcnt(3)
    v_mfma_f32_32x32x16_bf16 v[80:95], v[24:27], v[56:59], v[80:95]
    s_waitcnt lgkmcnt(0)
    v_mfma_f32_32x32x16_bf16 v[80:95], v[16:19], v[48:51], v[80:95]
    s_nop 7
    s_nop 7
    s_barrier
    ds_write_b128 v3, v[64:67] offset:0
    ds_write_b128 v3, v[68:71] offset:1024
    ds_write_b128 v3, v[72:75] offset:2048
    ds_write_b128 v3, v[76:79] offset:3072
    ds_write_b128 v3, v[80:83] offset:4096
    ds_write_b128 v3, v[84:87] offset:5120
    ds_write_b128 v3, v[88:91] offset:6144
    ds_write_b128 v3, v[92:95] offset:7168
    s_waitcnt lgkmcnt(0)
    s_barrier
    s_endpgm
conv_epi:
    v_mul_u32_u24 v15, 80, v10
    v_lshlrev_b32 v16, 3, v11
    v_sub_u32 v16, 8, v16
    v_add_u32 v15, v15, v16
    v_add_u32 v15, 19376, v15
    v_add_u32 v15, s30, v15
    v_lshlrev_b32 v16, 6, v10
    v_lshl_add_u32 v16, v11, 3, v16
    v_add_u32 v17, s30, v16
    v_add_u32 v16, s31, v2

    ds_read_b64 v[100:101], v15 offset:0
    ds_read_b64 v[102:103], v15 offset:16
    ds_read_b64 v[104:105], v15 offset:32
    ds_read_b64 v[106:107], v15 offset:48
    ds_read_b64 v[108:109], v15 offset:2560
    ds_read_b64 v[110:111], v15 offset:2576
    ds_read_b64 v[112:113], v15 offset:2592
    ds_read_b64 v[114:115], v15 offset:2608
    s_nop 7
    s_nop 3
    s_waitcnt lgkmcnt(0)
    v_and_b32 v20, 0xffff0000, v101
    v_lshlrev_b32 v21, 16, v101
    v_and_b32 v22, 0xffff0000, v100
    v_lshlrev_b32 v23, 16, v100
    v_mul_f32 v20, v20, v9
    v_mul_f32 v21, v21, v9
    v_mul_f32 v22, v22, v9
    v_mul_f32 v23, v23, v9
    v_cvt_pk_bf16_f32 v24, v20, v21
    v_cvt_pk_bf16_f32 v25, v22, v23
    v_cvt_pk_bf16_f32 v26, v64, v65
    v_cvt_pk_bf16_f32 v27, v66, v67
    v_lshlrev_b32 v20, 16, v24
    v_and_b32 v21, 0xffff0000, v24
    v_lshlrev_b32 v22, 16, v25
    v_and_b32 v23, 0xffff0000, v25
    v_lshlrev_b32 v28, 16, v26
    v_and_b32 v29, 0xffff0000, v26
    v_lshlrev_b32 v30, 16, v27
    v_and_b32 v31, 0xffff0000, v27
    v_add_f32 v20, v20, v28
    v_add_f32 v21, v21, v29
    v_add_f32 v22, v22, v30
    v_add_f32 v23, v23, v31
    v_cvt_pk_bf16_f32 v100, v20, v21
    v_cvt_pk_bf16_f32 v101, v22, v23
    ds_write_b64 v17, v[100:101] offset:0

    v_and_b32 v20, 0xffff0000, v103
    v_lshlrev_b32 v21, 16, v103
    v_and_b32 v22, 0xffff0000, v102
    v_lshlrev_b32 v23, 16, v102
    v_mul_f32 v20, v20, v9
    v_mul_f32 v21, v21, v9
    v_mul_f32 v22, v22, v9
    v_mul_f32 v23, v23, v9
    v_cvt_pk_bf16_f32 v24, v20, v21
    v_cvt_pk_bf16_f32 v25, v22, v23
    v_cvt_pk_bf16_f32 v26, v68, v69
    v_cvt_pk_bf16_f32 v27, v70, v71
    v_lshlrev_b32 v20, 16, v24
    v_and_b32 v21, 0xffff0000, v24
    v_lshlrev_b32 v22, 16, v25
    v_and_b32 v23, 0xffff0000, v25
    v_lshlrev_b32 v28, 16, v26
    v_and_b32 v29, 0xffff0000, v26
    v_lshlrev_b32 v30, 16, v27
    v_and_b32 v31, 0xffff0000, v27
    v_add_f32 v20, v20, v28
    v_add_f32 v21, v21, v29
    v_add_f32 v22, v22, v30
    v_add_f32 v23, v23, v31
    v_cvt_pk_bf16_f32 v102, v20, v21
    v_cvt_pk_bf16_f32 v103, v22, v23
    ds_write_b64 v17, v[102:103] offset:16

    v_and_b32 v20, 0xffff0000, v105
    v_lshlrev_b32 v21, 16, v105
    v_and_b32 v22, 0xffff0000, v104
    v_lshlrev_b32 v23, 16, v104
    v_mul_f32 v20, v20, v9
    v_mul_f32 v21, v21, v9
    v_mul_f32 v22, v22, v9
    v_mul_f32 v23, v23, v9
    v_cvt_pk_bf16_f32 v24, v20, v21
    v_cvt_pk_bf16_f32 v25, v22, v23
    v_cvt_pk_bf16_f32 v26, v72, v73
    v_cvt_pk_bf16_f32 v27, v74, v75
    v_lshlrev_b32 v20, 16, v24
    v_and_b32 v21, 0xffff0000, v24
    v_lshlrev_b32 v22, 16, v25
    v_and_b32 v23, 0xffff0000, v25
    v_lshlrev_b32 v28, 16, v26
    v_and_b32 v29, 0xffff0000, v26
    v_lshlrev_b32 v30, 16, v27
    v_and_b32 v31, 0xffff0000, v27
    v_add_f32 v20, v20, v28
    v_add_f32 v21, v21, v29
    v_add_f32 v22, v22, v30
    v_add_f32 v23, v23, v31
    v_cvt_pk_bf16_f32 v104, v20, v21
    v_cvt_pk_bf16_f32 v105, v22, v23
    ds_write_b64 v17, v[104:105] offset:32

    v_and_b32 v20, 0xffff0000, v107
    v_lshlrev_b32 v21, 16, v107
    v_and_b32 v22, 0xffff0000, v106
    v_lshlrev_b32 v23, 16, v106
    v_mul_f32 v20, v20, v9
    v_mul_f32 v21, v21, v9
    v_mul_f32 v22, v22, v9
    v_mul_f32 v23, v23, v9
    v_cvt_pk_bf16_f32 v24, v20, v21
    v_cvt_pk_bf16_f32 v25, v22, v23
    v_cvt_pk_bf16_f32 v26, v76, v77
    v_cvt_pk_bf16_f32 v27, v78, v79
    v_lshlrev_b32 v20, 16, v24
    v_and_b32 v21, 0xffff0000, v24
    v_lshlrev_b32 v22, 16, v25
    v_and_b32 v23, 0xffff0000, v25
    v_lshlrev_b32 v28, 16, v26
    v_and_b32 v29, 0xffff0000, v26
    v_lshlrev_b32 v30, 16, v27
    v_and_b32 v31, 0xffff0000, v27
    v_add_f32 v20, v20, v28
    v_add_f32 v21, v21, v29
    v_add_f32 v22, v22, v30
    v_add_f32 v23, v23, v31
    v_cvt_pk_bf16_f32 v106, v20, v21
    v_cvt_pk_bf16_f32 v107, v22, v23
    ds_write_b64 v17, v[106:107] offset:48

    v_and_b32 v20, 0xffff0000, v109
    v_lshlrev_b32 v21, 16, v109
    v_and_b32 v22, 0xffff0000, v108
    v_lshlrev_b32 v23, 16, v108
    v_mul_f32 v20, v20, v9
    v_mul_f32 v21, v21, v9
    v_mul_f32 v22, v22, v9
    v_mul_f32 v23, v23, v9
    v_cvt_pk_bf16_f32 v24, v20, v21
    v_cvt_pk_bf16_f32 v25, v22, v23
    v_cvt_pk_bf16_f32 v26, v80, v81
    v_cvt_pk_bf16_f32 v27, v82, v83
    v_lshlrev_b32 v20, 16, v24
    v_and_b32 v21, 0xffff0000, v24
    v_lshlrev_b32 v22, 16, v25
    v_and_b32 v23, 0xffff0000, v25
    v_lshlrev_b32 v28, 16, v26
    v_and_b32 v29, 0xffff0000, v26
    v_lshlrev_b32 v30, 16, v27
    v_and_b32 v31, 0xffff0000, v27
    v_add_f32 v20, v20, v28
    v_add_f32 v21, v21, v29
    v_add_f32 v22, v22, v30
    v_add_f32 v23, v23, v31
    v_cvt_pk_bf16_f32 v108, v20, v21
    v_cvt_pk_bf16_f32 v109, v22, v23
    ds_write_b64 v17, v[108:109] offset:2048

    v_and_b32 v20, 0xffff0000, v111
    v_lshlrev_b32 v21, 16, v111
    v_and_b32 v22, 0xffff0000, v110
    v_lshlrev_b32 v23, 16, v110
    v_mul_f32 v20, v20, v9
    v_mul_f32 v21, v21, v9
    v_mul_f32 v22, v22, v9
    v_mul_f32 v23, v23, v9
    v_cvt_pk_bf16_f32 v24, v20, v21
    v_cvt_pk_bf16_f32 v25, v22, v23
    v_cvt_pk_bf16_f32 v26, v84, v85
    v_cvt_pk_bf16_f32 v27, v86, v87
    v_lshlrev_b32 v20, 16, v24
    v_and_b32 v21, 0xffff0000, v24
    v_lshlrev_b32 v22, 16, v25
    v_and_b32 v23, 0xffff0000, v25
    v_lshlrev_b32 v28, 16, v26
    v_and_b32 v29, 0xffff0000, v26
    v_lshlrev_b32 v30, 16, v27
    v_and_b32 v31, 0xffff0000, v27
    v_add_f32 v20, v20, v28
    v_add_f32 v21, v21, v29
    v_add_f32 v22, v22, v30
    v_add_f32 v23, v23, v31
    v_cvt_pk_bf16_f32 v110, v20, v21
    v_cvt_pk_bf16_f32 v111, v22, v23
    ds_write_b64 v17, v[110:111] offset:2064

    v_and_b32 v20, 0xffff0000, v113
    v_lshlrev_b32 v21, 16, v113
    v_and_b32 v22, 0xffff0000, v112
    v_lshlrev_b32 v23, 16, v112
    v_mul_f32 v20, v20, v9
    v_mul_f32 v21, v21, v9
    v_mul_f32 v22, v22, v9
    v_mul_f32 v23, v23, v9
    v_cvt_pk_bf16_f32 v24, v20, v21
    v_cvt_pk_bf16_f32 v25, v22, v23
    v_cvt_pk_bf16_f32 v26, v88, v89
    v_cvt_pk_bf16_f32 v27, v90, v91
    v_lshlrev_b32 v20, 16, v24
    v_and_b32 v21, 0xffff0000, v24
    v_lshlrev_b32 v22, 16, v25
    v_and_b32 v23, 0xffff0000, v25
    v_lshlrev_b32 v28, 16, v26
    v_and_b32 v29, 0xffff0000, v26
    v_lshlrev_b32 v30, 16, v27
    v_and_b32 v31, 0xffff0000, v27
    v_add_f32 v20, v20, v28
    v_add_f32 v21, v21, v29
    v_add_f32 v22, v22, v30
    v_add_f32 v23, v23, v31
    v_cvt_pk_bf16_f32 v112, v20, v21
    v_cvt_pk_bf16_f32 v113, v22, v23
    ds_write_b64 v17, v[112:113] offset:2080

    v_and_b32 v20, 0xffff0000, v115
    v_lshlrev_b32 v21, 16, v115
    v_and_b32 v22, 0xffff0000, v114
    v_lshlrev_b32 v23, 16, v114
    v_mul_f32 v20, v20, v9
    v_mul_f32 v21, v21, v9
    v_mul_f32 v22, v22, v9
    v_mul_f32 v23, v23, v9
    v_cvt_pk_bf16_f32 v24, v20, v21
    v_cvt_pk_bf16_f32 v25, v22, v23
    v_cvt_pk_bf16_f32 v26, v92, v93
    v_cvt_pk_bf16_f32 v27, v94, v95
    v_lshlrev_b32 v20, 16, v24
    v_and_b32 v21, 0xffff0000, v24
    v_lshlrev_b32 v22, 16, v25
    v_and_b32 v23, 0xffff0000, v25
    v_lshlrev_b32 v28, 16, v26
    v_and_b32 v29, 0xffff0000, v26
    v_lshlrev_b32 v30, 16, v27
    v_and_b32 v31, 0xffff0000, v27
    v_add_f32 v20, v20, v28
    v_add_f32 v21, v21, v29
    v_add_f32 v22, v22, v30
    v_add_f32 v23, v23, v31
    v_cvt_pk_bf16_f32 v114, v20, v21
    v_cvt_pk_bf16_f32 v115, v22, v23
    ds_write_b64 v17, v[114:115] offset:2096

    s_waitcnt lgkmcnt(0)
    ds_read_b128 v[32:35], v3 offset:0
    ds_read_b128 v[36:39], v3 offset:1024
    ds_read_b128 v[40:43], v3 offset:2048
    ds_read_b128 v[44:47], v3 offset:3072
    s_waitcnt lgkmcnt(3)
    buffer_store_dwordx4 v[32:35], v16, s[20:23], 0 offen offset:0
    s_waitcnt lgkmcnt(2)
    buffer_store_dwordx4 v[36:39], v16, s[20:23], 0 offen offset:1024
    s_waitcnt lgkmcnt(1)
    buffer_store_dwordx4 v[40:43], v16, s[20:23], 0 offen offset:2048
    s_waitcnt lgkmcnt(0)
    buffer_store_dwordx4 v[44:47], v16, s[20:23], 0 offen offset:3072
g2_done:
    s_endpgm
.globl final_kernel
.p2align 8
.type final_kernel,@function
final_kernel:
    s_load_dwordx2 s[4:5], s[0:1], 96
    s_load_dwordx2 s[6:7], s[0:1], 0
    s_load_dwordx2 s[8:9], s[0:1], 80
    s_cmp_ge_u32 s2, 288
    s_cbranch_scc1 k4_done
    s_mov_b32 s34, 0x1c71c71d
    s_mul_hi_u32 s35, s2, s34
    s_mul_i32 s36, s35, 9
    s_sub_u32 s36, s2, s36
    v_lshrrev_b32 v1, 6, v0
    s_nop 0
    v_readfirstlane_b32 s24, v1
    v_and_b32 v1, 63, v0
    s_waitcnt lgkmcnt(0)

    s_add_u32 s12, s4, 23592960
    s_addc_u32 s13, s5, 0
    s_mov_b32 s14, 2359296
    s_mov_b32 s15, 0x00020000
    s_add_u32 s16, s4, 25952256
    s_addc_u32 s17, s5, 0
    s_mov_b32 s18, 18874368
    s_mov_b32 s19, 0x00020000
    s_mov_b32 s20, s4
    s_mov_b32 s21, s5
    s_mov_b32 s22, 2359296
    s_mov_b32 s23, 0x00020000
    s_mov_b32 s40, s6
    s_mov_b32 s41, s7
    s_mov_b32 s42, 2359296
    s_mov_b32 s43, 0x00020000
    s_mov_b32 s44, s8
    s_mov_b32 s45, s9
    s_mov_b32 s46, 2359296
    s_mov_b32 s47, 0x00020000
    v_lshrrev_b32 v2, 2, v0
    v_and_b32 v3, 3, v0
    s_lshl_b32 s37, s36, 6
    v_add_u32 v4, s37, v2
    v_lshlrev_b32 v4, 12, v4
    v_lshl_add_u32 v4, v3, 5, v4
    s_lshl_b32 s38, s35, 7
    v_add_u32 v4, s38, v4
    buffer_load_dwordx4 v[8:11], v4, s[12:15], 0 offen
    buffer_load_dwordx4 v[12:15], v4, s[12:15], 0 offen offset:16
    v_mul_u32_u24 v5, 160, v2
    v_lshl_add_u32 v5, v3, 5, v5
    s_lshl_b32 s25, s35, 2
    s_add_u32 s25, s25, s24
    s_mul_i32 s26, s25, 36
    s_lshl_b32 s27, s36, 2
    s_add_u32 s26, s26, s27
    s_lshl_b32 s26, s26, 10
    v_lshlrev_b32 v6, 4, v1
    v_add_u32 v6, s26, v6
    v_and_b32 v7, 15, v1
    s_lshl_b32 s27, s25, 4
    v_add_u32 v7, s27, v7
    v_mul_u32_u24 v7, 1152, v7
    v_lshrrev_b32 v16, 4, v1
    v_lshl_add_u32 v7, v16, 3, v7
    s_lshl_b32 s27, s36, 7
    v_add_u32 v7, s27, v7
    s_mul_i32 s27, s25, 18
    s_lshl_b32 s28, s36, 1
    s_add_u32 s27, s27, s28
    s_lshl_b32 s27, s27, 10
    v_lshlrev_b32 v17, 4, v1
    v_add_u32 v17, s27, v17
    v_lshrrev_b32 v18, 2, v1
    v_mul_u32_u24 v18, 160, v18
    v_and_b32 v19, 3, v1
    v_lshl_add_u32 v18, v19, 3, v18
    s_lshl_b32 s27, s24, 5
    v_add_u32 v18, s27, v18

    s_mov_b32 s27, 0
    buffer_load_dwordx4 v[24:27], v6, s[16:19], s27 offen
    s_mov_b32 s27, 4718592
    buffer_load_dwordx4 v[28:31], v6, s[16:19], s27 offen
    s_mov_b32 s27, 9437184
    buffer_load_dwordx4 v[32:35], v6, s[16:19], s27 offen
    s_mov_b32 s27, 14155776
    buffer_load_dwordx4 v[36:39], v6, s[16:19], s27 offen
    buffer_load_dwordx2 v[88:89], v7, s[40:43], 0 offen offset:0
    buffer_load_dwordx2 v[90:91], v17, s[20:23], 0 offen offset:0
    s_mov_b32 s27, 1024
    buffer_load_dwordx4 v[40:43], v6, s[16:19], s27 offen
    s_mov_b32 s27, 4719616
    buffer_load_dwordx4 v[44:47], v6, s[16:19], s27 offen
    s_mov_b32 s27, 9438208
    buffer_load_dwordx4 v[48:51], v6, s[16:19], s27 offen
    s_mov_b32 s27, 14156800
    buffer_load_dwordx4 v[52:55], v6, s[16:19], s27 offen
    buffer_load_dwordx2 v[92:93], v7, s[40:43], 0 offen offset:32
    buffer_load_dwordx2 v[94:95], v17, s[20:23], 0 offen offset:8
    s_mov_b32 s27, 2048
    buffer_load_dwordx4 v[56:59], v6, s[16:19], s27 offen
    s_mov_b32 s27, 4720640
    buffer_load_dwordx4 v[60:63], v6, s[16:19], s27 offen
    s_mov_b32 s27, 9439232
    buffer_load_dwordx4 v[64:67], v6, s[16:19], s27 offen
    s_mov_b32 s27, 14157824
    buffer_load_dwordx4 v[68:71], v6, s[16:19], s27 offen
    buffer_load_dwordx2 v[96:97], v7, s[40:43], 0 offen offset:64
    buffer_load_dwordx2 v[98:99], v17, s[20:23], 0 offen offset:1024
    s_mov_b32 s27, 3072
    buffer_load_dwordx4 v[72:75], v6, s[16:19], s27 offen
    s_mov_b32 s27, 4721664
    buffer_load_dwordx4 v[76:79], v6, s[16:19], s27 offen
    s_mov_b32 s27, 9440256
    buffer_load_dwordx4 v[80:83], v6, s[16:19], s27 offen
    s_mov_b32 s27, 14158848
    buffer_load_dwordx4 v[84:87], v6, s[16:19], s27 offen
    buffer_load_dwordx2 v[100:101], v7, s[40:43], 0 offen offset:96
    buffer_load_dwordx2 v[102:103], v17, s[20:23], 0 offen offset:1032
    s_waitcnt vmcnt(24)
    ds_write_b128 v5, v[8:11]
    ds_write_b128 v5, v[12:15] offset:16
    s_waitcnt lgkmcnt(0)
    s_barrier

    ds_read_b64_tr_b16 v[104:105], v18 offset:0
    ds_read_b64_tr_b16 v[106:107], v18 offset:2560
    ds_read_b64_tr_b16 v[108:109], v18 offset:5120
    ds_read_b64_tr_b16 v[110:111], v18 offset:7680
    s_waitcnt vmcnt(18) lgkmcnt(3)
    v_add_f32 v24, v24, v28
    v_add_f32 v32, v32, v36
    v_add_f32 v24, v24, v32
    v_add_f32 v25, v25, v29
    v_add_f32 v33, v33, v37
    v_add_f32 v25, v25, v33
    v_add_f32 v26, v26, v30
    v_add_f32 v34, v34, v38
    v_add_f32 v26, v26, v34
    v_add_f32 v27, v27, v31
    v_add_f32 v35, v35, v39
    v_add_f32 v27, v27, v35
    v_cvt_pk_bf16_f32 v112, v24, v25
    v_cvt_pk_bf16_f32 v113, v26, v27
    v_lshlrev_b32 v116, 16, v90
    v_and_b32 v117, 0xffff0000, v90
    v_lshlrev_b32 v118, 16, v91
    v_and_b32 v119, 0xffff0000, v91
    v_lshlrev_b32 v120, 16, v104
    v_and_b32 v121, 0xffff0000, v104
    v_lshlrev_b32 v122, 16, v105
    v_and_b32 v123, 0xffff0000, v105
    v_mul_f32 v116, v116, v120
    v_mul_f32 v117, v117, v121
    v_mul_f32 v118, v118, v122
    v_mul_f32 v119, v119, v123
    v_cvt_pk_bf16_f32 v114, v116, v117
    v_cvt_pk_bf16_f32 v115, v118, v119
    v_lshlrev_b32 v116, 16, v88
    v_and_b32 v117, 0xffff0000, v88
    v_lshlrev_b32 v118, 16, v89
    v_and_b32 v119, 0xffff0000, v89
    v_lshlrev_b32 v120, 16, v114
    v_and_b32 v121, 0xffff0000, v114
    v_lshlrev_b32 v122, 16, v115
    v_and_b32 v123, 0xffff0000, v115
    v_add_f32 v116, v116, v120
    v_add_f32 v117, v117, v121
    v_add_f32 v118, v118, v122
    v_add_f32 v119, v119, v123
    v_cvt_pk_bf16_f32 v114, v116, v117
    v_cvt_pk_bf16_f32 v115, v118, v119
    v_lshlrev_b32 v116, 16, v114
    v_and_b32 v117, 0xffff0000, v114
    v_lshlrev_b32 v118, 16, v115
    v_and_b32 v119, 0xffff0000, v115
    v_lshlrev_b32 v120, 16, v112
    v_and_b32 v121, 0xffff0000, v112
    v_lshlrev_b32 v122, 16, v113
    v_and_b32 v123, 0xffff0000, v113
    v_add_f32 v116, v116, v120
    v_add_f32 v117, v117, v121
    v_add_f32 v118, v118, v122
    v_add_f32 v119, v119, v123
    v_cvt_pk_bf16_f32 v24, v116, v117
    v_cvt_pk_bf16_f32 v25, v118, v119

    s_waitcnt vmcnt(12) lgkmcnt(2)
    v_add_f32 v40, v40, v44
    v_add_f32 v48, v48, v52
    v_add_f32 v40, v40, v48
    v_add_f32 v41, v41, v45
    v_add_f32 v49, v49, v53
    v_add_f32 v41, v41, v49
    v_add_f32 v42, v42, v46
    v_add_f32 v50, v50, v54
    v_add_f32 v42, v42, v50
    v_add_f32 v43, v43, v47
    v_add_f32 v51, v51, v55
    v_add_f32 v43, v43, v51
    v_cvt_pk_bf16_f32 v112, v40, v41
    v_cvt_pk_bf16_f32 v113, v42, v43
    v_lshlrev_b32 v116, 16, v94
    v_and_b32 v117, 0xffff0000, v94
    v_lshlrev_b32 v118, 16, v95
    v_and_b32 v119, 0xffff0000, v95
    v_lshlrev_b32 v120, 16, v106
    v_and_b32 v121, 0xffff0000, v106
    v_lshlrev_b32 v122, 16, v107
    v_and_b32 v123, 0xffff0000, v107
    v_mul_f32 v116, v116, v120
    v_mul_f32 v117, v117, v121
    v_mul_f32 v118, v118, v122
    v_mul_f32 v119, v119, v123
    v_cvt_pk_bf16_f32 v114, v116, v117
    v_cvt_pk_bf16_f32 v115, v118, v119
    v_lshlrev_b32 v116, 16, v92
    v_and_b32 v117, 0xffff0000, v92
    v_lshlrev_b32 v118, 16, v93
    v_and_b32 v119, 0xffff0000, v93
    v_lshlrev_b32 v120, 16, v114
    v_and_b32 v121, 0xffff0000, v114
    v_lshlrev_b32 v122, 16, v115
    v_and_b32 v123, 0xffff0000, v115
    v_add_f32 v116, v116, v120
    v_add_f32 v117, v117, v121
    v_add_f32 v118, v118, v122
    v_add_f32 v119, v119, v123
    v_cvt_pk_bf16_f32 v114, v116, v117
    v_cvt_pk_bf16_f32 v115, v118, v119
    v_lshlrev_b32 v116, 16, v114
    v_and_b32 v117, 0xffff0000, v114
    v_lshlrev_b32 v118, 16, v115
    v_and_b32 v119, 0xffff0000, v115
    v_lshlrev_b32 v120, 16, v112
    v_and_b32 v121, 0xffff0000, v112
    v_lshlrev_b32 v122, 16, v113
    v_and_b32 v123, 0xffff0000, v113
    v_add_f32 v116, v116, v120
    v_add_f32 v117, v117, v121
    v_add_f32 v118, v118, v122
    v_add_f32 v119, v119, v123
    v_cvt_pk_bf16_f32 v40, v116, v117
    v_cvt_pk_bf16_f32 v41, v118, v119

    s_waitcnt vmcnt(6) lgkmcnt(1)
    v_add_f32 v56, v56, v60
    v_add_f32 v64, v64, v68
    v_add_f32 v56, v56, v64
    v_add_f32 v57, v57, v61
    v_add_f32 v65, v65, v69
    v_add_f32 v57, v57, v65
    v_add_f32 v58, v58, v62
    v_add_f32 v66, v66, v70
    v_add_f32 v58, v58, v66
    v_add_f32 v59, v59, v63
    v_add_f32 v67, v67, v71
    v_add_f32 v59, v59, v67
    v_cvt_pk_bf16_f32 v112, v56, v57
    v_cvt_pk_bf16_f32 v113, v58, v59
    v_lshlrev_b32 v116, 16, v98
    v_and_b32 v117, 0xffff0000, v98
    v_lshlrev_b32 v118, 16, v99
    v_and_b32 v119, 0xffff0000, v99
    v_lshlrev_b32 v120, 16, v108
    v_and_b32 v121, 0xffff0000, v108
    v_lshlrev_b32 v122, 16, v109
    v_and_b32 v123, 0xffff0000, v109
    v_mul_f32 v116, v116, v120
    v_mul_f32 v117, v117, v121
    v_mul_f32 v118, v118, v122
    v_mul_f32 v119, v119, v123
    v_cvt_pk_bf16_f32 v114, v116, v117
    v_cvt_pk_bf16_f32 v115, v118, v119
    v_lshlrev_b32 v116, 16, v96
    v_and_b32 v117, 0xffff0000, v96
    v_lshlrev_b32 v118, 16, v97
    v_and_b32 v119, 0xffff0000, v97
    v_lshlrev_b32 v120, 16, v114
    v_and_b32 v121, 0xffff0000, v114
    v_lshlrev_b32 v122, 16, v115
    v_and_b32 v123, 0xffff0000, v115
    v_add_f32 v116, v116, v120
    v_add_f32 v117, v117, v121
    v_add_f32 v118, v118, v122
    v_add_f32 v119, v119, v123
    v_cvt_pk_bf16_f32 v114, v116, v117
    v_cvt_pk_bf16_f32 v115, v118, v119
    v_lshlrev_b32 v116, 16, v114
    v_and_b32 v117, 0xffff0000, v114
    v_lshlrev_b32 v118, 16, v115
    v_and_b32 v119, 0xffff0000, v115
    v_lshlrev_b32 v120, 16, v112
    v_and_b32 v121, 0xffff0000, v112
    v_lshlrev_b32 v122, 16, v113
    v_and_b32 v123, 0xffff0000, v113
    v_add_f32 v116, v116, v120
    v_add_f32 v117, v117, v121
    v_add_f32 v118, v118, v122
    v_add_f32 v119, v119, v123
    v_cvt_pk_bf16_f32 v56, v116, v117
    v_cvt_pk_bf16_f32 v57, v118, v119

    s_waitcnt vmcnt(0) lgkmcnt(0)
    v_add_f32 v72, v72, v76
    v_add_f32 v80, v80, v84
    v_add_f32 v72, v72, v80
    v_add_f32 v73, v73, v77
    v_add_f32 v81, v81, v85
    v_add_f32 v73, v73, v81
    v_add_f32 v74, v74, v78
    v_add_f32 v82, v82, v86
    v_add_f32 v74, v74, v82
    v_add_f32 v75, v75, v79
    v_add_f32 v83, v83, v87
    v_add_f32 v75, v75, v83
    v_cvt_pk_bf16_f32 v112, v72, v73
    v_cvt_pk_bf16_f32 v113, v74, v75
    v_lshlrev_b32 v116, 16, v102
    v_and_b32 v117, 0xffff0000, v102
    v_lshlrev_b32 v118, 16, v103
    v_and_b32 v119, 0xffff0000, v103
    v_lshlrev_b32 v120, 16, v110
    v_and_b32 v121, 0xffff0000, v110
    v_lshlrev_b32 v122, 16, v111
    v_and_b32 v123, 0xffff0000, v111
    v_mul_f32 v116, v116, v120
    v_mul_f32 v117, v117, v121
    v_mul_f32 v118, v118, v122
    v_mul_f32 v119, v119, v123
    v_cvt_pk_bf16_f32 v114, v116, v117
    v_cvt_pk_bf16_f32 v115, v118, v119
    v_lshlrev_b32 v116, 16, v100
    v_and_b32 v117, 0xffff0000, v100
    v_lshlrev_b32 v118, 16, v101
    v_and_b32 v119, 0xffff0000, v101
    v_lshlrev_b32 v120, 16, v114
    v_and_b32 v121, 0xffff0000, v114
    v_lshlrev_b32 v122, 16, v115
    v_and_b32 v123, 0xffff0000, v115
    v_add_f32 v116, v116, v120
    v_add_f32 v117, v117, v121
    v_add_f32 v118, v118, v122
    v_add_f32 v119, v119, v123
    v_cvt_pk_bf16_f32 v114, v116, v117
    v_cvt_pk_bf16_f32 v115, v118, v119
    v_lshlrev_b32 v116, 16, v114
    v_and_b32 v117, 0xffff0000, v114
    v_lshlrev_b32 v118, 16, v115
    v_and_b32 v119, 0xffff0000, v115
    v_lshlrev_b32 v120, 16, v112
    v_and_b32 v121, 0xffff0000, v112
    v_lshlrev_b32 v122, 16, v113
    v_and_b32 v123, 0xffff0000, v113
    v_add_f32 v116, v116, v120
    v_add_f32 v117, v117, v121
    v_add_f32 v118, v118, v122
    v_add_f32 v119, v119, v123
    v_cvt_pk_bf16_f32 v72, v116, v117
    v_cvt_pk_bf16_f32 v73, v118, v119

    s_mul_i32 s27, s24, 2304
    s_add_u32 s27, s27, 10240
    v_and_b32 v112, 15, v1
    v_mul_u32_u24 v112, 144, v112
    v_lshrrev_b32 v113, 4, v1
    v_lshl_add_u32 v112, v113, 3, v112
    v_add_u32 v112, s27, v112
    v_lshrrev_b32 v113, 3, v1
    v_mul_u32_u24 v114, 144, v113
    v_and_b32 v115, 7, v1
    v_lshl_add_u32 v114, v115, 4, v114
    v_add_u32 v114, s27, v114
    s_lshl_b32 s27, s25, 4
    v_add_u32 v113, s27, v113
    v_mul_u32_u24 v113, 1152, v113
    v_lshl_add_u32 v113, v115, 4, v113
    s_lshl_b32 s27, s36, 7
    v_add_u32 v113, s27, v113

    ds_write_b64 v112, v[24:25] offset:0
    ds_write_b64 v112, v[40:41] offset:32
    ds_write_b64 v112, v[56:57] offset:64
    ds_write_b64 v112, v[72:73] offset:96
    s_waitcnt lgkmcnt(0)
    ds_read_b128 v[116:119], v114
    ds_read_b128 v[120:123], v114 offset:1152
    s_movk_i32 s27, 9216
    s_waitcnt lgkmcnt(1)
    buffer_store_dwordx4 v[116:119], v113, s[44:47], 0 offen
    s_waitcnt lgkmcnt(0)
    buffer_store_dwordx4 v[120:123], v113, s[44:47], s27 offen

k4_done:
    s_endpgm
.section .rodata,"a"
.p2align 6
.amdhsa_kernel prep_kernel
  .amdhsa_next_free_vgpr 128
  .amdhsa_next_free_sgpr 48
  .amdhsa_accum_offset 128
  .amdhsa_group_segment_fixed_size 0
  .amdhsa_kernarg_size 104
  .amdhsa_user_sgpr_count 2
  .amdhsa_user_sgpr_kernarg_segment_ptr 1
  .amdhsa_system_sgpr_workgroup_id_x 1
.end_amdhsa_kernel
.p2align 6
.amdhsa_kernel gemm1_kernel
  .amdhsa_next_free_vgpr 256
  .amdhsa_next_free_sgpr 102
  .amdhsa_accum_offset 256
  .amdhsa_group_segment_fixed_size 0
  .amdhsa_kernarg_size 104
  .amdhsa_user_sgpr_count 2
  .amdhsa_user_sgpr_kernarg_segment_ptr 1
  .amdhsa_system_sgpr_workgroup_id_x 1
.end_amdhsa_kernel
.p2align 6
.amdhsa_kernel gemm2_kernel
  .amdhsa_next_free_vgpr 128
  .amdhsa_next_free_sgpr 96
  .amdhsa_accum_offset 128
  .amdhsa_group_segment_fixed_size 0
  .amdhsa_kernarg_size 104
  .amdhsa_user_sgpr_count 2
  .amdhsa_user_sgpr_kernarg_segment_ptr 1
  .amdhsa_system_sgpr_workgroup_id_x 1
.end_amdhsa_kernel
.p2align 6
.amdhsa_kernel final_kernel
  .amdhsa_next_free_vgpr 128
  .amdhsa_next_free_sgpr 64
  .amdhsa_accum_offset 128
  .amdhsa_group_segment_fixed_size 0
  .amdhsa_kernarg_size 104
  .amdhsa_user_sgpr_count 2
  .amdhsa_user_sgpr_kernarg_segment_ptr 1
  .amdhsa_system_sgpr_workgroup_id_x 1
.end_amdhsa_kernel
```
